```python
import torch

def _softmax(x, axis=-1):
    return torch.softmax(x, dim=axis)
def _gelu(x):
    return torch.nn.functional.gelu(x, approximate="tanh")
def _silu(x):
    return torch.nn.functional.silu(x)
def _sigmoid(x):
    return torch.sigmoid(x)
def _layernorm(x, axis=-1, eps=1e-5):
    m = x.mean(dim=axis, keepdim=True)
    v = x.var(dim=axis, keepdim=True, unbiased=False)
    return (x - m) / torch.sqrt(v + eps)
def _scatter_add(tgt, idx, src, axis=0):
    return tgt.clone().index_add_(axis, idx, src)
def _segment_sum(src, seg, n):
    out = torch.zeros((n,) + src.shape[1:], dtype=src.dtype)
    return out.index_add_(0, seg, src)
def _pad(x, pw):
    flat = tuple(v for pair in reversed(pw) for v in pair)
    return torch.nn.functional.pad(x, flat)

kernel_name = 'interleave_layers__sliding_local_dilated__glu_gated_geglu__prompt'

def setup_inputs():

    _w = (lambda a: (lambda t: t.to(torch.bfloat16) if t.is_floating_point() else t)(torch.as_tensor(a)))
    def _A_setup():
        B, S, D = 1, 2048, 512
        return {
            "x": _w((lambda *s: torch.randn(*s, dtype=torch.bfloat16) * 0.05)(B, S, D)),
            "wqkv": _w((lambda *s: torch.randn(*s, dtype=torch.bfloat16) * 0.05)(D, 3 * D)),
            "wo": _w((lambda *s: torch.randn(*s, dtype=torch.bfloat16) * 0.05)(D, D)),
        }
    _A_in = _A_setup()

    def _B_setup():
        B, S, Dm, Df = 1, 2048, 512, 1792
        return {
            "x": _w((lambda *s: torch.randn(*s, dtype=torch.bfloat16) * 0.05)(B, S, Dm)),
            "w_gate": _w((lambda *s: torch.randn(*s, dtype=torch.bfloat16) * 0.8)(Dm, Df) * (Dm ** -0.5)),
            "w_up": _w((lambda *s: torch.randn(*s, dtype=torch.bfloat16) * 0.8)(Dm, Df) * (Dm ** -0.5)),
            "w_down": _w((lambda *s: torch.randn(*s, dtype=torch.bfloat16) * 0.8)(Df, Dm) * (Df ** -0.5)),
        }
    _B_in = _B_setup()

    return {
        "A_x": _A_in["x"],
        "A_wqkv": _A_in["wqkv"],
        "A_wo": _A_in["wo"],
        "B_x": _B_in["x"],
        "B_w_gate": _B_in["w_gate"],
        "B_w_up": _B_in["w_up"],
        "B_w_down": _B_in["w_down"],
    }

def reference(A_x, A_wqkv, A_wo, B_x, B_w_gate, B_w_up, B_w_down):
    def _A_ref(x, wqkv, wo):
        B, S, D = x.shape
        H = 32; Dh = D // H
        W, dil = 8, 2
        qkv = (lambda x, *d: x.permute(*d))((x @ wqkv).reshape(B, S, 3, H, Dh), 2, 0, 3, 1, 4)
        q, k, v = qkv[0], qkv[1], qkv[2]
        scale = Dh ** -0.5
        pos = torch.arange(S)
        off = torch.arange(W) * dil
        idx = pos[:, None] - off[None, :]
        mask = idx >= 0
        idx_c = torch.where(mask, idx, 0).reshape(-1)
        kg = k[:, :, idx_c, :].reshape(B, H, S, W, Dh)
        vg = v[:, :, idx_c, :].reshape(B, H, S, W, Dh)
        logits = torch.einsum("bhsd,bhswd->bhsw", q, kg) * scale
        logits = torch.where(mask[None, None, :, :], logits, -1e9)
        attn = _softmax(logits, axis=-1)
        o = torch.einsum("bhsw,bhswd->bhsd", attn, vg)
        return (lambda x, *d: x.permute(*d))(o, 0, 2, 1, 3).reshape(B, S, D) @ wo

    def _B_ref(x, w_gate, w_up, w_down):
        g = torch.einsum("bsd,df->bsf", x, w_gate)
        u = torch.einsum("bsd,df->bsf", x, w_up)
        h = _gelu(g) * u
        return torch.einsum("bsf,fd->bsd", h, w_down)

    x = A_x
    x = x + _A_ref(_layernorm(x, axis=-1), A_wqkv, A_wo)
    x = x + _B_ref(_layernorm(x, axis=-1), B_w_gate, B_w_up, B_w_down)
    x = x + _A_ref(_layernorm(x, axis=-1), A_wqkv, A_wo)
    x = x + _B_ref(_layernorm(x, axis=-1), B_w_gate, B_w_up, B_w_down)
    return x
```

```asm
; @launch grid=(256,1,1) block=(256,1,1) lds=163840
.amdgcn_target "amdgcn-amd-amdhsa--gfx950"
.text
.p2align 12
.globl interleave_layers__sliding_local_dilated__glu_gated_geglu__prompt_kernel
.p2align 8
.type interleave_layers__sliding_local_dilated__glu_gated_geglu__prompt_kernel,@function
interleave_layers__sliding_local_dilated__glu_gated_geglu__prompt_kernel:
    s_cmp_ge_u32 s2, 256
    s_cbranch_scc1 L_end_interleave_layers__sliding_local_dilated__glu_gated_geglu__prompt_kernel
    s_load_dwordx16 s[72:87], s[0:1], 0
    s_load_dwordx4 s[88:91], s[0:1], 64
    v_lshrrev_b32 v3, 6, v0
    v_and_b32 v0, 63, v0
    v_readfirstlane_b32 s3, v3
    v_lshlrev_b32 v1, 4, v0
    s_mov_b64 exec, 0
    s_cmp_eq_u32 s3, 0
    s_cbranch_scc1 L_pad15616
    s_cmp_eq_u32 s3, 1
    s_cbranch_scc1 L_pad3328
    s_cmp_eq_u32 s3, 2
    s_cbranch_scc1 L_pad7424
    s_cmp_eq_u32 s3, 3
    s_cbranch_scc1 L_pad11520
L_ret_top:
    s_mov_b64 exec, -1
    s_and_b32 s30, s2, 7
    s_lshr_b32 s31, s2, 3
    s_lshr_b32 s32, s30, 2
    s_lshl_b32 s32, s32, 4
    s_lshr_b32 s33, s31, 1
    s_add_u32 s16, s32, s33
    s_and_b32 s32, s30, 3
    s_lshl_b32 s32, s32, 1
    s_and_b32 s33, s31, 1
    s_add_u32 s17, s32, s33
    s_lshl_b32 s17, s17, 2
    s_add_u32 s17, s17, s3
    s_lshl_b32 s35, s3, 2
    v_lshrrev_b32 v3, 4, v0
    v_add_u32 v3, s35, v3
    v_and_b32 v4, 15, v0
    v_xor_b32 v4, v4, v3
    v_lshlrev_b32 v248, 10, v3
    v_lshl_add_u32 v248, v4, 4, v248
    v_lshrrev_b32 v3, 3, v0
    s_and_b32 s36, s3, 1
    s_lshl_b32 s36, s36, 1
    v_bfe_u32 v4, v0, 4, 1
    v_or_b32 v4, s36, v4
    v_bfe_u32 v5, v0, 1, 2
    v_xor_b32 v4, v4, v5
    s_lshl_b32 s36, s3, 3
    v_add_u32 v3, s36, v3
    v_mul_u32_u24 v249, 3072, v3
    v_lshl_add_u32 v249, v4, 5, v249
    v_and_b32 v4, 1, v0
    v_lshl_add_u32 v249, v4, 4, v249
    s_lshl_b32 s35, s3, 10
    s_mul_i32 s34, s3, 3072
    s_lshl_b32 s30, s16, 16
    s_sub_u32 s31, s30, 16384
    s_max_i32 s31, s31, 0
    s_add_u32 s68, s30, 16384
    s_add_u32 s69, s30, 32768
    s_add_u32 s27, s30, 49152
    s_lshr_b32 s32, s17, 2
    s_lshl_b32 s32, s32, 7
    s_and_b32 s52, s2, 7
    s_lshr_b32 s53, s2, 4
    s_lshl_b32 s53, s53, 3
    s_add_u32 s52, s52, s53
    s_lshl_b32 s52, s52, 1
    s_bfe_u32 s53, s2, 0x10003
    s_add_u32 s52, s52, s53
    s_mov_b32 s24, 0x3727c5ac
    s_mov_b32 s25, 0x3f803f80
    s_mov_b32 s26, 0x3eb8aa3b
    s_mov_b32 s28, 0xaaaaaaaa
    s_mov_b32 s29, 0xaaaaaaaa
    s_waitcnt lgkmcnt(0)
    s_mov_b32 s60, s72
    s_mov_b32 s61, s73
    s_mov_b32 s62, 0x200000
    s_mov_b32 s63, 0x00020000
    s_mov_b32 s92, s74
    s_mov_b32 s93, s75
    s_mov_b32 s94, 0x180000
    s_mov_b32 s95, 0x00020000
    s_mov_b32 s8, s90
    s_mov_b32 s9, s91
    s_mov_b32 s10, 0x10000000
    s_mov_b32 s11, 0x00020000
    s_mov_b32 s12, s86
    s_mov_b32 s13, s87
    s_mov_b32 s14, 0x200000
    s_mov_b32 s15, 0x00020000
    s_mov_b32 s4, s90
    s_mov_b32 s5, s91
    s_mov_b32 s78, 524288
    s_mov_b32 s79, 0x00020000
    s_mov_b32 s90, 256
    s_mov_b32 s91, 0x00020000
    s_cmp_lt_u32 s52, 240
    s_cbranch_scc1 L_z_skip
    s_cmp_gt_u32 s3, 1
    s_cbranch_scc1 L_z_skip
    s_sub_u32 s36, s52, 240
    s_lshl_b32 s36, s36, 1
    s_add_u32 s36, s36, s3
    s_lshl_b32 s36, s36, 14
    s_add_u32 s36, s36, 0x2300000
    v_lshlrev_b32 v3, 8, v0
    v_mov_b32 v4, 0
    buffer_store_dword v4, v3, s[8:11], s36 offen sc1
L_z_skip:
    s_add_u32 m0, s35, 0
    s_nop 0
    buffer_load_dwordx4 v248, s[60:63], s31 offen offset:0 lds
    s_add_u32 m0, s35, 4096
    s_nop 0
    buffer_load_dwordx4 v248, s[60:63], s30 offen offset:0 lds
    s_add_u32 m0, s35, 8192
    s_nop 0
    buffer_load_dwordx4 v248, s[60:63], s68 offen offset:0 lds
    s_add_u32 m0, s35, 12288
    s_nop 0
    buffer_load_dwordx4 v248, s[60:63], s69 offen offset:0 lds
    v_and_b32 v132, 15, v0
    v_lshrrev_b32 v133, 4, v0
    v_lshrrev_b32 v134, 2, v132
    v_mul_u32_u24 v250, 3072, v133
    v_lshl_add_u32 v250, v134, 7, v250
    v_bfe_u32 v135, v0, 3, 2
    v_xor_b32 v135, s3, v135
    v_lshl_add_u32 v250, v135, 5, v250
    v_and_b32 v135, 3, v0
    v_lshl_add_u32 v250, v135, 3, v250
    v_add_u32 v250, 114688, v250
    s_add_u32 m0, s35, 16384
    s_nop 0
    buffer_load_dwordx4 v248, s[60:63], s27 offen offset:0 lds
    s_lshl_b32 s38, s3, 12
    s_add_u32 s38, s38, 4096
    v_add_u32 v135, 0, v133
    v_xor_b32 v135, v135, v132
    v_lshlrev_b32 v140, 8, v132
    v_lshl_add_u32 v140, v135, 4, v140
    v_add_u32 v144, 61440, v140
    v_add_u32 v148, s38, v140
    v_add_u32 v135, 4, v133
    v_xor_b32 v135, v135, v132
    s_add_u32 m0, s34, 114688
    s_add_u32 s33, s32, 0
    buffer_load_dwordx4 v249, s[92:95], s33 offen offset:1024 lds
    v_lshlrev_b32 v141, 8, v132
    v_lshl_add_u32 v141, v135, 4, v141
    v_add_u32 v145, 61440, v141
    v_add_u32 v149, s38, v141
    v_add_u32 v135, 8, v133
    v_xor_b32 v135, v135, v132
    v_lshlrev_b32 v142, 8, v132
    v_lshl_add_u32 v142, v135, 4, v142
    v_add_u32 v146, 61440, v142
    v_add_u32 v150, s38, v142
    buffer_load_dwordx4 v249, s[92:95], s33 offen offset:2048 lds
    v_add_u32 v135, 12, v133
    v_xor_b32 v135, v135, v132
    v_lshlrev_b32 v143, 8, v132
    v_lshl_add_u32 v143, v135, 4, v143
    v_add_u32 v147, 61440, v143
    v_add_u32 v151, s38, v143
    s_mul_i32 s38, s3, 20480
    v_add_u32 v100, s38, v140
    v_add_u32 v101, s38, v141
    v_add_u32 v102, s38, v142
    v_add_u32 v103, s38, v143
    buffer_load_dwordx4 v249, s[92:95], s33 offen offset:0 lds
    v_lshlrev_b32 v104, 3, v132
    s_lshl_b32 s38, s3, 7
    s_add_u32 s38, s38, 4096
    v_add_u32 v105, s38, v104
    v_mov_b32 v188, s25
    v_mov_b32 v189, s25
    v_mov_b32 v190, s25
    v_mov_b32 v191, s25
    s_and_b32 s36, s2, 7
    s_lshr_b32 s37, s2, 3
    s_add_u32 m0, s34, 126976
    s_add_u32 s33, s32, 98304
    buffer_load_dwordx4 v249, s[92:95], s33 offen offset:1024 lds
    s_lshr_b32 s38, s36, 1
    s_lshl_b32 s38, s38, 3
    s_lshr_b32 s57, s37, 2
    s_add_u32 s18, s38, s57
    s_and_b32 s38, s36, 1
    s_lshl_b32 s38, s38, 2
    s_and_b32 s57, s37, 3
    s_add_u32 s19, s38, s57
    s_and_b32 s36, s2, 7
    s_lshr_b32 s37, s2, 3
    buffer_load_dwordx4 v249, s[92:95], s33 offen offset:2048 lds
    s_lshr_b32 s38, s36, 1
    s_lshl_b32 s38, s38, 2
    s_lshr_b32 s57, s37, 3
    s_add_u32 s20, s38, s57
    s_and_b32 s38, s36, 1
    s_lshl_b32 s38, s38, 3
    s_and_b32 s57, s37, 7
    s_add_u32 s21, s38, s57
    s_and_b32 s36, s2, 7
    s_lshr_b32 s37, s2, 3
    buffer_load_dwordx4 v249, s[92:95], s33 offen offset:0 lds
    s_lshr_b32 s38, s36, 0
    s_lshl_b32 s38, s38, 2
    s_lshr_b32 s57, s37, 3
    s_add_u32 s22, s38, s57
    s_and_b32 s38, s36, 0
    s_lshl_b32 s38, s38, 3
    s_and_b32 s57, s37, 7
    s_add_u32 s23, s38, s57
    s_and_b32 s36, s2, 7
    s_lshr_b32 s37, s2, 3
    s_lshr_b32 s38, s36, 1
    s_add_u32 m0, s34, 139264
    s_add_u32 s33, s32, 196608
    buffer_load_dwordx4 v249, s[92:95], s33 offen offset:1024 lds
    s_lshl_b32 s38, s38, 3
    s_lshr_b32 s57, s37, 2
    s_add_u32 s100, s38, s57
    s_and_b32 s38, s36, 1
    s_lshl_b32 s38, s38, 2
    s_and_b32 s57, s37, 3
    s_add_u32 s101, s38, s57
    s_mov_b32 s99, 0x00020000
    s_mov_b32 s51, 0
    s_mov_b32 s53, 0
    s_mov_b32 s54, 0
    s_cmp_lt_u32 s52, 48
    s_cbranch_scc1 L_sl_qkv
    s_cmp_lt_u32 s52, 64
    s_cbranch_scc1 L_sl_wo
    s_cmp_lt_u32 s52, 176
    s_cbranch_scc1 L_sl_gu
    s_mov_b32 s96, s84
    s_mov_b32 s97, s85
    s_mov_b32 s98, 1835008
    s_cmp_ge_u32 s52, 240
    s_cselect_b32 s36, 16, 0
    s_sub_u32 s36, s52, s36
    s_sub_u32 s36, s36, 176
    s_lshr_b32 s37, s36, 4
    s_and_b32 s36, s36, 15
    s_mov_b32 s40, 1024
    s_mul_i32 s41, s37, 458752
    s_mul_i32 s38, s3, 114688
    s_add_u32 s41, s41, s38
    s_lshl_b32 s38, s36, 6
    s_add_u32 s41, s41, s38
    s_mul_i32 s43, s36, 114688
    s_mul_i32 s38, s37, 28672
    s_add_u32 s43, s43, s38
    s_mul_i32 s38, s3, 7168
    s_add_u32 s43, s43, s38
    s_add_u32 s43, s43, 0x580000
    s_mov_b32 s44, 1024
    s_mov_b32 s45, 2048
    s_mov_b32 s46, 256
    s_mov_b32 s47, 512
    s_mov_b32 s48, 16
    s_mov_b32 s49, 32
    s_mov_b32 s50, 8
    s_mov_b32 s51, 16384
    s_mov_b32 s53, 1024
    s_lshr_b32 s36, s36, 1
    s_lshl_b32 s36, s36, 8
    s_add_u32 s64, s36, 0x237b800
    s_cmp_ge_u32 s52, 240
    s_cselect_b32 s64, 0x237c800, s64
    s_mov_b32 s65, s64
    s_branch L_sl_go
L_sl_gu:
    s_cmp_lt_u32 s52, 120
    s_cselect_b32 s96, s80, s82
    s_cselect_b32 s97, s81, s83
    s_cselect_b32 s36, 64, 120
    s_cselect_b32 s37, 0, 256
    s_mov_b32 s98, 1835008
    s_sub_u32 s36, s52, s36
    s_mov_b32 s40, 3584
    s_mul_i32 s41, s3, 458752
    s_lshl_b32 s38, s36, 6
    s_add_u32 s41, s41, s38
    s_lshl_b32 s43, s36, 16
    s_add_u32 s43, s43, s37
    s_lshl_b32 s38, s3, 13
    s_add_u32 s43, s43, s38
    s_add_u32 s43, s43, 0x200000
    s_mov_b32 s44, 1024
    s_mov_b32 s45, 2048
    s_mov_b32 s46, 32768
    s_mov_b32 s47, 512
    s_mov_b32 s48, 32
    s_mov_b32 s49, 16
    s_mov_b32 s50, 8
    s_mov_b32 s54, 2
    s_lshl_b32 s38, s36, 1
    s_add_u32 s38, s38, 0
    s_mul_i32 s39, s38, 9363
    s_lshr_b32 s39, s39, 16
    s_lshl_b32 s64, s39, 8
    s_add_u32 s64, s64, 0x237a800
    s_lshl_b32 s55, s39, 11
    s_mul_i32 s39, s39, 7
    s_sub_u32 s38, s38, s39
    s_lshr_b32 s39, s38, 1
    s_lshl_b32 s39, s39, 9
    s_add_u32 s55, s55, s39
    s_and_b32 s38, s38, 1
    s_lshl_b32 s38, s38, 3
    s_add_u32 s55, s55, s38
    s_add_u32 s55, s55, s37
    s_add_u32 s55, s55, 0x760000
    s_lshl_b32 s38, s36, 1
    s_add_u32 s38, s38, 1
    s_mul_i32 s39, s38, 9363
    s_lshr_b32 s39, s39, 16
    s_lshl_b32 s65, s39, 8
    s_add_u32 s65, s65, 0x237a800
    s_lshl_b32 s56, s39, 11
    s_mul_i32 s39, s39, 7
    s_sub_u32 s38, s38, s39
    s_lshr_b32 s39, s38, 1
    s_lshl_b32 s39, s39, 9
    s_add_u32 s56, s56, s39
    s_and_b32 s38, s38, 1
    s_lshl_b32 s38, s38, 3
    s_add_u32 s56, s56, s38
    s_add_u32 s56, s56, s37
    s_add_u32 s56, s56, 0x760000
    s_branch L_sl_go
L_sl_wo:
    s_mov_b32 s96, s76
    s_mov_b32 s97, s77
    s_mov_b32 s98, 524288
    s_sub_u32 s36, s52, 48
    s_mov_b32 s40, 1024
    s_lshl_b32 s41, s3, 17
    s_lshl_b32 s38, s36, 6
    s_add_u32 s41, s41, s38
    s_lshr_b32 s37, s36, 1
    s_lshl_b32 s43, s37, 16
    s_and_b32 s38, s36, 1
    s_lshl_b32 s38, s38, 11
    s_add_u32 s43, s43, s38
    s_lshl_b32 s38, s3, 14
    s_add_u32 s43, s43, s38
    s_add_u32 s43, s43, 0x180000
    s_mov_b32 s44, 512
    s_mov_b32 s45, 4096
    s_mov_b32 s46, 1024
    s_mov_b32 s47, 256
    s_mov_b32 s48, 8
    s_mov_b32 s49, 16
    s_mov_b32 s50, 32
    s_lshl_b32 s37, s37, 8
    s_add_u32 s64, s37, 0x237a000
    s_mov_b32 s65, s64
    s_branch L_sl_go
L_sl_qkv:
    s_mov_b32 s96, s74
    s_mov_b32 s97, s75
    s_mov_b32 s98, 1572864
    s_mov_b32 s40, 3072
    s_mul_i32 s41, s3, 393216
    s_lshl_b32 s38, s52, 6
    s_add_u32 s41, s41, s38
    s_and_b32 s36, s52, 15
    s_mul_i32 s43, s36, 98304
    s_lshr_b32 s38, s52, 4
    s_lshl_b32 s38, s38, 10
    s_add_u32 s43, s43, s38
    s_mul_i32 s38, s3, 12288
    s_add_u32 s43, s43, s38
    s_mov_b32 s44, 512
    s_mov_b32 s45, 3072
    s_mov_b32 s46, 49152
    s_mov_b32 s47, 256
    s_mov_b32 s48, 32
    s_mov_b32 s49, 8
    s_mov_b32 s50, 16
    s_mov_b32 s54, 1
    s_lshl_b32 s55, s52, 7
    s_add_u32 s55, s55, 0x740000
    s_add_u32 s56, s55, 64
    s_lshr_b32 s36, s36, 1
    s_lshl_b32 s36, s36, 8
    s_add_u32 s64, s36, 0x237c000
    s_mov_b32 s65, s64
L_sl_go:
    s_lshl_b32 s36, s2, 2
    s_add_u32 s36, s36, s3
    s_lshl_b32 s36, s36, 9
    s_add_u32 s36, s36, 0x2400000
    s_add_u32 s37, s36, 256
    s_cmp_eq_u32 s3, 0
    s_cselect_b32 s38, s54, 0
    s_cmp_lg_u32 s38, 0
    s_cselect_b32 s55, s55, s36
    s_cselect_b32 s56, s56, s37
    s_lshl_b32 s42, s40, 4
    s_sub_u32 s51, s42, s51
    s_lshl_b32 s66, s3, 13
    s_add_u32 s66, s66, 81920
    v_lshrrev_b32 v135, 2, v0
    v_mul_u32_u24 v251, s40, v135
    buffer_load_dwordx4 v249, s[92:95], s33 offen offset:2048 lds
    v_and_b32 v135, 3, v0
    v_lshl_add_u32 v251, v135, 4, v251
    v_lshrrev_b32 v136, 5, v0
    v_and_b32 v137, 1, v133
    v_lshl_add_u32 v135, v136, 3, v134
    v_lshlrev_b32 v252, 6, v135
    v_mad_u32_u24 v252, v137, s48, v252
    v_and_b32 v135, 1, v0
    v_mad_u32_u24 v252, v135, s49, v252
    v_bfe_u32 v135, v0, 1, 1
    buffer_load_dwordx4 v249, s[92:95], s33 offen offset:0 lds
    v_mad_u32_u24 v252, v135, s50, v252
    v_add_u32 v252, s66, v252
    v_lshlrev_b32 v253, 4, v132
    v_mad_u32_u24 v253, v137, s46, v253
    v_mad_u32_u24 v253, v136, s47, v253
    v_xor_b32 v135, v0, v133
    v_and_b32 v135, 1, v135
    v_cmp_eq_u32 vcc, 0, v135
    s_nop 1
    v_cndmask_b32 v244, 0, v188, vcc
    v_mov_b32 v245, v244
    v_mov_b32 v246, v244
    v_mov_b32 v247, v244
    v_mov_b32 v218, s64
    v_writelane_b32 v218, s65, 1
    s_add_u32 m0, s34, 151552
    s_add_u32 s33, s32, 294912
    buffer_load_dwordx4 v249, s[92:95], s33 offen offset:1024 lds
    s_cmp_eq_u32 s54, 2
    s_cselect_b32 s38, 16, 4
    v_mul_u32_u24 v154, s38, v132
    v_mov_b32 v135, s55
    v_mov_b32 v136, s56
    v_cmp_eq_u32 vcc, 0, v137
    s_nop 1
    v_cndmask_b32 v135, v136, v135, vcc
    v_add_u32 v154, v154, v135
    v_and_b32 v135, 1, v0
    v_lshlrev_b32 v155, 6, v135
    v_lshl_add_u32 v155, v133, 4, v155
    s_lshl_b32 s38, s3, 7
    s_add_u32 s38, s38, 82944
    v_add_u32 v155, s38, v155
    v_and_b32 v135, 31, v0
    v_lshlrev_b32 v156, 2, v135
    v_add_u32 v156, 82944, v156
    buffer_load_dwordx4 v249, s[92:95], s33 offen offset:2048 lds
    s_lshr_b32 s38, s19, 0
    s_lshl_b32 s38, s38, 8
    s_add_u32 s38, s38, 0x237a000
    v_mov_b32 v254, s38
    v_mov_b32 v255, 4
    s_lshr_b32 s38, s21, 0
    s_lshl_b32 s38, s38, 8
    s_add_u32 s38, s38, 0x237a800
    v_writelane_b32 v254, s38, 1
    v_writelane_b32 v255, 14, 1
    buffer_load_dwordx4 v249, s[92:95], s33 offen offset:0 lds
    s_lshr_b32 s38, s23, 0
    s_lshl_b32 s38, s38, 8
    s_add_u32 s38, s38, 0x237b800
    v_writelane_b32 v254, s38, 2
    v_writelane_b32 v255, 16, 2
    s_lshr_b32 s38, s101, 0
    s_lshl_b32 s38, s38, 8
    s_add_u32 s38, s38, 0x237c000
    v_writelane_b32 v254, s38, 3
    v_writelane_b32 v255, 12, 3
    s_add_u32 m0, s35, 20224
    s_nop 0
    buffer_load_dwordx4 v248, s[60:63], s31 offen offset:256 lds
    v_and_b32 v3, 15, v0
    v_lshrrev_b32 v4, 4, v0
    v_lshlrev_b32 v7, 9, v4
    v_lshl_add_u32 v7, v3, 4, v7
    v_add_u32 v6, 65536, v1
    v_lshlrev_b32 v8, 3, v3
    v_add_u32 v8, 81920, v8
    v_lshlrev_b32 v9, 5, v4
    s_add_u32 m0, s35, 24320
    s_nop 0
    buffer_load_dwordx4 v248, s[60:63], s30 offen offset:256 lds
    v_add_u32 v9, 81920, v9
    v_lshrrev_b32 v134, 3, v0
    v_lshlrev_b32 v5, 10, v134
    v_bfe_u32 v134, v0, 4, 1
    v_lshlrev_b32 v134, 2, v134
    v_and_b32 v135, 7, v0
    v_xor_b32 v134, v134, v135
    v_lshl_add_u32 v5, v134, 4, v5
    s_add_u32 m0, s35, 28416
    s_nop 0
    buffer_load_dwordx4 v248, s[60:63], s68 offen offset:256 lds
    v_and_b32 v134, 1, v3
    v_lshl_add_u32 v135, v4, 2, v134
    v_add_u32 v136, 2, v135
    v_add_u32 v137, 2, v3
    v_mov_b32 v138, 0xf149f2ca
    v_mov_b32 v139, 0
    v_cmp_ge_u32 vcc, v135, v137
    s_nop 1
    v_cndmask_b32 v10, v138, v139, vcc
    s_add_u32 m0, s35, 32512
    s_nop 0
    buffer_load_dwordx4 v248, s[60:63], s69 offen offset:256 lds
    v_cmp_ge_u32 vcc, v136, v137
    s_nop 1
    v_cndmask_b32 v11, v138, v139, vcc
    v_cmp_le_u32 vcc, v135, v3
    s_nop 1
    v_cndmask_b32 v12, v138, v139, vcc
    v_cmp_le_u32 vcc, v136, v3
    s_nop 1
    v_cndmask_b32 v13, v138, v139, vcc
    s_cmp_eq_u32 s16, 0
    s_cselect_b64 s[58:59], -1, 0
    v_cndmask_b32 v14, v10, v138, s[58:59]
    s_add_u32 m0, s35, 36608
    s_nop 0
    buffer_load_dwordx4 v248, s[60:63], s27 offen offset:256 lds
    v_cndmask_b32 v15, v11, v138, s[58:59]
    v_mov_b32 v135, 0x0c0c0100
    v_mov_b32 v136, 0x01000c0c
    v_cndmask_b32 v16, v135, v136, s[28:29]
    v_mov_b32 v135, 0x0c0c0302
    v_mov_b32 v136, 0x03020c0c
    v_cndmask_b32 v17, v135, v136, s[28:29]
    s_waitcnt vmcnt(14)
    s_barrier
    s_cmp_lt_u32 s52, 240
    s_cbranch_scc1 L_zf_skip
    s_cmp_lg_u32 s3, 0
    s_cbranch_scc1 L_zf_skip
    s_sub_u32 s36, s52, 240
    s_lshl_b32 s36, s36, 2
    v_mov_b32 v135, 1
    s_mov_b64 exec, 1
    buffer_store_dword v135, off, s[88:91], s36 offset:0 sc1
    s_mov_b64 exec, -1
L_zf_skip:
    ds_read_b64_tr_b16 v[164:165], v250 offset:1024
    ds_read_b64_tr_b16 v[166:167], v250 offset:1536
    ds_read_b64_tr_b16 v[168:169], v250 offset:2048
    ds_read_b64_tr_b16 v[170:171], v250 offset:2560
    ds_read_b64_tr_b16 v[160:161], v250 offset:0
    ds_read_b64_tr_b16 v[162:163], v250 offset:512
    ds_read_b128 v[84:87], v140 offset:0
    ds_read_b128 v[88:91], v140 offset:4096
    ds_read_b128 v[92:95], v140 offset:8192
    ds_read_b128 v[96:99], v140 offset:12288
    s_waitcnt vmcnt(11)
    s_waitcnt lgkmcnt(4)
    s_barrier
    s_waitcnt lgkmcnt(3)
    v_mfma_f32_16x16x32_bf16 v[28:31], v[164:167], v[84:87], 0
    ds_read_b64_tr_b16 v[176:177], v250 offset:13312
    v_mfma_f32_16x16x32_bf16 v[32:35], v[84:87], v[168:171], 0
    ds_read_b128 v[208:211], v140 offset:16384
    s_waitcnt lgkmcnt(4)
    v_mfma_f32_16x16x32_bf16 v[36:39], v[164:167], v[88:91], 0
    ds_read_b64_tr_b16 v[178:179], v250 offset:13824
    s_add_u32 m0, s34, 114688
    s_add_u32 s33, s32, 393216
    buffer_load_dwordx4 v249, s[92:95], s33 offen offset:1024 lds
    v_mfma_f32_16x16x32_bf16 v[40:43], v[88:91], v[168:171], 0
    ds_read_b128 v[212:215], v141 offset:0
    v_mfma_f32_16x16x32_bf16 v[44:47], v[160:163], v[88:91], 0
    ds_read_b64_tr_b16 v[180:181], v250 offset:14336
    s_waitcnt lgkmcnt(6)
    v_mfma_f32_16x16x32_bf16 v[48:51], v[164:167], v[92:95], 0
    ds_read_b64_tr_b16 v[182:183], v250 offset:14848
    v_mfma_f32_16x16x32_bf16 v[52:55], v[92:95], v[168:171], 0
    ds_read_b128 v[84:87], v141 offset:4096
    buffer_load_dwordx4 v249, s[92:95], s33 offen offset:2048 lds
    v_mfma_f32_16x16x32_bf16 v[56:59], v[160:163], v[92:95], 0
    ds_read_b64_tr_b16 v[172:173], v250 offset:12288
    s_waitcnt lgkmcnt(8)
    v_mfma_f32_16x16x32_bf16 v[60:63], v[164:167], v[96:99], 0
    ds_read_b64_tr_b16 v[174:175], v250 offset:12800
    v_mfma_f32_16x16x32_bf16 v[64:67], v[96:99], v[168:171], 0
    ds_read_b128 v[88:91], v141 offset:8192
    buffer_load_dwordx4 v249, s[92:95], s33 offen offset:0 lds
    v_mfma_f32_16x16x32_bf16 v[68:71], v[160:163], v[96:99], 0
    s_waitcnt lgkmcnt(8)
    v_mfma_f32_16x16x32_bf16 v[72:75], v[164:167], v[208:211], 0
    v_mfma_f32_16x16x32_bf16 v[76:79], v[208:211], v[168:171], 0
    ds_read_b128 v[92:95], v141 offset:12288
    v_mfma_f32_16x16x32_bf16 v[80:83], v[160:163], v[208:211], 0
    s_add_u32 m0, s66, 0
    s_nop 0
    buffer_load_dwordx4 v251, s[96:99], s41 offen lds
    s_add_u32 s41, s41, s42
    v_mfma_f32_16x16x32_bf16 v[22:25], v[164:167], v[188:191], 0
    v_mfma_f32_16x16x32_bf16 v[184:187], v[188:191], v[168:171], 0
    v_mfma_f32_16x16x32_bf16 v[18:21], v[160:163], v[188:191], 0
L_pad3328:
    s_cbranch_execz L_ret_top
    s_waitcnt vmcnt(12)
    s_waitcnt lgkmcnt(2)
    s_barrier
    v_mfma_f32_16x16x32_bf16 v[28:31], v[176:179], v[212:215], v[28:31]
    ds_read_b64_tr_b16 v[164:165], v250 offset:25600
    v_mfma_f32_16x16x32_bf16 v[32:35], v[212:215], v[180:183], v[32:35]
    ds_read_b128 v[96:99], v141 offset:16384
    s_add_u32 m0, s34, 126976
    s_add_u32 s33, s32, 491520
    buffer_load_dwordx4 v249, s[92:95], s33 offen offset:1024 lds
    v_mfma_f32_16x16x32_bf16 v[36:39], v[176:179], v[84:87], v[36:39]
    ds_read_b64_tr_b16 v[166:167], v250 offset:26112
    v_mfma_f32_16x16x32_bf16 v[40:43], v[84:87], v[180:183], v[40:43]
    ds_read_b128 v[208:211], v142 offset:0
    v_mfma_f32_16x16x32_bf16 v[44:47], v[172:175], v[84:87], v[44:47]
    ds_read_b64_tr_b16 v[168:169], v250 offset:26624
    buffer_load_dwordx4 v249, s[92:95], s33 offen offset:2048 lds
    s_waitcnt lgkmcnt(6)
    v_mfma_f32_16x16x32_bf16 v[48:51], v[176:179], v[88:91], v[48:51]
    ds_read_b64_tr_b16 v[170:171], v250 offset:27136
    v_mfma_f32_16x16x32_bf16 v[52:55], v[88:91], v[180:183], v[52:55]
    ds_read_b128 v[212:215], v142 offset:4096
    buffer_load_dwordx4 v249, s[92:95], s33 offen offset:0 lds
    v_mfma_f32_16x16x32_bf16 v[56:59], v[172:175], v[88:91], v[56:59]
    ds_read_b64_tr_b16 v[160:161], v250 offset:24576
    s_waitcnt lgkmcnt(8)
    v_mfma_f32_16x16x32_bf16 v[60:63], v[176:179], v[92:95], v[60:63]
    ds_read_b64_tr_b16 v[162:163], v250 offset:25088
    v_mfma_f32_16x16x32_bf16 v[64:67], v[92:95], v[180:183], v[64:67]
    ds_read_b128 v[84:87], v142 offset:8192
    s_add_u32 m0, s35, 40448
    s_nop 0
    buffer_load_dwordx4 v248, s[60:63], s31 offen offset:512 lds
    v_mfma_f32_16x16x32_bf16 v[68:71], v[172:175], v[92:95], v[68:71]
    s_waitcnt lgkmcnt(8)
    v_mfma_f32_16x16x32_bf16 v[72:75], v[176:179], v[96:99], v[72:75]
    s_add_u32 m0, s35, 44544
    s_nop 0
    buffer_load_dwordx4 v248, s[60:63], s30 offen offset:512 lds
    v_mfma_f32_16x16x32_bf16 v[76:79], v[96:99], v[180:183], v[76:79]
    ds_read_b128 v[88:91], v142 offset:12288
    v_mfma_f32_16x16x32_bf16 v[80:83], v[172:175], v[96:99], v[80:83]
    v_mfma_f32_16x16x32_bf16 v[22:25], v[176:179], v[188:191], v[22:25]
    s_add_u32 m0, s66, 1024
    s_nop 0
    buffer_load_dwordx4 v251, s[96:99], s41 offen lds
    s_add_u32 s41, s41, s42
    v_mfma_f32_16x16x32_bf16 v[184:187], v[188:191], v[180:183], v[184:187]
    v_mfma_f32_16x16x32_bf16 v[18:21], v[172:175], v[188:191], v[18:21]
    s_waitcnt vmcnt(15)
    s_waitcnt lgkmcnt(2)
    s_barrier
    v_mfma_f32_16x16x32_bf16 v[28:31], v[164:167], v[208:211], v[28:31]
    ds_read_b64_tr_b16 v[176:177], v250 offset:37888
    v_mfma_f32_16x16x32_bf16 v[32:35], v[208:211], v[168:171], v[32:35]
    ds_read_b128 v[92:95], v142 offset:16384
    s_add_u32 m0, s34, 139264
    s_add_u32 s33, s32, 589824
    buffer_load_dwordx4 v249, s[92:95], s33 offen offset:1024 lds
    v_mfma_f32_16x16x32_bf16 v[36:39], v[164:167], v[212:215], v[36:39]
    ds_read_b64_tr_b16 v[178:179], v250 offset:38400
    v_mfma_f32_16x16x32_bf16 v[40:43], v[212:215], v[168:171], v[40:43]
    ds_read_b128 v[96:99], v148 offset:0
    v_mfma_f32_16x16x32_bf16 v[44:47], v[160:163], v[212:215], v[44:47]
    ds_read_b64_tr_b16 v[180:181], v250 offset:38912
    s_waitcnt lgkmcnt(6)
    v_mfma_f32_16x16x32_bf16 v[48:51], v[164:167], v[84:87], v[48:51]
    ds_read_b64_tr_b16 v[182:183], v250 offset:39424
    buffer_load_dwordx4 v249, s[92:95], s33 offen offset:2048 lds
    v_mfma_f32_16x16x32_bf16 v[52:55], v[84:87], v[168:171], v[52:55]
    ds_read_b128 v[208:211], v149 offset:0
    v_mfma_f32_16x16x32_bf16 v[56:59], v[160:163], v[84:87], v[56:59]
    ds_read_b64_tr_b16 v[172:173], v250 offset:36864
    s_waitcnt lgkmcnt(8)
    v_mfma_f32_16x16x32_bf16 v[60:63], v[164:167], v[88:91], v[60:63]
    ds_read_b64_tr_b16 v[174:175], v250 offset:37376
    buffer_load_dwordx4 v249, s[92:95], s33 offen offset:0 lds
    v_mfma_f32_16x16x32_bf16 v[64:67], v[88:91], v[168:171], v[64:67]
    ds_read_b128 v[212:215], v143 offset:0
    v_mfma_f32_16x16x32_bf16 v[68:71], v[160:163], v[88:91], v[68:71]
    s_waitcnt lgkmcnt(8)
    v_mfma_f32_16x16x32_bf16 v[72:75], v[164:167], v[92:95], v[72:75]
    s_add_u32 m0, s35, 48640
    s_nop 0
    buffer_load_dwordx4 v248, s[60:63], s68 offen offset:512 lds
    v_mfma_f32_16x16x32_bf16 v[76:79], v[92:95], v[168:171], v[76:79]
    ds_read_b128 v[84:87], v143 offset:4096
    v_mfma_f32_16x16x32_bf16 v[80:83], v[160:163], v[92:95], v[80:83]
    v_mfma_f32_16x16x32_bf16 v[22:25], v[164:167], v[188:191], v[22:25]
    s_add_u32 m0, s35, 52736
    s_nop 0
    buffer_load_dwordx4 v248, s[60:63], s69 offen offset:512 lds
    v_mfma_f32_16x16x32_bf16 v[184:187], v[188:191], v[168:171], v[184:187]
    v_mfma_f32_16x16x32_bf16 v[18:21], v[160:163], v[188:191], v[18:21]
    s_waitcnt lgkmcnt(7)
    v_mfma_f32_16x16x32_bf16 v[192:195], v[188:191], v[96:99], 0
    v_mfma_f32_16x16x32_bf16 v[196:199], v[96:99], v[96:99], 0
    ds_read_b128 v[88:91], v143 offset:8192
    s_add_u32 m0, s66, 2048
    s_nop 0
    buffer_load_dwordx4 v251, s[96:99], s41 offen lds
    s_add_u32 s41, s41, s42
    s_waitcnt lgkmcnt(5)
    v_mfma_f32_16x16x32_bf16 v[192:195], v[188:191], v[208:211], v[192:195]
    v_mfma_f32_16x16x32_bf16 v[196:199], v[208:211], v[208:211], v[196:199]
    ds_read_b128 v[92:95], v143 offset:12288
    s_waitcnt vmcnt(13)
    s_waitcnt lgkmcnt(4)
    s_barrier
    s_waitcnt lgkmcnt(3)
    v_mfma_f32_16x16x32_bf16 v[28:31], v[176:179], v[212:215], v[28:31]
    ds_read_b64_tr_b16 v[164:165], v250 offset:1024
    v_mfma_f32_16x16x32_bf16 v[32:35], v[212:215], v[180:183], v[32:35]
    ds_read_b128 v[96:99], v143 offset:16384
    s_add_u32 m0, s34, 151552
    s_add_u32 s33, s32, 688128
    buffer_load_dwordx4 v249, s[92:95], s33 offen offset:1024 lds
    s_waitcnt lgkmcnt(4)
    v_mfma_f32_16x16x32_bf16 v[36:39], v[176:179], v[84:87], v[36:39]
    ds_read_b64_tr_b16 v[166:167], v250 offset:1536
    v_mfma_f32_16x16x32_bf16 v[40:43], v[84:87], v[180:183], v[40:43]
    ds_read_b128 v[208:211], v150 offset:0
    v_mfma_f32_16x16x32_bf16 v[44:47], v[172:175], v[84:87], v[44:47]
    ds_read_b64_tr_b16 v[168:169], v250 offset:2048
    s_waitcnt lgkmcnt(6)
    v_mfma_f32_16x16x32_bf16 v[48:51], v[176:179], v[88:91], v[48:51]
    ds_read_b64_tr_b16 v[170:171], v250 offset:2560
    buffer_load_dwordx4 v249, s[92:95], s33 offen offset:2048 lds
    v_mfma_f32_16x16x32_bf16 v[52:55], v[88:91], v[180:183], v[52:55]
    ds_read_b128 v[212:215], v151 offset:0
    v_mfma_f32_16x16x32_bf16 v[56:59], v[172:175], v[88:91], v[56:59]
    ds_read_b64_tr_b16 v[160:161], v250 offset:0
    s_waitcnt lgkmcnt(8)
    v_mfma_f32_16x16x32_bf16 v[60:63], v[176:179], v[92:95], v[60:63]
    ds_read_b64_tr_b16 v[162:163], v250 offset:512
    buffer_load_dwordx4 v249, s[92:95], s33 offen offset:0 lds
    v_mfma_f32_16x16x32_bf16 v[64:67], v[92:95], v[180:183], v[64:67]
    ds_read_b128 v[84:87], v140 offset:20480
    v_mfma_f32_16x16x32_bf16 v[68:71], v[172:175], v[92:95], v[68:71]
    s_waitcnt lgkmcnt(8)
    v_mfma_f32_16x16x32_bf16 v[72:75], v[176:179], v[96:99], v[72:75]
    s_add_u32 m0, s35, 60672
    s_nop 0
    buffer_load_dwordx4 v248, s[60:63], s31 offen offset:768 lds
    v_mfma_f32_16x16x32_bf16 v[76:79], v[96:99], v[180:183], v[76:79]
    ds_read_b128 v[88:91], v140 offset:24576
    v_mfma_f32_16x16x32_bf16 v[80:83], v[172:175], v[96:99], v[80:83]
    v_mfma_f32_16x16x32_bf16 v[22:25], v[176:179], v[188:191], v[22:25]
    s_add_u32 m0, s35, 56832
    s_nop 0
    buffer_load_dwordx4 v248, s[60:63], s27 offen offset:512 lds
    v_mfma_f32_16x16x32_bf16 v[184:187], v[188:191], v[180:183], v[184:187]
    v_mfma_f32_16x16x32_bf16 v[18:21], v[172:175], v[188:191], v[18:21]
    s_waitcnt lgkmcnt(7)
    v_mfma_f32_16x16x32_bf16 v[192:195], v[188:191], v[208:211], v[192:195]
    v_mfma_f32_16x16x32_bf16 v[196:199], v[208:211], v[208:211], v[196:199]
    ds_read_b128 v[92:95], v140 offset:28672
    s_add_u32 m0, s66, 3072
    s_nop 0
    buffer_load_dwordx4 v251, s[96:99], s41 offen lds
    s_add_u32 s41, s41, s42
    s_waitcnt lgkmcnt(5)
    v_mfma_f32_16x16x32_bf16 v[192:195], v[188:191], v[212:215], v[192:195]
    v_mfma_f32_16x16x32_bf16 v[196:199], v[212:215], v[212:215], v[196:199]
    ds_read_b128 v[96:99], v140 offset:32768
    s_waitcnt vmcnt(15)
    s_waitcnt lgkmcnt(4)
    s_barrier
    s_waitcnt lgkmcnt(3)
    v_mfma_f32_16x16x32_bf16 v[28:31], v[164:167], v[84:87], v[28:31]
    ds_read_b64_tr_b16 v[176:177], v250 offset:13312
    v_mfma_f32_16x16x32_bf16 v[32:35], v[84:87], v[168:171], v[32:35]
    ds_read_b128 v[208:211], v140 offset:36864
    s_add_u32 m0, s34, 114688
    s_add_u32 s33, s32, 786432
    buffer_load_dwordx4 v249, s[92:95], s33 offen offset:1024 lds
    s_waitcnt lgkmcnt(4)
    v_mfma_f32_16x16x32_bf16 v[36:39], v[164:167], v[88:91], v[36:39]
    ds_read_b64_tr_b16 v[178:179], v250 offset:13824
    v_mfma_f32_16x16x32_bf16 v[40:43], v[88:91], v[168:171], v[40:43]
    ds_read_b128 v[212:215], v148 offset:20480
    v_mfma_f32_16x16x32_bf16 v[44:47], v[160:163], v[88:91], v[44:47]
    ds_read_b64_tr_b16 v[180:181], v250 offset:14336
    buffer_load_dwordx4 v249, s[92:95], s33 offen offset:2048 lds
    s_waitcnt lgkmcnt(6)
    v_mfma_f32_16x16x32_bf16 v[48:51], v[164:167], v[92:95], v[48:51]
    ds_read_b64_tr_b16 v[182:183], v250 offset:14848
    ds_read_b64_tr_b16 v[224:225], v252 offset:0
    v_mfma_f32_16x16x32_bf16 v[52:55], v[92:95], v[168:171], v[52:55]
    ds_read_b128 v[84:87], v149 offset:20480
    v_mfma_f32_16x16x32_bf16 v[56:59], v[160:163], v[92:95], v[56:59]
    ds_read_b64_tr_b16 v[172:173], v250 offset:12288
    buffer_load_dwordx4 v249, s[92:95], s33 offen offset:0 lds
    s_waitcnt lgkmcnt(9)
    v_mfma_f32_16x16x32_bf16 v[60:63], v[164:167], v[96:99], v[60:63]
    ds_read_b64_tr_b16 v[174:175], v250 offset:12800
    v_mfma_f32_16x16x32_bf16 v[64:67], v[96:99], v[168:171], v[64:67]
    ds_read_b128 v[88:91], v141 offset:20480
    s_add_u32 m0, s35, 64768
    s_nop 0
    buffer_load_dwordx4 v248, s[60:63], s30 offen offset:768 lds
    v_mfma_f32_16x16x32_bf16 v[68:71], v[160:163], v[96:99], v[68:71]
    s_waitcnt lgkmcnt(9)
    v_mfma_f32_16x16x32_bf16 v[72:75], v[164:167], v[208:211], v[72:75]
    ds_read_b64_tr_b16 v[226:227], v252 offset:256
    v_mfma_f32_16x16x32_bf16 v[76:79], v[208:211], v[168:171], v[76:79]
    ds_read_b128 v[92:95], v141 offset:24576
    s_add_u32 m0, s35, 68864
    s_nop 0
    buffer_load_dwordx4 v248, s[60:63], s68 offen offset:768 lds
    v_mfma_f32_16x16x32_bf16 v[80:83], v[160:163], v[208:211], v[80:83]
    v_mfma_f32_16x16x32_bf16 v[22:25], v[164:167], v[188:191], v[22:25]
    v_mfma_f32_16x16x32_bf16 v[184:187], v[188:191], v[168:171], v[184:187]
    s_add_u32 m0, s66, 4096
    s_nop 0
    buffer_load_dwordx4 v251, s[96:99], s41 offen lds
    s_add_u32 s41, s41, s42
    v_mfma_f32_16x16x32_bf16 v[18:21], v[160:163], v[188:191], v[18:21]
    s_waitcnt lgkmcnt(9)
    v_mfma_f32_16x16x32_bf16 v[192:195], v[188:191], v[212:215], v[192:195]
    s_waitcnt lgkmcnt(1)
    buffer_store_dwordx4 v[224:227], v253, s[8:11], s43 offen sc1
    v_mfma_f32_16x16x32_bf16 v[196:199], v[212:215], v[212:215], v[196:199]
    ds_read_b128 v[96:99], v141 offset:28672
    v_mfma_f32_16x16x32_bf16 v[192:195], v[188:191], v[84:87], v[192:195]
    v_mfma_f32_16x16x32_bf16 v[240:243], v[224:227], v[244:247], 0
    v_mfma_f32_16x16x32_bf16 v[196:199], v[84:87], v[84:87], v[196:199]
    ds_read_b128 v[208:211], v141 offset:32768
    s_waitcnt vmcnt(16)
    s_barrier
    v_mfma_f32_16x16x32_bf16 v[28:31], v[176:179], v[88:91], v[28:31]
    ds_read_b64_tr_b16 v[164:165], v250 offset:25600
    v_mfma_f32_16x16x32_bf16 v[32:35], v[88:91], v[180:183], v[32:35]
    ds_read_b128 v[212:215], v141 offset:36864
    s_add_u32 m0, s34, 126976
    s_add_u32 s33, s32, 884736
    buffer_load_dwordx4 v249, s[92:95], s33 offen offset:1024 lds
    s_waitcnt lgkmcnt(4)
    v_mfma_f32_16x16x32_bf16 v[36:39], v[176:179], v[92:95], v[36:39]
    ds_read_b64_tr_b16 v[166:167], v250 offset:26112
    v_mfma_f32_16x16x32_bf16 v[40:43], v[92:95], v[180:183], v[40:43]
    ds_read_b128 v[84:87], v150 offset:20480
    v_mfma_f32_16x16x32_bf16 v[44:47], v[172:175], v[92:95], v[44:47]
    ds_read_b64_tr_b16 v[168:169], v250 offset:26624
    buffer_load_dwordx4 v249, s[92:95], s33 offen offset:2048 lds
    s_waitcnt lgkmcnt(6)
    v_mfma_f32_16x16x32_bf16 v[48:51], v[176:179], v[96:99], v[48:51]
    ds_read_b64_tr_b16 v[170:171], v250 offset:27136
    ds_read_b64_tr_b16 v[228:229], v252 offset:1024
    v_mfma_f32_16x16x32_bf16 v[52:55], v[96:99], v[180:183], v[52:55]
    ds_read_b128 v[88:91], v151 offset:20480
    v_mfma_f32_16x16x32_bf16 v[56:59], v[172:175], v[96:99], v[56:59]
    ds_read_b64_tr_b16 v[160:161], v250 offset:24576
    buffer_load_dwordx4 v249, s[92:95], s33 offen offset:0 lds
    s_waitcnt lgkmcnt(9)
    v_mfma_f32_16x16x32_bf16 v[60:63], v[176:179], v[208:211], v[60:63]
    ds_read_b64_tr_b16 v[162:163], v250 offset:25088
    v_mfma_f32_16x16x32_bf16 v[64:67], v[208:211], v[180:183], v[64:67]
    ds_read_b128 v[92:95], v142 offset:20480
    s_add_u32 m0, s35, 72960
    s_nop 0
    buffer_load_dwordx4 v248, s[60:63], s69 offen offset:768 lds
    v_mfma_f32_16x16x32_bf16 v[68:71], v[172:175], v[208:211], v[68:71]
    ds_read_b64_tr_b16 v[230:231], v252 offset:1280
    s_waitcnt lgkmcnt(10)
    v_mfma_f32_16x16x32_bf16 v[72:75], v[176:179], v[212:215], v[72:75]
    v_mfma_f32_16x16x32_bf16 v[76:79], v[212:215], v[180:183], v[76:79]
    ds_read_b128 v[96:99], v142 offset:24576
    s_add_u32 m0, s35, 77056
    s_nop 0
    buffer_load_dwordx4 v248, s[60:63], s27 offen offset:768 lds
    v_mfma_f32_16x16x32_bf16 v[80:83], v[172:175], v[212:215], v[80:83]
    v_mfma_f32_16x16x32_bf16 v[22:25], v[176:179], v[188:191], v[22:25]
    s_add_u32 m0, s66, 5120
    s_nop 0
    buffer_load_dwordx4 v251, s[96:99], s41 offen lds
    s_add_u32 s41, s41, s42
    v_mfma_f32_16x16x32_bf16 v[184:187], v[188:191], v[180:183], v[184:187]
    v_mfma_f32_16x16x32_bf16 v[18:21], v[172:175], v[188:191], v[18:21]
    s_add_u32 s67, s43, s44
    s_waitcnt lgkmcnt(9)
    v_mfma_f32_16x16x32_bf16 v[192:195], v[188:191], v[84:87], v[192:195]
    s_waitcnt lgkmcnt(1)
    buffer_store_dwordx4 v[228:231], v253, s[8:11], s67 offen sc1
    v_mfma_f32_16x16x32_bf16 v[196:199], v[84:87], v[84:87], v[196:199]
    ds_read_b128 v[208:211], v142 offset:28672
    s_add_u32 s43, s43, s45
    v_mfma_f32_16x16x32_bf16 v[192:195], v[188:191], v[88:91], v[192:195]
    v_mfma_f32_16x16x32_bf16 v[240:243], v[228:231], v[244:247], v[240:243]
    v_mfma_f32_16x16x32_bf16 v[196:199], v[88:91], v[88:91], v[196:199]
    ds_read_b128 v[212:215], v142 offset:32768
    s_waitcnt vmcnt(15)
    s_barrier
    v_mfma_f32_16x16x32_bf16 v[28:31], v[164:167], v[92:95], v[28:31]
    ds_read_b64_tr_b16 v[176:177], v250 offset:37888
    v_mfma_f32_16x16x32_bf16 v[32:35], v[92:95], v[168:171], v[32:35]
    ds_read_b128 v[84:87], v142 offset:36864
    s_waitcnt lgkmcnt(4)
    v_mfma_f32_16x16x32_bf16 v[36:39], v[164:167], v[96:99], v[36:39]
    ds_read_b64_tr_b16 v[178:179], v250 offset:38400
    s_add_u32 m0, s34, 139264
    s_add_u32 s33, s32, 983040
    buffer_load_dwordx4 v249, s[92:95], s33 offen offset:1024 lds
    v_mfma_f32_16x16x32_bf16 v[40:43], v[96:99], v[168:171], v[40:43]
    ds_read_b128 v[88:91], v148 offset:40960
    v_mfma_f32_16x16x32_bf16 v[44:47], v[160:163], v[96:99], v[44:47]
    ds_read_b64_tr_b16 v[180:181], v250 offset:38912
    s_waitcnt lgkmcnt(6)
    v_mfma_f32_16x16x32_bf16 v[48:51], v[164:167], v[208:211], v[48:51]
    ds_read_b64_tr_b16 v[182:183], v250 offset:39424
    buffer_load_dwordx4 v249, s[92:95], s33 offen offset:2048 lds
    v_mfma_f32_16x16x32_bf16 v[52:55], v[208:211], v[168:171], v[52:55]
    ds_read_b128 v[92:95], v149 offset:40960
    v_mfma_f32_16x16x32_bf16 v[56:59], v[160:163], v[208:211], v[56:59]
    ds_read_b64_tr_b16 v[172:173], v250 offset:36864
    ds_read_b64_tr_b16 v[232:233], v252 offset:2048
    s_waitcnt lgkmcnt(9)
    v_mfma_f32_16x16x32_bf16 v[60:63], v[164:167], v[212:215], v[60:63]
    ds_read_b64_tr_b16 v[174:175], v250 offset:37376
    v_mfma_f32_16x16x32_bf16 v[64:67], v[212:215], v[168:171], v[64:67]
    ds_read_b128 v[96:99], v143 offset:20480
    buffer_load_dwordx4 v249, s[92:95], s33 offen offset:0 lds
    v_mfma_f32_16x16x32_bf16 v[68:71], v[160:163], v[212:215], v[68:71]
    s_waitcnt lgkmcnt(9)
    v_mfma_f32_16x16x32_bf16 v[72:75], v[164:167], v[84:87], v[72:75]
    ds_read_b64_tr_b16 v[234:235], v252 offset:2304
    v_mfma_f32_16x16x32_bf16 v[76:79], v[84:87], v[168:171], v[76:79]
    ds_read_b128 v[208:211], v143 offset:24576
    v_mfma_f32_16x16x32_bf16 v[80:83], v[160:163], v[84:87], v[80:83]
    s_add_u32 m0, s66, 6144
    s_nop 0
    buffer_load_dwordx4 v251, s[96:99], s41 offen lds
    s_add_u32 s41, s41, s51
    v_mfma_f32_16x16x32_bf16 v[22:25], v[164:167], v[188:191], v[22:25]
    v_mfma_f32_16x16x32_bf16 v[184:187], v[188:191], v[168:171], v[184:187]
    v_mfma_f32_16x16x32_bf16 v[18:21], v[160:163], v[188:191], v[18:21]
    s_waitcnt lgkmcnt(9)
    v_mfma_f32_16x16x32_bf16 v[192:195], v[188:191], v[88:91], v[192:195]
    s_waitcnt lgkmcnt(1)
    buffer_store_dwordx4 v[232:235], v253, s[8:11], s43 offen sc1
    v_mfma_f32_16x16x32_bf16 v[196:199], v[88:91], v[88:91], v[196:199]
    ds_read_b128 v[212:215], v143 offset:28672
    v_mfma_f32_16x16x32_bf16 v[192:195], v[188:191], v[92:95], v[192:195]
    v_mfma_f32_16x16x32_bf16 v[240:243], v[232:235], v[244:247], v[240:243]
    v_mfma_f32_16x16x32_bf16 v[196:199], v[92:95], v[92:95], v[196:199]
    ds_read_b128 v[84:87], v143 offset:32768
    s_waitcnt vmcnt(16)
    s_barrier
    v_mfma_f32_16x16x32_bf16 v[28:31], v[176:179], v[96:99], v[28:31]
    ds_read_b64_tr_b16 v[164:165], v250 offset:1024
    v_mfma_f32_16x16x32_bf16 v[32:35], v[96:99], v[180:183], v[32:35]
    ds_read_b128 v[88:91], v143 offset:36864
    s_waitcnt lgkmcnt(4)
    v_mfma_f32_16x16x32_bf16 v[36:39], v[176:179], v[208:211], v[36:39]
    ds_read_b64_tr_b16 v[166:167], v250 offset:1536
    s_add_u32 m0, s34, 151552
    s_add_u32 s33, s32, 1081344
    buffer_load_dwordx4 v249, s[92:95], s33 offen offset:1024 lds
    v_mfma_f32_16x16x32_bf16 v[40:43], v[208:211], v[180:183], v[40:43]
    ds_read_b128 v[92:95], v150 offset:40960
    v_mfma_f32_16x16x32_bf16 v[44:47], v[172:175], v[208:211], v[44:47]
    ds_read_b64_tr_b16 v[168:169], v250 offset:2048
    s_waitcnt lgkmcnt(6)
    v_mfma_f32_16x16x32_bf16 v[48:51], v[176:179], v[212:215], v[48:51]
    ds_read_b64_tr_b16 v[170:171], v250 offset:2560
    buffer_load_dwordx4 v249, s[92:95], s33 offen offset:2048 lds
    v_mfma_f32_16x16x32_bf16 v[52:55], v[212:215], v[180:183], v[52:55]
    ds_read_b128 v[96:99], v151 offset:40960
    v_mfma_f32_16x16x32_bf16 v[56:59], v[172:175], v[212:215], v[56:59]
    ds_read_b64_tr_b16 v[160:161], v250 offset:0
    ds_read_b64_tr_b16 v[236:237], v252 offset:3072
    s_waitcnt lgkmcnt(9)
    v_mfma_f32_16x16x32_bf16 v[60:63], v[176:179], v[84:87], v[60:63]
    ds_read_b64_tr_b16 v[162:163], v250 offset:512
    v_mfma_f32_16x16x32_bf16 v[64:67], v[84:87], v[180:183], v[64:67]
    ds_read_b128 v[208:211], v140 offset:40960
    buffer_load_dwordx4 v249, s[92:95], s33 offen offset:0 lds
    v_mfma_f32_16x16x32_bf16 v[68:71], v[172:175], v[84:87], v[68:71]
    s_waitcnt lgkmcnt(9)
    v_mfma_f32_16x16x32_bf16 v[72:75], v[176:179], v[88:91], v[72:75]
    ds_read_b64_tr_b16 v[238:239], v252 offset:3328
    v_mfma_f32_16x16x32_bf16 v[76:79], v[88:91], v[180:183], v[76:79]
    ds_read_b128 v[212:215], v140 offset:45056
    v_mfma_f32_16x16x32_bf16 v[80:83], v[172:175], v[88:91], v[80:83]
    s_add_u32 m0, s66, 7168
    s_nop 0
    buffer_load_dwordx4 v251, s[96:99], s41 offen lds
    s_add_u32 s41, s41, s42
    v_mfma_f32_16x16x32_bf16 v[22:25], v[176:179], v[188:191], v[22:25]
    v_mfma_f32_16x16x32_bf16 v[184:187], v[188:191], v[180:183], v[184:187]
    s_add_u32 s67, s43, s44
    v_mfma_f32_16x16x32_bf16 v[18:21], v[172:175], v[188:191], v[18:21]
    s_waitcnt lgkmcnt(1)
    buffer_store_dwordx4 v[236:239], v253, s[8:11], s67 offen sc1
    v_mfma_f32_16x16x32_bf16 v[192:195], v[188:191], v[92:95], v[192:195]
    v_mfma_f32_16x16x32_bf16 v[196:199], v[92:95], v[92:95], v[196:199]
    ds_read_b128 v[84:87], v140 offset:49152
    s_add_u32 s43, s43, s45
    v_mfma_f32_16x16x32_bf16 v[192:195], v[188:191], v[96:99], v[192:195]
    v_mfma_f32_16x16x32_bf16 v[240:243], v[236:239], v[244:247], v[240:243]
    v_mfma_f32_16x16x32_bf16 v[196:199], v[96:99], v[96:99], v[196:199]
    ds_read_b128 v[88:91], v140 offset:53248
    s_waitcnt vmcnt(12)
    s_barrier
    v_mfma_f32_16x16x32_bf16 v[28:31], v[164:167], v[208:211], v[28:31]
    ds_read_b64_tr_b16 v[176:177], v250 offset:13312
    v_mfma_f32_16x16x32_bf16 v[32:35], v[208:211], v[168:171], v[32:35]
    ds_read_b128 v[92:95], v140 offset:57344
    s_waitcnt lgkmcnt(4)
    v_mfma_f32_16x16x32_bf16 v[36:39], v[164:167], v[212:215], v[36:39]
    ds_read_b64_tr_b16 v[178:179], v250 offset:13824
    v_mfma_f32_16x16x32_bf16 v[40:43], v[212:215], v[168:171], v[40:43]
    ds_read_b128 v[96:99], v148 offset:61440
    s_add_u32 m0, s34, 114688
    s_add_u32 s33, s32, 1179648
    buffer_load_dwordx4 v249, s[92:95], s33 offen offset:1024 lds
    v_mfma_f32_16x16x32_bf16 v[44:47], v[160:163], v[212:215], v[44:47]
    ds_read_b64_tr_b16 v[180:181], v250 offset:14336
    s_waitcnt lgkmcnt(6)
    v_mfma_f32_16x16x32_bf16 v[48:51], v[164:167], v[84:87], v[48:51]
    ds_read_b64_tr_b16 v[182:183], v250 offset:14848
    ds_read_b64_tr_b16 v[224:225], v252 offset:4096
    v_mfma_f32_16x16x32_bf16 v[52:55], v[84:87], v[168:171], v[52:55]
    ds_read_b128 v[208:211], v149 offset:61440
    v_mfma_f32_16x16x32_bf16 v[56:59], v[160:163], v[84:87], v[56:59]
    ds_read_b64_tr_b16 v[172:173], v250 offset:12288
    s_waitcnt lgkmcnt(9)
    v_mfma_f32_16x16x32_bf16 v[60:63], v[164:167], v[88:91], v[60:63]
    ds_read_b64_tr_b16 v[174:175], v250 offset:12800
    buffer_load_dwordx4 v249, s[92:95], s33 offen offset:2048 lds
    v_mfma_f32_16x16x32_bf16 v[64:67], v[88:91], v[168:171], v[64:67]
    ds_read_b128 v[212:215], v141 offset:40960
    v_mfma_f32_16x16x32_bf16 v[68:71], v[160:163], v[88:91], v[68:71]
    ds_read_b64_tr_b16 v[226:227], v252 offset:4352
    s_waitcnt lgkmcnt(10)
    v_mfma_f32_16x16x32_bf16 v[72:75], v[164:167], v[92:95], v[72:75]
    v_mfma_f32_16x16x32_bf16 v[76:79], v[92:95], v[168:171], v[76:79]
    ds_read_b128 v[84:87], v141 offset:45056
    buffer_load_dwordx4 v249, s[92:95], s33 offen offset:0 lds
    v_mfma_f32_16x16x32_bf16 v[80:83], v[160:163], v[92:95], v[80:83]
    v_mfma_f32_16x16x32_bf16 v[22:25], v[164:167], v[188:191], v[22:25]
    v_mfma_f32_16x16x32_bf16 v[184:187], v[188:191], v[168:171], v[184:187]
    v_mfma_f32_16x16x32_bf16 v[18:21], v[160:163], v[188:191], v[18:21]
    s_waitcnt lgkmcnt(1)
    buffer_store_dwordx4 v[224:227], v253, s[8:11], s43 offen sc1
    v_mfma_f32_16x16x32_bf16 v[192:195], v[188:191], v[96:99], v[192:195]
    v_mfma_f32_16x16x32_bf16 v[196:199], v[96:99], v[96:99], v[196:199]
    ds_read_b128 v[88:91], v141 offset:49152
    v_mfma_f32_16x16x32_bf16 v[192:195], v[188:191], v[208:211], v[192:195]
    v_mfma_f32_16x16x32_bf16 v[240:243], v[224:227], v[244:247], v[240:243]
    v_mfma_f32_16x16x32_bf16 v[196:199], v[208:211], v[208:211], v[196:199]
    ds_read_b128 v[92:95], v141 offset:53248
    s_waitcnt vmcnt(11)
    s_barrier
    v_mfma_f32_16x16x32_bf16 v[28:31], v[176:179], v[212:215], v[28:31]
    ds_read_b64_tr_b16 v[164:165], v250 offset:25600
    v_mfma_f32_16x16x32_bf16 v[32:35], v[212:215], v[180:183], v[32:35]
    ds_read_b128 v[96:99], v141 offset:57344
    s_waitcnt lgkmcnt(4)
    v_mfma_f32_16x16x32_bf16 v[36:39], v[176:179], v[84:87], v[36:39]
    ds_read_b64_tr_b16 v[166:167], v250 offset:26112
    v_mfma_f32_16x16x32_bf16 v[40:43], v[84:87], v[180:183], v[40:43]
    ds_read_b128 v[208:211], v150 offset:61440
    s_add_u32 m0, s34, 126976
    s_add_u32 s33, s32, 1277952
    buffer_load_dwordx4 v249, s[92:95], s33 offen offset:1024 lds
    v_mfma_f32_16x16x32_bf16 v[44:47], v[172:175], v[84:87], v[44:47]
    ds_read_b64_tr_b16 v[168:169], v250 offset:26624
    s_waitcnt lgkmcnt(6)
    v_mfma_f32_16x16x32_bf16 v[48:51], v[176:179], v[88:91], v[48:51]
    ds_read_b64_tr_b16 v[170:171], v250 offset:27136
    v_mfma_f32_16x16x32_bf16 v[52:55], v[88:91], v[180:183], v[52:55]
    ds_read_b128 v[212:215], v151 offset:61440
    ds_read_b64_tr_b16 v[228:229], v252 offset:5120
    v_mfma_f32_16x16x32_bf16 v[56:59], v[172:175], v[88:91], v[56:59]
    ds_read_b64_tr_b16 v[160:161], v250 offset:24576
    s_waitcnt lgkmcnt(9)
    v_mfma_f32_16x16x32_bf16 v[60:63], v[176:179], v[92:95], v[60:63]
    ds_read_b64_tr_b16 v[162:163], v250 offset:25088
    v_mfma_f32_16x16x32_bf16 v[64:67], v[92:95], v[180:183], v[64:67]
    ds_read_b128 v[84:87], v100 offset:0
    buffer_load_dwordx4 v249, s[92:95], s33 offen offset:2048 lds
    v_mfma_f32_16x16x32_bf16 v[68:71], v[172:175], v[92:95], v[68:71]
    s_waitcnt lgkmcnt(9)
    v_mfma_f32_16x16x32_bf16 v[72:75], v[176:179], v[96:99], v[72:75]
    ds_read_b64_tr_b16 v[230:231], v252 offset:5376
    v_mfma_f32_16x16x32_bf16 v[76:79], v[96:99], v[180:183], v[76:79]
    ds_read_b128 v[88:91], v101 offset:0
    v_mfma_f32_16x16x32_bf16 v[80:83], v[172:175], v[96:99], v[80:83]
    v_mfma_f32_16x16x32_bf16 v[22:25], v[176:179], v[188:191], v[22:25]
    buffer_load_dwordx4 v249, s[92:95], s33 offen offset:0 lds
    v_mfma_f32_16x16x32_bf16 v[184:187], v[188:191], v[180:183], v[184:187]
    v_mfma_f32_16x16x32_bf16 v[18:21], v[172:175], v[188:191], v[18:21]
    s_add_u32 s67, s43, s44
    s_waitcnt lgkmcnt(9)
    v_mfma_f32_16x16x32_bf16 v[192:195], v[188:191], v[208:211], v[192:195]
    v_mfma_f32_16x16x32_bf16 v[196:199], v[208:211], v[208:211], v[196:199]
    ds_read_b128 v[92:95], v142 offset:40960
    s_waitcnt lgkmcnt(7)
    v_mfma_f32_16x16x32_bf16 v[192:195], v[188:191], v[212:215], v[192:195]
    s_waitcnt lgkmcnt(2)
    buffer_store_dwordx4 v[228:231], v253, s[8:11], s67 offen sc1
    v_mfma_f32_16x16x32_bf16 v[196:199], v[212:215], v[212:215], v[196:199]
    ds_read_b128 v[96:99], v142 offset:45056
    v_mfma_f32_16x16x32_bf16 v[200:203], v[188:191], v[84:87], 0
    s_add_u32 s43, s43, s45
    v_mfma_f32_16x16x32_bf16 v[204:207], v[84:87], v[84:87], 0
    ds_read_b128 v[208:211], v142 offset:49152
    v_mfma_f32_16x16x32_bf16 v[240:243], v[228:231], v[244:247], v[240:243]
    s_waitcnt lgkmcnt(3)
    v_mfma_f32_16x16x32_bf16 v[200:203], v[188:191], v[88:91], v[200:203]
    v_mfma_f32_16x16x32_bf16 v[204:207], v[88:91], v[88:91], v[204:207]
    ds_read_b128 v[212:215], v142 offset:53248
    s_waitcnt vmcnt(10)
    s_barrier
    s_waitcnt lgkmcnt(3)
    v_mfma_f32_16x16x32_bf16 v[28:31], v[164:167], v[92:95], v[28:31]
    ds_read_b64_tr_b16 v[176:177], v250 offset:37888
    v_mfma_f32_16x16x32_bf16 v[32:35], v[92:95], v[168:171], v[32:35]
    ds_read_b128 v[84:87], v142 offset:57344
    s_waitcnt lgkmcnt(4)
    v_mfma_f32_16x16x32_bf16 v[36:39], v[164:167], v[96:99], v[36:39]
    ds_read_b64_tr_b16 v[178:179], v250 offset:38400
    v_mfma_f32_16x16x32_bf16 v[40:43], v[96:99], v[168:171], v[40:43]
    ds_read_b128 v[88:91], v102 offset:0
    s_add_u32 m0, s34, 139264
    s_add_u32 s33, s32, 1376256
    buffer_load_dwordx4 v249, s[92:95], s33 offen offset:1024 lds
    v_mfma_f32_16x16x32_bf16 v[44:47], v[160:163], v[96:99], v[44:47]
    ds_read_b64_tr_b16 v[180:181], v250 offset:38912
    s_waitcnt lgkmcnt(6)
    v_mfma_f32_16x16x32_bf16 v[48:51], v[164:167], v[208:211], v[48:51]
    ds_read_b64_tr_b16 v[182:183], v250 offset:39424
    ds_read_b64_tr_b16 v[232:233], v252 offset:6144
    v_mfma_f32_16x16x32_bf16 v[52:55], v[208:211], v[168:171], v[52:55]
    ds_read_b128 v[92:95], v103 offset:0
    v_mfma_f32_16x16x32_bf16 v[56:59], v[160:163], v[208:211], v[56:59]
    ds_read_b64_tr_b16 v[172:173], v250 offset:36864
    s_waitcnt lgkmcnt(9)
    v_mfma_f32_16x16x32_bf16 v[60:63], v[164:167], v[212:215], v[60:63]
    ds_read_b64_tr_b16 v[174:175], v250 offset:37376
    buffer_load_dwordx4 v249, s[92:95], s33 offen offset:2048 lds
    v_mfma_f32_16x16x32_bf16 v[64:67], v[212:215], v[168:171], v[64:67]
    ds_read_b128 v[96:99], v143 offset:40960
    v_mfma_f32_16x16x32_bf16 v[68:71], v[160:163], v[212:215], v[68:71]
    ds_read_b64_tr_b16 v[234:235], v252 offset:6400
    s_waitcnt lgkmcnt(10)
    v_mfma_f32_16x16x32_bf16 v[72:75], v[164:167], v[84:87], v[72:75]
    v_mfma_f32_16x16x32_bf16 v[76:79], v[84:87], v[168:171], v[76:79]
    ds_read_b128 v[208:211], v143 offset:45056
    buffer_load_dwordx4 v249, s[92:95], s33 offen offset:0 lds
    v_mfma_f32_16x16x32_bf16 v[80:83], v[160:163], v[84:87], v[80:83]
    v_mfma_f32_16x16x32_bf16 v[22:25], v[164:167], v[188:191], v[22:25]
    v_mfma_f32_16x16x32_bf16 v[184:187], v[188:191], v[168:171], v[184:187]
    v_mfma_f32_16x16x32_bf16 v[18:21], v[160:163], v[188:191], v[18:21]
    s_waitcnt lgkmcnt(1)
    buffer_store_dwordx4 v[232:235], v253, s[8:11], s43 offen sc1
    v_mfma_f32_16x16x32_bf16 v[200:203], v[188:191], v[88:91], v[200:203]
    v_mfma_f32_16x16x32_bf16 v[204:207], v[88:91], v[88:91], v[204:207]
    ds_read_b128 v[212:215], v143 offset:49152
    v_mfma_f32_16x16x32_bf16 v[200:203], v[188:191], v[92:95], v[200:203]
    v_mfma_f32_16x16x32_bf16 v[240:243], v[232:235], v[244:247], v[240:243]
    v_mfma_f32_16x16x32_bf16 v[204:207], v[92:95], v[92:95], v[204:207]
    ds_read_b128 v[84:87], v143 offset:53248
    s_waitcnt vmcnt(9)
    s_barrier
    v_mfma_f32_16x16x32_bf16 v[28:31], v[176:179], v[96:99], v[28:31]
    ds_read_b64_tr_b16 v[164:165], v250 offset:1024
L_pad7424:
    s_cbranch_execz L_ret_top
    v_mfma_f32_16x16x32_bf16 v[32:35], v[96:99], v[180:183], v[32:35]
    ds_read_b128 v[88:91], v143 offset:57344
    s_add_u32 m0, s34, 151552
    s_add_u32 s33, s32, 1474560
    buffer_load_dwordx4 v249, s[92:95], s33 offen offset:1024 lds
    s_waitcnt lgkmcnt(4)
    v_mfma_f32_16x16x32_bf16 v[36:39], v[176:179], v[208:211], v[36:39]
    ds_read_b64_tr_b16 v[166:167], v250 offset:1536
    ds_read_b64_tr_b16 v[236:237], v252 offset:7168
    v_mfma_f32_16x16x32_bf16 v[40:43], v[208:211], v[180:183], v[40:43]
    ds_read_b128 v[92:95], v140 offset:61440
    buffer_load_dwordx4 v249, s[92:95], s33 offen offset:2048 lds
    ds_read_b64_tr_b16 v[238:239], v252 offset:7424
    v_mfma_f32_16x16x32_bf16 v[44:47], v[172:175], v[208:211], v[44:47]
    ds_read_b64_tr_b16 v[168:169], v250 offset:2048
    buffer_load_dwordx4 v249, s[92:95], s33 offen offset:0 lds
    s_waitcnt lgkmcnt(8)
    v_mfma_f32_16x16x32_bf16 v[48:51], v[176:179], v[212:215], v[48:51]
    ds_read_b64_tr_b16 v[170:171], v250 offset:2560
    s_mov_b32 s58, 0xcccccccc
    s_add_u32 s67, s43, s44
    s_mov_b32 s59, 0xcccccccc
    v_mfma_f32_16x16x32_bf16 v[52:55], v[212:215], v[180:183], v[52:55]
    ds_read_b128 v[96:99], v144 offset:4096
    v_cndmask_b32 v196, v196, v197, s[28:29]
    v_cndmask_b32 v198, v198, v199, s[28:29]
    v_cndmask_b32 v196, v196, v198, s[58:59]
    v_mfma_f32_16x16x32_bf16 v[56:59], v[172:175], v[212:215], v[56:59]
    ds_read_b64_tr_b16 v[160:161], v250 offset:0
    s_sub_u32 s67, s67, s53
    v_cndmask_b32 v204, v204, v205, s[28:29]
    v_cndmask_b32 v206, v206, v207, s[28:29]
    s_waitcnt lgkmcnt(10)
    v_mfma_f32_16x16x32_bf16 v[60:63], v[176:179], v[84:87], v[60:63]
    ds_read_b64_tr_b16 v[162:163], v250 offset:512
    v_cndmask_b32 v204, v204, v206, s[58:59]
    v_mov_b32 v193, v196
    v_mfma_f32_16x16x32_bf16 v[64:67], v[84:87], v[180:183], v[64:67]
    ds_read_b128 v[208:211], v144 offset:8192
    s_waitcnt lgkmcnt(6)
    buffer_store_dwordx4 v[236:239], v253, s[8:11], s67 offen sc1
    v_mfma_f32_16x16x32_bf16 v[68:71], v[172:175], v[84:87], v[68:71]
    v_mov_b32 v201, v204
    v_mul_f32 v192, 0xbb000000, v192
    v_mul_f32 v194, v192, v192
    v_mfma_f32_16x16x32_bf16 v[72:75], v[176:179], v[88:91], v[72:75]
    v_mov_b32 v195, 0x3b000000
    s_add_u32 s43, s43, s45
    v_fma_f32 v194, v193, v195, -v194
    v_mfma_f32_16x16x32_bf16 v[76:79], v[88:91], v[180:183], v[76:79]
    ds_read_b128 v[212:215], v144 offset:12288
    v_max_f32 v194, 0, v194
    v_add_f32 v194, s24, v194
    v_mov_b32 v193, v192
    v_mfma_f32_16x16x32_bf16 v[80:83], v[172:175], v[88:91], v[80:83]
    v_mfma_f32_16x16x32_bf16 v[240:243], v[236:239], v[244:247], v[240:243]
    v_rsq_f32 v192, v194
    v_mfma_f32_16x16x32_bf16 v[22:25], v[176:179], v[188:191], v[22:25]
    s_lshl_b32 s38, s3, 7
    v_add_u32 v196, s38, v8
    v_mfma_f32_16x16x32_bf16 v[184:187], v[188:191], v[180:183], v[184:187]
    s_mov_b32 exec_lo, 0x00f0000f
    s_mov_b32 exec_hi, 0xf0000f00
    ds_write_b64 v196, v[192:193] offset:128
    ds_write_b64 v105, v[200:201]
    s_mov_b64 exec, -1
    v_mfma_f32_16x16x32_bf16 v[18:21], v[172:175], v[188:191], v[18:21]
    s_waitcnt vmcnt(9)
    s_waitcnt lgkmcnt(0)
    s_barrier
    v_mfma_f32_16x16x32_bf16 v[28:31], v[164:167], v[92:95], v[28:31]
    ds_read_b64_tr_b16 v[176:177], v250 offset:13312
    s_mov_b32 exec_lo, 0x00030003
    s_mov_b32 exec_hi, 0x00030003
    ds_write_b128 v155, v[240:243]
    s_mov_b64 exec, -1
    v_mfma_f32_16x16x32_bf16 v[32:35], v[92:95], v[168:171], v[32:35]
    ds_read_b128 v[84:87], v144 offset:16384
    v_mfma_f32_16x16x32_bf16 v[36:39], v[164:167], v[96:99], v[36:39]
    ds_read_b64_tr_b16 v[178:179], v250 offset:13824
    ds_read_b64 v[200:201], v104 offset:4096
    ds_read_b64 v[202:203], v104 offset:4224
    v_mfma_f32_16x16x32_bf16 v[40:43], v[96:99], v[168:171], v[40:43]
    ds_read_b128 v[88:91], v141 offset:61440
    ds_read_b64 v[204:205], v104 offset:4352
    v_mfma_f32_16x16x32_bf16 v[44:47], v[160:163], v[96:99], v[44:47]
    ds_read_b64_tr_b16 v[180:181], v250 offset:14336
    ds_read_b64 v[206:207], v104 offset:4480
    s_waitcnt lgkmcnt(4)
    v_add_f32 v200, v200, v202
    v_mfma_f32_16x16x32_bf16 v[48:51], v[164:167], v[208:211], v[48:51]
    ds_read_b64_tr_b16 v[182:183], v250 offset:14848
    s_waitcnt lgkmcnt(1)
    v_add_f32 v204, v204, v206
    v_mfma_f32_16x16x32_bf16 v[52:55], v[208:211], v[168:171], v[52:55]
    ds_read_b128 v[92:95], v145 offset:4096
    v_add_f32 v201, v201, v203
    v_mfma_f32_16x16x32_bf16 v[56:59], v[160:163], v[208:211], v[56:59]
    ds_read_b64_tr_b16 v[172:173], v250 offset:12288
    v_add_f32 v205, v205, v207
    v_add_f32 v200, v200, v204
    v_mfma_f32_16x16x32_bf16 v[60:63], v[164:167], v[212:215], v[60:63]
    ds_read_b64_tr_b16 v[174:175], v250 offset:12800
    v_add_f32 v201, v201, v205
    v_mfma_f32_16x16x32_bf16 v[64:67], v[212:215], v[168:171], v[64:67]
    ds_read_b128 v[96:99], v145 offset:8192
    v_mul_f32 v200, 0xbb000000, v200
    v_mul_f32 v202, v200, v200
    v_mfma_f32_16x16x32_bf16 v[68:71], v[160:163], v[212:215], v[68:71]
    v_mov_b32 v203, 0x3b000000
    v_mfma_f32_16x16x32_bf16 v[72:75], v[164:167], v[84:87], v[72:75]
    v_fma_f32 v202, v201, v203, -v202
    v_mfma_f32_16x16x32_bf16 v[76:79], v[84:87], v[168:171], v[76:79]
    ds_read_b128 v[208:211], v145 offset:12288
    v_max_f32 v202, 0, v202
    v_add_f32 v202, s24, v202
    v_mfma_f32_16x16x32_bf16 v[80:83], v[160:163], v[84:87], v[80:83]
    v_mov_b32 v201, v200
    v_mfma_f32_16x16x32_bf16 v[22:25], v[164:167], v[188:191], v[22:25]
    v_rsq_f32 v200, v202
    v_mfma_f32_16x16x32_bf16 v[184:187], v[188:191], v[168:171], v[184:187]
    ds_write_b64 v8, v[200:201]
    v_mfma_f32_16x16x32_bf16 v[18:21], v[160:163], v[188:191], v[18:21]
    s_waitcnt vmcnt(5)
    s_waitcnt lgkmcnt(0)
    s_barrier
    v_mfma_f32_16x16x32_bf16 v[28:31], v[176:179], v[88:91], v[28:31]
    ds_read_b64_tr_b16 v[164:165], v250 offset:25600
    ds_read_b32 v240, v156 offset:0
    ds_read_b32 v241, v156 offset:128
    v_mfma_f32_16x16x32_bf16 v[32:35], v[88:91], v[180:183], v[32:35]
    ds_read_b128 v[212:215], v145 offset:16384
    ds_read_b32 v242, v156 offset:256
    ds_read_b32 v243, v156 offset:384
    v_mfma_f32_16x16x32_bf16 v[36:39], v[176:179], v[92:95], v[36:39]
    ds_read_b64_tr_b16 v[166:167], v250 offset:26112
    s_waitcnt lgkmcnt(4)
    v_add_f32 v240, v240, v241
    v_mfma_f32_16x16x32_bf16 v[40:43], v[92:95], v[180:183], v[40:43]
    ds_read_b128 v[84:87], v142 offset:61440
    s_waitcnt lgkmcnt(2)
    v_add_f32 v242, v242, v243
    v_add_f32 v240, v240, v242
    v_mfma_f32_16x16x32_bf16 v[44:47], v[172:175], v[92:95], v[44:47]
    ds_read_b64_tr_b16 v[168:169], v250 offset:26624
    v_cvt_pk_bf16_f32 v243, v240, v240
    v_and_b32 v241, 0xffff0000, v243
    v_mfma_f32_16x16x32_bf16 v[48:51], v[176:179], v[96:99], v[48:51]
    ds_read_b64_tr_b16 v[170:171], v250 offset:27136
    v_sub_f32 v242, v240, v241
    v_and_b32 v243, 0xffff, v243
    v_mfma_f32_16x16x32_bf16 v[52:55], v[96:99], v[180:183], v[52:55]
    ds_read_b128 v[88:91], v146 offset:4096
    v_cvt_pk_bf16_f32 v242, v241, v242
    v_mfma_f32_16x16x32_bf16 v[56:59], v[172:175], v[96:99], v[56:59]
    ds_read_b64_tr_b16 v[160:161], v250 offset:24576
    v_mfma_f32_16x16x32_bf16 v[60:63], v[176:179], v[208:211], v[60:63]
    ds_read_b64_tr_b16 v[162:163], v250 offset:25088
    v_mfma_f32_16x16x32_bf16 v[64:67], v[208:211], v[180:183], v[64:67]
    ds_read_b128 v[92:95], v146 offset:8192
    s_cmp_eq_u32 s54, 2
    s_cbranch_scc1 L_cs_gu
    buffer_store_dword v240, v154, s[8:11], 0 offen sc1
    s_branch L_cs_done
L_cs_gu:
    buffer_store_dwordx2 v[242:243], v154, s[8:11], 0 offen sc1
L_cs_done:
    v_mfma_f32_16x16x32_bf16 v[68:71], v[172:175], v[208:211], v[68:71]
    v_mfma_f32_16x16x32_bf16 v[72:75], v[176:179], v[212:215], v[72:75]
    v_mfma_f32_16x16x32_bf16 v[76:79], v[212:215], v[180:183], v[76:79]
    ds_read_b128 v[96:99], v146 offset:12288
    v_mfma_f32_16x16x32_bf16 v[80:83], v[172:175], v[212:215], v[80:83]
    v_mfma_f32_16x16x32_bf16 v[22:25], v[176:179], v[188:191], v[22:25]
    s_mov_b64 exec, 0xffff
    v_lshlrev_b32 v221, 2, v0
    buffer_load_dword v216, v221, s[88:91], 0 offen offset:0 sc1
    s_mov_b64 exec, -1
    v_mfma_f32_16x16x32_bf16 v[184:187], v[188:191], v[180:183], v[184:187]
    v_mfma_f32_16x16x32_bf16 v[18:21], v[172:175], v[188:191], v[18:21]
    s_waitcnt vmcnt(3)
    s_waitcnt lgkmcnt(2)
    s_barrier
    v_mfma_f32_16x16x32_bf16 v[28:31], v[164:167], v[84:87], v[28:31]
    ds_read_b64_tr_b16 v[176:177], v250 offset:37888
    v_mov_b32 v232, -1
    v_mfma_f32_16x16x32_bf16 v[32:35], v[84:87], v[168:171], v[32:35]
    ds_read_b128 v[208:211], v146 offset:16384
    v_mov_b32 v233, -1
    v_mfma_f32_16x16x32_bf16 v[36:39], v[164:167], v[88:91], v[36:39]
    ds_read_b64_tr_b16 v[178:179], v250 offset:38400
    v_mov_b32 v234, -1
    v_mfma_f32_16x16x32_bf16 v[40:43], v[88:91], v[168:171], v[40:43]
    ds_read_b128 v[212:215], v143 offset:61440
    v_mov_b32 v235, -1
    v_mfma_f32_16x16x32_bf16 v[44:47], v[160:163], v[88:91], v[44:47]
    ds_read_b64_tr_b16 v[180:181], v250 offset:38912
    s_lshl_b32 s39, s101, 2
    s_add_u32 s39, s39, s3
    s_waitcnt lgkmcnt(6)
    v_mfma_f32_16x16x32_bf16 v[48:51], v[164:167], v[92:95], v[48:51]
    ds_read_b64_tr_b16 v[182:183], v250 offset:39424
    s_lshl_b32 s38, s100, 16
    s_lshl_b32 s39, s39, 10
    v_mfma_f32_16x16x32_bf16 v[52:55], v[92:95], v[168:171], v[52:55]
    ds_read_b128 v[84:87], v147 offset:4096
    s_add_u32 s38, s38, s39
    s_add_u32 s38, s38, 0x1000000
    v_mfma_f32_16x16x32_bf16 v[56:59], v[160:163], v[92:95], v[56:59]
    ds_read_b64_tr_b16 v[172:173], v250 offset:36864
    s_waitcnt lgkmcnt(8)
    v_mfma_f32_16x16x32_bf16 v[60:63], v[164:167], v[96:99], v[60:63]
    ds_read_b64_tr_b16 v[174:175], v250 offset:37376
    v_mfma_f32_16x16x32_bf16 v[64:67], v[96:99], v[168:171], v[64:67]
    ds_read_b128 v[88:91], v147 offset:8192
    buffer_store_dwordx4 v[232:235], v1, s[8:11], s38 offen sc1
    v_mfma_f32_16x16x32_bf16 v[68:71], v[160:163], v[96:99], v[68:71]
    s_waitcnt lgkmcnt(8)
    v_mfma_f32_16x16x32_bf16 v[72:75], v[164:167], v[208:211], v[72:75]
    s_add_u32 s38, s38, 32768
    v_mfma_f32_16x16x32_bf16 v[76:79], v[208:211], v[168:171], v[76:79]
    ds_read_b128 v[92:95], v147 offset:12288
    v_mfma_f32_16x16x32_bf16 v[80:83], v[160:163], v[208:211], v[80:83]
    buffer_store_dwordx4 v[232:235], v1, s[8:11], s38 offen sc1
    v_mfma_f32_16x16x32_bf16 v[22:25], v[164:167], v[188:191], v[22:25]
    v_mfma_f32_16x16x32_bf16 v[184:187], v[188:191], v[168:171], v[184:187]
    v_mfma_f32_16x16x32_bf16 v[18:21], v[160:163], v[188:191], v[18:21]
    s_waitcnt lgkmcnt(2)
    s_barrier
    v_mfma_f32_16x16x32_bf16 v[28:31], v[176:179], v[212:215], v[28:31]
    s_lshr_b32 s38, s3, 1
    s_lshl_b32 s39, s18, 1
    s_add_u32 s38, s38, s39
    v_mfma_f32_16x16x32_bf16 v[32:35], v[212:215], v[180:183], v[32:35]
    ds_read_b128 v[96:99], v147 offset:16384
    s_lshl_b32 s38, s38, 15
    s_and_b32 s39, s3, 1
    s_lshl_b32 s39, s39, 8
    v_mfma_f32_16x16x32_bf16 v[36:39], v[176:179], v[84:87], v[36:39]
    s_add_u32 s38, s38, s39
    s_lshl_b32 s39, s19, 12
    s_add_u32 s38, s38, s39
    v_mfma_f32_16x16x32_bf16 v[40:43], v[84:87], v[180:183], v[40:43]
    s_add_u32 s38, s38, 0x1200000
    v_mfma_f32_16x16x32_bf16 v[44:47], v[172:175], v[84:87], v[44:47]
    buffer_store_dwordx4 v[232:235], v7, s[8:11], s38 offen offset:0 sc1
    s_waitcnt lgkmcnt(2)
    v_mfma_f32_16x16x32_bf16 v[48:51], v[176:179], v[88:91], v[48:51]
    v_mfma_f32_16x16x32_bf16 v[52:55], v[88:91], v[180:183], v[52:55]
    v_mfma_f32_16x16x32_bf16 v[56:59], v[172:175], v[88:91], v[56:59]
    buffer_store_dwordx4 v[232:235], v7, s[8:11], s38 offen offset:2048 sc1
    s_waitcnt lgkmcnt(1)
    v_mfma_f32_16x16x32_bf16 v[60:63], v[176:179], v[92:95], v[60:63]
    s_lshl_b32 s38, s18, 2
    v_mfma_f32_16x16x32_bf16 v[64:67], v[92:95], v[180:183], v[64:67]
    s_add_u32 s38, s38, s3
    s_lshl_b32 s38, s38, 10
    s_lshl_b32 s39, s19, 7
    v_mfma_f32_16x16x32_bf16 v[68:71], v[172:175], v[92:95], v[68:71]
    s_add_u32 s38, s38, s39
    s_add_u32 s38, s38, 0x22a0000
    v_bfe_u32 v236, v0, 4, 1
    s_waitcnt lgkmcnt(0)
    v_mfma_f32_16x16x32_bf16 v[72:75], v[176:179], v[96:99], v[72:75]
    v_lshlrev_b32 v236, 2, v236
    v_mfma_f32_16x16x32_bf16 v[76:79], v[96:99], v[180:183], v[76:79]
    v_and_b32 v237, 15, v0
    v_lshl_add_u32 v236, v237, 3, v236
    v_mfma_f32_16x16x32_bf16 v[80:83], v[172:175], v[96:99], v[80:83]
    v_mfma_f32_16x16x32_bf16 v[22:25], v[176:179], v[188:191], v[22:25]
    buffer_store_dword v232, v236, s[8:11], s38 offen sc1
    v_mfma_f32_16x16x32_bf16 v[184:187], v[188:191], v[180:183], v[184:187]
    v_mfma_f32_16x16x32_bf16 v[18:21], v[172:175], v[188:191], v[18:21]
    s_nop 6
    v_mov_b32 v26, v184
    ds_read_b64 v[160:161], v8 offset:0
    ds_read_b128 v[162:165], v9 offset:0
    ds_read_b128 v[166:169], v9 offset:16
    ds_read_b64 v[170:171], v8 offset:128
    ds_read_b128 v[172:175], v9 offset:128
    ds_read_b128 v[176:179], v9 offset:144
    ds_read_b64 v[180:181], v8 offset:256
    ds_read_b128 v[182:185], v9 offset:256
    ds_read_b128 v[186:189], v9 offset:272
    ds_read_b64 v[190:191], v8 offset:384
    ds_read_b128 v[192:195], v9 offset:384
    ds_read_b128 v[196:199], v9 offset:400
    ds_read_b64 v[200:201], v8 offset:512
    ds_read_b128 v[202:205], v9 offset:512
    ds_read_b128 v[206:209], v9 offset:528
    s_waitcnt lgkmcnt(0)
    s_waitcnt vmcnt(5)
    s_cmp_lg_u32 s3, 0
    s_cbranch_scc1 L_zc_skip
    s_mov_b64 exec, 0xffff
    s_mov_b32 s57, 100000
    v_cmp_ne_u32 vcc, 1, v216
    s_cbranch_vccz L_zchk_ok
L_zchk:
    buffer_load_dword v216, v221, s[88:91], 0 offen offset:0 sc1
    s_waitcnt vmcnt(0)
    v_cmp_ne_u32 vcc, 1, v216
    s_sub_u32 s57, s57, 1
    s_cbranch_scc1 L_zchk_ok
    s_cbranch_vccnz L_zchk
L_zchk_ok:
    s_mov_b64 exec, -1
L_zc_skip:
    s_barrier
    s_cmp_lg_u32 s3, 0
    s_cbranch_scc1 L_sig0_skip
    s_mov_b64 exec, 3
    v_mov_b32 v216, 1
    buffer_atomic_add v216, v218, s[8:11], 0 offen sc1
    s_mov_b64 exec, -1
L_sig0_skip:
    v_pk_fma_f32 v[28:29], v[160:161], v[22:23], v[28:29] op_sel:[1,0,0] op_sel_hi:[1,1,1]
    s_lshl_b32 s42, s19, 7
    v_pk_fma_f32 v[30:31], v[160:161], v[24:25], v[30:31] op_sel:[1,0,0] op_sel_hi:[1,1,1]
    v_pk_mul_f32 v[28:29], v[160:161], v[28:29] op_sel:[0,0] op_sel_hi:[0,1]
    v_pk_mul_f32 v[30:31], v[160:161], v[30:31] op_sel:[0,0] op_sel_hi:[0,1]
    v_cvt_pk_bf16_f32 v100, v28, v29
    v_cvt_pk_bf16_f32 v101, v30, v31
    s_lshl_b32 s43, s3, 17
    v_fmac_f32 v32, v163, v26
    v_fmac_f32 v33, v165, v26
    v_fmac_f32 v34, v167, v26
    v_fmac_f32 v35, v169, v26
    v_mul_f32 v32, v162, v32
    v_mul_f32 v33, v164, v33
    s_add_u32 s42, s42, s43
    v_mul_f32 v34, v166, v34
    v_mul_f32 v35, v168, v35
    v_cvt_pk_bf16_f32 v110, v32, v33
    v_cvt_pk_bf16_f32 v111, v34, v35
    v_pk_fma_f32 v[36:37], v[170:171], v[22:23], v[36:37] op_sel:[1,0,0] op_sel_hi:[1,1,1]
    v_pk_fma_f32 v[38:39], v[170:171], v[24:25], v[38:39] op_sel:[1,0,0] op_sel_hi:[1,1,1]
    s_lshl_b32 s43, s3, 14
    v_pk_fma_f32 v[44:45], v[170:171], v[18:19], v[44:45] op_sel:[1,0,0] op_sel_hi:[1,1,1]
    v_pk_fma_f32 v[46:47], v[170:171], v[20:21], v[46:47] op_sel:[1,0,0] op_sel_hi:[1,1,1]
    v_pk_mul_f32 v[36:37], v[170:171], v[36:37] op_sel:[0,0] op_sel_hi:[0,1]
    v_pk_mul_f32 v[38:39], v[170:171], v[38:39] op_sel:[0,0] op_sel_hi:[0,1]
    v_mul_f32 v128, s26, v170
    v_cvt_pk_bf16_f32 v120, v44, v45
    s_add_u32 s43, s43, 98304
    v_cvt_pk_bf16_f32 v121, v46, v47
    v_cvt_pk_bf16_f32 v102, v36, v37
    v_cvt_pk_bf16_f32 v103, v38, v39
    v_fmac_f32 v40, v173, v26
    v_fmac_f32 v41, v175, v26
    v_fmac_f32 v42, v177, v26
    s_mov_b32 m0, s43
    v_fmac_f32 v43, v179, v26
    v_mul_f32 v40, v172, v40
    v_mul_f32 v41, v174, v41
    v_mul_f32 v42, v176, v42
    v_mul_f32 v43, v178, v43
    v_cvt_pk_bf16_f32 v112, v40, v41
    buffer_load_dwordx4 v5, s[76:79], s42 offen offset:0 lds
    v_cvt_pk_bf16_f32 v113, v42, v43
    v_pk_fma_f32 v[48:49], v[180:181], v[22:23], v[48:49] op_sel:[1,0,0] op_sel_hi:[1,1,1]
    v_pk_fma_f32 v[50:51], v[180:181], v[24:25], v[50:51] op_sel:[1,0,0] op_sel_hi:[1,1,1]
    v_pk_fma_f32 v[56:57], v[180:181], v[18:19], v[56:57] op_sel:[1,0,0] op_sel_hi:[1,1,1]
    v_pk_fma_f32 v[58:59], v[180:181], v[20:21], v[58:59] op_sel:[1,0,0] op_sel_hi:[1,1,1]
    v_pk_mul_f32 v[48:49], v[180:181], v[48:49] op_sel:[0,0] op_sel_hi:[0,1]
    s_add_u32 s42, s42, 7168
    v_pk_mul_f32 v[50:51], v[180:181], v[50:51] op_sel:[0,0] op_sel_hi:[0,1]
    v_mul_f32 v129, s26, v180
    v_cvt_pk_bf16_f32 v122, v56, v57
    v_cvt_pk_bf16_f32 v123, v58, v59
    v_cvt_pk_bf16_f32 v104, v48, v49
    v_cvt_pk_bf16_f32 v105, v50, v51
    buffer_load_dwordx4 v5, s[76:79], s42 offen offset:1024 lds
    v_fmac_f32 v52, v183, v26
    v_fmac_f32 v53, v185, v26
    v_fmac_f32 v54, v187, v26
    v_fmac_f32 v55, v189, v26
    v_mul_f32 v52, v182, v52
    v_mul_f32 v53, v184, v53
    s_add_u32 s42, s42, 7168
    v_mul_f32 v54, v186, v54
    v_mul_f32 v55, v188, v55
    v_cvt_pk_bf16_f32 v114, v52, v53
    v_cvt_pk_bf16_f32 v115, v54, v55
    v_mfma_f32_16x16x16_bf16 v[28:31], v[100:101], v[120:121], 0
    v_mfma_f32_16x16x16_bf16 v[32:35], v[102:103], v[120:121], 0
    buffer_load_dwordx4 v5, s[76:79], s42 offen offset:2048 lds
    v_mfma_f32_16x16x16_bf16 v[36:39], v[102:103], v[122:123], 0
    v_mfma_f32_16x16x16_bf16 v[40:43], v[104:105], v[122:123], 0
    s_lshl_b32 s38, s16, 16
    s_lshl_b32 s39, s17, 10
    s_add_u32 s38, s38, s39
    s_add_u32 s38, s38, 0xa00000
    s_add_u32 s42, s42, 7168
    v_cndmask_b32 v44, v28, v29, s[28:29]
    v_cndmask_b32 v45, v30, v31, s[28:29]
    v_cndmask_b32 v46, v32, v33, s[28:29]
    v_cndmask_b32 v47, v34, v35, s[28:29]
    v_cndmask_b32 v48, v36, v37, s[28:29]
    v_cndmask_b32 v49, v38, v39, s[28:29]
    buffer_load_dwordx4 v5, s[76:79], s42 offen offset:3072 lds
    v_cndmask_b32 v50, v40, v41, s[28:29]
    v_cndmask_b32 v51, v42, v43, s[28:29]
    v_pk_fma_f32 v[44:45], v[44:45], v[128:129], v[14:15] op_sel:[0,0,0] op_sel_hi:[1,0,1]
    v_pk_fma_f32 v[46:47], v[46:47], v[128:129], v[12:13] op_sel:[0,0,0] op_sel_hi:[1,0,1]
    v_pk_fma_f32 v[48:49], v[48:49], v[128:129], v[10:11] op_sel:[0,1,0] op_sel_hi:[1,1,1]
    v_pk_fma_f32 v[50:51], v[50:51], v[128:129], v[12:13] op_sel:[0,1,0] op_sel_hi:[1,1,1]
    s_add_u32 s42, s42, 11264
    v_max3_f32 v142, v44, v45, v46
    v_max3_f32 v143, v48, v49, v50
    v_max_f32 v142, v142, v47
    v_max_f32 v143, v143, v51
    s_nop 1
    v_permlane16_swap_b32 v142, v143
    v_max_f32 v142, v142, v143
    s_add_u32 s43, s43, 4096
    v_mov_b32 v143, v142
    s_nop 1
    v_permlane32_swap_b32 v142, v143
    v_max_f32 v142, v142, v143
    v_mov_b32 v143, v142
    s_nop 1
    v_permlane16_swap_b32 v142, v143
    s_mov_b32 m0, s43
    v_pk_add_f32 v[44:45], v[44:45], v[142:143] op_sel:[0,0] op_sel_hi:[1,0] neg_lo:[0,1] neg_hi:[0,1]
    v_pk_add_f32 v[46:47], v[46:47], v[142:143] op_sel:[0,0] op_sel_hi:[1,0] neg_lo:[0,1] neg_hi:[0,1]
    v_pk_add_f32 v[48:49], v[48:49], v[142:143] op_sel:[0,1] op_sel_hi:[1,1] neg_lo:[0,1] neg_hi:[0,1]
    v_pk_add_f32 v[50:51], v[50:51], v[142:143] op_sel:[0,1] op_sel_hi:[1,1] neg_lo:[0,1] neg_hi:[0,1]
    v_exp_f32 v44, v44
    v_exp_f32 v45, v45
    buffer_load_dwordx4 v5, s[76:79], s42 offen offset:0 lds
    v_exp_f32 v46, v46
    v_exp_f32 v47, v47
    v_exp_f32 v48, v48
    v_exp_f32 v49, v49
    v_exp_f32 v50, v50
    v_exp_f32 v51, v51
    s_add_u32 s42, s42, 7168
    v_cvt_pk_bf16_f32 v28, v44, v45
    v_cvt_pk_bf16_f32 v29, v46, v47
    v_perm_b32 v52, v28, v28, v16
    v_perm_b32 v53, v28, v28, v17
    v_perm_b32 v54, v29, v29, v16
    v_perm_b32 v55, v29, v29, v17
    buffer_load_dwordx4 v5, s[76:79], s42 offen offset:1024 lds
    v_add_f32 v144, v44, v45
    v_add_f32 v46, v46, v47
    v_mfma_f32_16x16x32_bf16 v[146:149], v[110:113], v[52:55], 0
    v_add_f32 v144, v144, v46
    v_cvt_pk_bf16_f32 v36, v48, v49
    v_cvt_pk_bf16_f32 v37, v50, v51
    s_add_u32 s42, s42, 7168
    v_perm_b32 v56, v36, v36, v16
    v_perm_b32 v57, v36, v36, v17
    v_perm_b32 v58, v37, v37, v16
    v_perm_b32 v59, v37, v37, v17
    v_add_f32 v145, v48, v49
    v_add_f32 v50, v50, v51
    buffer_load_dwordx4 v5, s[76:79], s42 offen offset:2048 lds
    v_mfma_f32_16x16x32_bf16 v[150:153], v[112:115], v[56:59], 0
    v_add_f32 v145, v145, v50
    s_nop 1
    v_permlane16_swap_b32 v144, v145
    v_add_f32 v144, v144, v145
    v_mov_b32 v145, v144
    s_nop 1
    v_permlane32_swap_b32 v144, v145
    s_add_u32 s42, s42, 7168
    v_add_f32 v144, v144, v145
    v_rcp_f32 v144, v144
    s_nop 0
    v_mov_b32 v145, v144
    s_nop 1
    v_permlane16_swap_b32 v144, v145
    v_pk_mul_f32 v[146:147], v[146:147], v[144:145] op_sel:[0,0] op_sel_hi:[1,0]
    v_pk_mul_f32 v[148:149], v[148:149], v[144:145] op_sel:[0,0] op_sel_hi:[1,0]
    buffer_load_dwordx4 v5, s[76:79], s42 offen offset:3072 lds
    v_pk_mul_f32 v[150:151], v[150:151], v[144:145] op_sel:[0,1] op_sel_hi:[1,1]
    v_pk_mul_f32 v[152:153], v[152:153], v[144:145] op_sel:[0,1] op_sel_hi:[1,1]
    v_cvt_pk_bf16_f32 v154, v146, v147
    v_cvt_pk_bf16_f32 v155, v148, v149
    v_cvt_pk_bf16_f32 v156, v150, v151
    v_cvt_pk_bf16_f32 v157, v152, v153
    s_add_u32 s42, s42, 11264
    v_permlane16_swap_b32 v154, v156
    v_permlane16_swap_b32 v155, v157
    buffer_store_dwordx4 v[154:157], v1, s[8:11], s38 offen sc1
    v_pk_fma_f32 v[60:61], v[190:191], v[22:23], v[60:61] op_sel:[1,0,0] op_sel_hi:[1,1,1]
    v_pk_fma_f32 v[62:63], v[190:191], v[24:25], v[62:63] op_sel:[1,0,0] op_sel_hi:[1,1,1]
    v_pk_fma_f32 v[68:69], v[190:191], v[18:19], v[68:69] op_sel:[1,0,0] op_sel_hi:[1,1,1]
    s_add_u32 s43, s43, 4096
    v_pk_fma_f32 v[70:71], v[190:191], v[20:21], v[70:71] op_sel:[1,0,0] op_sel_hi:[1,1,1]
    v_pk_mul_f32 v[60:61], v[190:191], v[60:61] op_sel:[0,0] op_sel_hi:[0,1]
    v_pk_mul_f32 v[62:63], v[190:191], v[62:63] op_sel:[0,0] op_sel_hi:[0,1]
    v_mul_f32 v130, s26, v190
    v_cvt_pk_bf16_f32 v124, v68, v69
    v_cvt_pk_bf16_f32 v125, v70, v71
    s_mov_b32 m0, s43
    v_cvt_pk_bf16_f32 v106, v60, v61
    v_cvt_pk_bf16_f32 v107, v62, v63
    v_fmac_f32 v64, v193, v26
    v_fmac_f32 v65, v195, v26
    v_fmac_f32 v66, v197, v26
    v_fmac_f32 v67, v199, v26
    buffer_load_dwordx4 v5, s[76:79], s42 offen offset:0 lds
    v_mul_f32 v64, v192, v64
    v_mul_f32 v65, v194, v65
    v_mul_f32 v66, v196, v66
    v_mul_f32 v67, v198, v67
    v_cvt_pk_bf16_f32 v116, v64, v65
    v_cvt_pk_bf16_f32 v117, v66, v67
    s_add_u32 s42, s42, 7168
    v_pk_fma_f32 v[72:73], v[200:201], v[22:23], v[72:73] op_sel:[1,0,0] op_sel_hi:[1,1,1]
    v_pk_fma_f32 v[74:75], v[200:201], v[24:25], v[74:75] op_sel:[1,0,0] op_sel_hi:[1,1,1]
    v_pk_fma_f32 v[80:81], v[200:201], v[18:19], v[80:81] op_sel:[1,0,0] op_sel_hi:[1,1,1]
    v_pk_fma_f32 v[82:83], v[200:201], v[20:21], v[82:83] op_sel:[1,0,0] op_sel_hi:[1,1,1]
    v_pk_mul_f32 v[72:73], v[200:201], v[72:73] op_sel:[0,0] op_sel_hi:[0,1]
    v_pk_mul_f32 v[74:75], v[200:201], v[74:75] op_sel:[0,0] op_sel_hi:[0,1]
    buffer_load_dwordx4 v5, s[76:79], s42 offen offset:1024 lds
    v_mul_f32 v131, s26, v200
    v_cvt_pk_bf16_f32 v126, v80, v81
    v_cvt_pk_bf16_f32 v127, v82, v83
    v_cvt_pk_bf16_f32 v108, v72, v73
    v_cvt_pk_bf16_f32 v109, v74, v75
    s_add_u32 s42, s42, 7168
    v_fmac_f32 v76, v203, v26
    v_fmac_f32 v77, v205, v26
    v_fmac_f32 v78, v207, v26
    v_fmac_f32 v79, v209, v26
    v_mul_f32 v76, v202, v76
    v_mul_f32 v77, v204, v77
    buffer_load_dwordx4 v5, s[76:79], s42 offen offset:2048 lds
    v_mul_f32 v78, v206, v78
    v_mul_f32 v79, v208, v79
    v_cvt_pk_bf16_f32 v118, v76, v77
    v_cvt_pk_bf16_f32 v119, v78, v79
    v_mfma_f32_16x16x16_bf16 v[28:31], v[104:105], v[124:125], 0
    v_mfma_f32_16x16x16_bf16 v[32:35], v[106:107], v[124:125], 0
    s_add_u32 s42, s42, 7168
    v_mfma_f32_16x16x16_bf16 v[36:39], v[106:107], v[126:127], 0
    v_mfma_f32_16x16x16_bf16 v[40:43], v[108:109], v[126:127], 0
    s_add_u32 s38, s38, 32768
    s_nop 2
    v_cndmask_b32 v44, v28, v29, s[28:29]
    v_cndmask_b32 v45, v30, v31, s[28:29]
    v_cndmask_b32 v46, v32, v33, s[28:29]
    buffer_load_dwordx4 v5, s[76:79], s42 offen offset:3072 lds
    v_cndmask_b32 v47, v34, v35, s[28:29]
    v_cndmask_b32 v48, v36, v37, s[28:29]
    v_cndmask_b32 v49, v38, v39, s[28:29]
    v_cndmask_b32 v50, v40, v41, s[28:29]
    v_cndmask_b32 v51, v42, v43, s[28:29]
    v_pk_fma_f32 v[44:45], v[44:45], v[130:131], v[10:11] op_sel:[0,0,0] op_sel_hi:[1,0,1]
    s_add_u32 s42, s42, 11264
    v_pk_fma_f32 v[46:47], v[46:47], v[130:131], v[12:13] op_sel:[0,0,0] op_sel_hi:[1,0,1]
    v_pk_fma_f32 v[48:49], v[48:49], v[130:131], v[10:11] op_sel:[0,1,0] op_sel_hi:[1,1,1]
    v_pk_fma_f32 v[50:51], v[50:51], v[130:131], v[12:13] op_sel:[0,1,0] op_sel_hi:[1,1,1]
    v_max3_f32 v142, v44, v45, v46
    v_max3_f32 v143, v48, v49, v50
    v_max_f32 v142, v142, v47
    s_add_u32 s43, s43, 4096
    v_max_f32 v143, v143, v51
    s_nop 1
    v_permlane16_swap_b32 v142, v143
    v_max_f32 v142, v142, v143
    v_mov_b32 v143, v142
    s_nop 1
    v_permlane32_swap_b32 v142, v143
    v_max_f32 v142, v142, v143
    s_mov_b32 m0, s43
    v_mov_b32 v143, v142
    s_nop 1
    v_permlane16_swap_b32 v142, v143
    v_pk_add_f32 v[44:45], v[44:45], v[142:143] op_sel:[0,0] op_sel_hi:[1,0] neg_lo:[0,1] neg_hi:[0,1]
    v_pk_add_f32 v[46:47], v[46:47], v[142:143] op_sel:[0,0] op_sel_hi:[1,0] neg_lo:[0,1] neg_hi:[0,1]
    v_pk_add_f32 v[48:49], v[48:49], v[142:143] op_sel:[0,1] op_sel_hi:[1,1] neg_lo:[0,1] neg_hi:[0,1]
    v_pk_add_f32 v[50:51], v[50:51], v[142:143] op_sel:[0,1] op_sel_hi:[1,1] neg_lo:[0,1] neg_hi:[0,1]
    buffer_load_dwordx4 v5, s[76:79], s42 offen offset:0 lds
    v_exp_f32 v44, v44
    v_exp_f32 v45, v45
    v_exp_f32 v46, v46
    v_exp_f32 v47, v47
    v_exp_f32 v48, v48
    v_exp_f32 v49, v49
    s_add_u32 s42, s42, 7168
    v_exp_f32 v50, v50
    v_exp_f32 v51, v51
    v_cvt_pk_bf16_f32 v28, v44, v45
    v_cvt_pk_bf16_f32 v29, v46, v47
    v_perm_b32 v52, v28, v28, v16
    v_perm_b32 v53, v28, v28, v17
    buffer_load_dwordx4 v5, s[76:79], s42 offen offset:1024 lds
    v_perm_b32 v54, v29, v29, v16
    v_perm_b32 v55, v29, v29, v17
    v_add_f32 v144, v44, v45
    v_add_f32 v46, v46, v47
    v_mfma_f32_16x16x32_bf16 v[146:149], v[114:117], v[52:55], 0
    v_add_f32 v144, v144, v46
    s_add_u32 s42, s42, 7168
    v_cvt_pk_bf16_f32 v36, v48, v49
    v_cvt_pk_bf16_f32 v37, v50, v51
    v_perm_b32 v56, v36, v36, v16
    v_perm_b32 v57, v36, v36, v17
    v_perm_b32 v58, v37, v37, v16
    v_perm_b32 v59, v37, v37, v17
    buffer_load_dwordx4 v5, s[76:79], s42 offen offset:2048 lds
    v_add_f32 v145, v48, v49
    v_add_f32 v50, v50, v51
    v_mfma_f32_16x16x32_bf16 v[150:153], v[116:119], v[56:59], 0
    v_add_f32 v145, v145, v50
    s_nop 1
    v_permlane16_swap_b32 v144, v145
    v_add_f32 v144, v144, v145
    s_add_u32 s42, s42, 7168
    v_mov_b32 v145, v144
    s_nop 1
    v_permlane32_swap_b32 v144, v145
    v_add_f32 v144, v144, v145
    v_rcp_f32 v144, v144
    s_nop 0
    v_mov_b32 v145, v144
    s_nop 1
    v_permlane16_swap_b32 v144, v145
    buffer_load_dwordx4 v5, s[76:79], s42 offen offset:3072 lds
    v_pk_mul_f32 v[146:147], v[146:147], v[144:145] op_sel:[0,0] op_sel_hi:[1,0]
    v_pk_mul_f32 v[148:149], v[148:149], v[144:145] op_sel:[0,0] op_sel_hi:[1,0]
    v_pk_mul_f32 v[150:151], v[150:151], v[144:145] op_sel:[0,1] op_sel_hi:[1,1]
    v_pk_mul_f32 v[152:153], v[152:153], v[144:145] op_sel:[0,1] op_sel_hi:[1,1]
    v_cvt_pk_bf16_f32 v154, v146, v147
    v_cvt_pk_bf16_f32 v155, v148, v149
    v_cvt_pk_bf16_f32 v156, v150, v151
    v_cvt_pk_bf16_f32 v157, v152, v153
    s_nop 0
    v_permlane16_swap_b32 v154, v156
    v_permlane16_swap_b32 v155, v157
    buffer_store_dwordx4 v[154:157], v1, s[8:11], s38 offen sc1
    s_lshl_b32 s38, s3, 14
    s_add_u32 s38, s38, 98304
    v_lshrrev_b32 v11, 5, v0
    v_bfe_u32 v15, v0, 2, 2
L_pad11520:
    s_cbranch_execz L_ret_top
    v_lshl_add_u32 v12, v11, 3, v15
    v_lshlrev_b32 v12, 7, v12
    v_bfe_u32 v15, v0, 3, 1
    v_lshl_add_u32 v12, v15, 6, v12
    v_and_b32 v15, 3, v0
    v_lshl_add_u32 v12, v15, 4, v12
    v_bfe_u32 v15, v0, 4, 1
    v_lshl_add_u32 v12, v15, 3, v12
    v_add_u32 v12, s38, v12
    v_xor_b32 v13, 64, v12
    v_lshlrev_b32 v14, 10, v15
    v_lshl_add_u32 v14, v11, 8, v14
    v_and_b32 v15, 15, v0
    v_lshl_add_u32 v14, v15, 4, v14
    v_add_u32 v14, s38, v14
    s_waitcnt vmcnt(1)
    ds_read_b64_tr_b16 v[28:29], v12 offset:0
    ds_read_b64_tr_b16 v[30:31], v12 offset:512
    ds_read_b64_tr_b16 v[32:33], v13 offset:0
    ds_read_b64_tr_b16 v[34:35], v13 offset:512
    ds_read_b64_tr_b16 v[36:37], v12 offset:2048
    ds_read_b64_tr_b16 v[38:39], v12 offset:2560
    ds_read_b64_tr_b16 v[40:41], v13 offset:2048
    ds_read_b64_tr_b16 v[42:43], v13 offset:2560
    ds_read_b64_tr_b16 v[44:45], v12 offset:4096
    ds_read_b64_tr_b16 v[46:47], v12 offset:4608
    ds_read_b64_tr_b16 v[48:49], v13 offset:4096
    ds_read_b64_tr_b16 v[50:51], v13 offset:4608
    ds_read_b64_tr_b16 v[52:53], v12 offset:6144
    ds_read_b64_tr_b16 v[54:55], v12 offset:6656
    ds_read_b64_tr_b16 v[56:57], v13 offset:6144
    ds_read_b64_tr_b16 v[58:59], v13 offset:6656
    ds_read_b64_tr_b16 v[60:61], v12 offset:8192
    ds_read_b64_tr_b16 v[62:63], v12 offset:8704
    ds_read_b64_tr_b16 v[64:65], v13 offset:8192
    ds_read_b64_tr_b16 v[66:67], v13 offset:8704
    ds_read_b64_tr_b16 v[68:69], v12 offset:10240
    ds_read_b64_tr_b16 v[70:71], v12 offset:10752
    ds_read_b64_tr_b16 v[72:73], v13 offset:10240
    ds_read_b64_tr_b16 v[74:75], v13 offset:10752
    ds_read_b64_tr_b16 v[76:77], v12 offset:12288
    ds_read_b64_tr_b16 v[78:79], v12 offset:12800
    ds_read_b64_tr_b16 v[80:81], v13 offset:12288
    ds_read_b64_tr_b16 v[82:83], v13 offset:12800
    ds_read_b64_tr_b16 v[84:85], v12 offset:14336
    ds_read_b64_tr_b16 v[86:87], v12 offset:14848
    ds_read_b64_tr_b16 v[88:89], v13 offset:14336
    ds_read_b64_tr_b16 v[90:91], v13 offset:14848
    s_waitcnt lgkmcnt(0)
    s_mov_b64 exec, 15
    buffer_load_dword v216, v254, s[8:11], 0 offen sc1
    s_mov_b64 exec, -1
    s_lshl_b32 s30, s16, 8
    s_add_u32 s30, s30, 0x2300000
    v_mov_b32 v3, 1
    s_waitcnt vmcnt(1)
    s_barrier
    s_cmp_lg_u32 s3, 0
    s_cbranch_scc1 L_sg1
    s_mov_b64 exec, 1
    buffer_atomic_add v3, off, s[8:11], s30 sc1
    s_mov_b64 exec, -1
L_sg1:
    s_mov_b32 s16, s100
    s_lshl_b32 s17, s101, 2
    s_add_u32 s17, s17, s3
    ds_write_b128 v14, v[28:31] offset:0
    ds_write_b128 v14, v[32:35] offset:2048
    ds_write_b128 v14, v[36:39] offset:512
    ds_write_b128 v14, v[40:43] offset:2560
    ds_write_b128 v14, v[44:47] offset:4096
    ds_write_b128 v14, v[48:51] offset:6144
    ds_write_b128 v14, v[52:55] offset:4608
    ds_write_b128 v14, v[56:59] offset:6656
    ds_write_b128 v14, v[60:63] offset:8192
    ds_write_b128 v14, v[64:67] offset:10240
    ds_write_b128 v14, v[68:71] offset:8704
    ds_write_b128 v14, v[72:75] offset:10752
    ds_write_b128 v14, v[76:79] offset:12288
    ds_write_b128 v14, v[80:83] offset:14336
    ds_write_b128 v14, v[84:87] offset:12800
    ds_write_b128 v14, v[88:91] offset:14848
    s_waitcnt vmcnt(0)
    s_cmp_lg_u32 s3, 0
    s_cbranch_scc1 L_g0_skip
    s_mov_b64 exec, 15
    s_mov_b32 s57, 100000
    v_cmp_ne_u32 vcc, v255, v216
    s_cbranch_vccz L_g0_ok
L_g0:
    buffer_load_dword v216, v254, s[8:11], 0 offen sc1
    s_waitcnt vmcnt(0)
    v_cmp_ne_u32 vcc, v255, v216
    s_sub_u32 s57, s57, 1
    s_cbranch_scc1 L_g0_ok
    s_cbranch_vccnz L_g0
L_g0_ok:
    s_mov_b64 exec, -1
L_g0_skip:
    s_barrier
    v_add_u32 v8, 98304, v1
    s_lshr_b32 s30, s3, 1
    s_lshl_b32 s31, s18, 1
    s_add_u32 s30, s30, s31
    s_lshl_b32 s30, s30, 15
    s_and_b32 s31, s3, 1
    s_lshl_b32 s31, s31, 8
    s_add_u32 s30, s30, s31
    s_add_u32 s31, s30, 0xa00000
    s_lshl_b32 s32, s19, 12
    s_add_u32 s30, s30, s32
    s_add_u32 s32, s30, 0x800000
    s_add_u32 s33, s30, 0xc00000
    s_lshl_b32 s34, s18, 8
    s_add_u32 s35, s34, 0x2304000
    s_add_u32 s34, s34, 0x2300000
    s_lshl_b32 s36, s18, 2
    s_add_u32 s36, s36, s3
    s_lshl_b32 s36, s36, 10
    s_lshl_b32 s37, s19, 7
    s_add_u32 s36, s36, s37
    s_add_u32 s36, s36, 0x2280000
    v_bfe_u32 v9, v0, 4, 1
    v_lshlrev_b32 v9, 2, v9
    v_and_b32 v10, 15, v0
    v_lshl_add_u32 v9, v10, 3, v9
    v_lshlrev_b32 v10, 10, v10
    v_lshrrev_b32 v11, 4, v0
    v_lshl_add_u32 v10, v11, 4, v10
    s_lshl_b32 s32, s18, 2
    s_add_u32 s32, s32, s3
    s_lshl_b32 s32, s32, 14
    s_lshl_b32 s37, s19, 7
    s_add_u32 s32, s32, s37
    buffer_load_dwordx4 v[92:95], v10, s[60:63], s32 offen
    buffer_load_dwordx4 v[96:99], v10, s[60:63], s32 offen offset:64
    s_mul_i32 s44, s21, 229376
    s_lshl_b32 s45, s3, 13
    s_add_u32 s44, s44, s45
    s_add_u32 m0, s45, 0
    s_add_u32 s47, s44, 0x200000
    buffer_load_dwordx4 v1, s[8:11], s47 offen offset:0 sc1 lds
    buffer_load_dwordx4 v1, s[8:11], s47 offen offset:1024 sc1 lds
    buffer_load_dwordx4 v1, s[8:11], s47 offen offset:2048 sc1 lds
    buffer_load_dwordx4 v1, s[8:11], s47 offen offset:3072 sc1 lds
    s_add_u32 m0, s45, 4096
    s_add_u32 s47, s44, 0x201000
    buffer_load_dwordx4 v1, s[8:11], s47 offen offset:0 sc1 lds
    buffer_load_dwordx4 v1, s[8:11], s47 offen offset:1024 sc1 lds
    buffer_load_dwordx4 v1, s[8:11], s47 offen offset:2048 sc1 lds
    buffer_load_dwordx4 v1, s[8:11], s47 offen offset:3072 sc1 lds
    s_add_u32 m0, s45, 32768
    s_add_u32 s47, s44, 0x208000
    buffer_load_dwordx4 v1, s[8:11], s47 offen offset:0 sc1 lds
    buffer_load_dwordx4 v1, s[8:11], s47 offen offset:1024 sc1 lds
    s_cmp_lg_u32 s3, 0
    s_cbranch_scc1 L_ap2
    s_load_dword s64, s[4:5], s34 glc
L_ap2:
    buffer_load_dwordx4 v1, s[8:11], s47 offen offset:2048 sc1 lds
    buffer_load_dwordx4 v1, s[8:11], s47 offen offset:3072 sc1 lds
    s_add_u32 m0, s45, 36864
    s_add_u32 s47, s44, 0x209000
    buffer_load_dwordx4 v1, s[8:11], s47 offen offset:0 sc1 lds
    buffer_load_dwordx4 v1, s[8:11], s47 offen offset:1024 sc1 lds
    buffer_load_dwordx4 v1, s[8:11], s47 offen offset:2048 sc1 lds
    buffer_load_dwordx4 v1, s[8:11], s47 offen offset:3072 sc1 lds
    s_waitcnt lgkmcnt(0)
    s_cmp_lg_u32 s3, 0
    s_cbranch_scc1 L_pw_done3
    s_mov_b32 s57, 100000
    s_waitcnt lgkmcnt(0)
    s_cmp_eq_u32 s64, 8
    s_cbranch_scc1 L_pw_done3
L_pw3:
    s_load_dword s64, s[4:5], s34 glc
    s_sub_u32 s57, s57, 1
    s_cbranch_scc1 L_pw_done3
    s_waitcnt lgkmcnt(0)
    s_cmp_lg_u32 s64, 8
    s_cbranch_scc1 L_pw3
L_pw_done3:
    s_barrier
    buffer_load_dwordx4 v[28:31], v7, s[8:11], s31 offen offset:0 sc1
    buffer_load_dwordx4 v[32:35], v7, s[8:11], s31 offen offset:2048 sc1
    s_add_u32 s31, s31, 4096
    buffer_load_dwordx4 v[36:39], v7, s[8:11], s31 offen offset:0 sc1
    buffer_load_dwordx4 v[40:43], v7, s[8:11], s31 offen offset:2048 sc1
    s_add_u32 s31, s31, 4096
    buffer_load_dwordx4 v[44:47], v7, s[8:11], s31 offen offset:0 sc1
    buffer_load_dwordx4 v[48:51], v7, s[8:11], s31 offen offset:2048 sc1
    s_add_u32 s31, s31, 4096
    buffer_load_dwordx4 v[52:55], v7, s[8:11], s31 offen offset:0 sc1
    buffer_load_dwordx4 v[56:59], v7, s[8:11], s31 offen offset:2048 sc1
    s_add_u32 s31, s31, 4096
    buffer_load_dwordx4 v[60:63], v7, s[8:11], s31 offen offset:0 sc1
    buffer_load_dwordx4 v[64:67], v7, s[8:11], s31 offen offset:2048 sc1
    s_mov_b64 exec, 0
    s_cmp_eq_u32 s3, 0
    s_cbranch_scc1 L_pad19712
    s_cmp_eq_u32 s3, 1
    s_cbranch_scc1 L_pad23808
    s_cmp_eq_u32 s3, 2
    s_cbranch_scc1 L_pad27904
    s_cmp_eq_u32 s3, 3
    s_cbranch_scc1 L_pad32000
L_ret_p2s0:
    s_mov_b64 exec, -1
    s_waitcnt vmcnt(27)
    v_lshlrev_b32 v100, 16, v92
    v_and_b32 v101, 0xffff0000, v92
    v_lshlrev_b32 v102, 16, v93
    v_and_b32 v103, 0xffff0000, v93
    v_lshlrev_b32 v104, 16, v94
    v_and_b32 v105, 0xffff0000, v94
    v_lshlrev_b32 v106, 16, v95
    v_and_b32 v107, 0xffff0000, v95
    s_waitcnt vmcnt(26)
    v_lshlrev_b32 v108, 16, v96
    v_and_b32 v109, 0xffff0000, v96
    v_lshlrev_b32 v110, 16, v97
    v_and_b32 v111, 0xffff0000, v97
    v_lshlrev_b32 v112, 16, v98
    v_and_b32 v113, 0xffff0000, v98
    v_lshlrev_b32 v114, 16, v99
    v_and_b32 v115, 0xffff0000, v99
    ds_read_b128 v[116:119], v8 offset:0
    ds_read_b128 v[120:123], v8 offset:1024
    ds_read_b128 v[124:127], v8 offset:2048
    ds_read_b128 v[128:131], v8 offset:3072
    ds_read_b128 v[132:135], v8 offset:4096
    ds_read_b128 v[136:139], v8 offset:5120
    s_waitcnt lgkmcnt(4)
    s_waitcnt vmcnt(9)
    v_mfma_f32_16x16x32_bf16 v[100:103], v[116:119], v[28:31], v[100:103]
    ds_read_b128 v[140:143], v8 offset:6144
    s_add_u32 s31, s31, 4096
    buffer_load_dwordx4 v[68:71], v7, s[8:11], s31 offen offset:0 sc1
    v_mfma_f32_16x16x32_bf16 v[104:107], v[120:123], v[28:31], v[104:107]
    ds_read_b128 v[144:147], v8 offset:7168
    s_waitcnt lgkmcnt(5)
    v_mfma_f32_16x16x32_bf16 v[108:111], v[124:127], v[28:31], v[108:111]
    ds_read_b128 v[116:119], v8 offset:8192
    s_waitcnt lgkmcnt(5)
    v_mfma_f32_16x16x32_bf16 v[112:115], v[128:131], v[28:31], v[112:115]
    ds_read_b128 v[120:123], v8 offset:9216
    s_waitcnt vmcnt(9) lgkmcnt(5)
    v_mfma_f32_16x16x32_bf16 v[100:103], v[132:135], v[32:35], v[100:103]
    ds_read_b128 v[124:127], v8 offset:10240
    buffer_load_dwordx4 v[72:75], v7, s[8:11], s31 offen offset:2048 sc1
    s_waitcnt lgkmcnt(5)
    v_mfma_f32_16x16x32_bf16 v[104:107], v[136:139], v[32:35], v[104:107]
    ds_read_b128 v[128:131], v8 offset:11264
    s_waitcnt lgkmcnt(5)
    v_mfma_f32_16x16x32_bf16 v[108:111], v[140:143], v[32:35], v[108:111]
    ds_read_b128 v[132:135], v8 offset:12288
    s_waitcnt lgkmcnt(5)
    v_mfma_f32_16x16x32_bf16 v[112:115], v[144:147], v[32:35], v[112:115]
    ds_read_b128 v[136:139], v8 offset:13312
    s_waitcnt vmcnt(9) lgkmcnt(5)
    v_mfma_f32_16x16x32_bf16 v[100:103], v[116:119], v[36:39], v[100:103]
    ds_read_b128 v[140:143], v8 offset:14336
    s_add_u32 s31, s31, 4096
    buffer_load_dwordx4 v[76:79], v7, s[8:11], s31 offen offset:0 sc1
    s_waitcnt lgkmcnt(5)
    v_mfma_f32_16x16x32_bf16 v[104:107], v[120:123], v[36:39], v[104:107]
    ds_read_b128 v[144:147], v8 offset:15360
    s_waitcnt lgkmcnt(5)
    v_mfma_f32_16x16x32_bf16 v[108:111], v[124:127], v[36:39], v[108:111]
    ds_read_b128 v[116:119], v8 offset:16384
    s_waitcnt lgkmcnt(5)
    v_mfma_f32_16x16x32_bf16 v[112:115], v[128:131], v[36:39], v[112:115]
    ds_read_b128 v[120:123], v8 offset:17408
    s_waitcnt vmcnt(9) lgkmcnt(5)
    v_mfma_f32_16x16x32_bf16 v[100:103], v[132:135], v[40:43], v[100:103]
    ds_read_b128 v[124:127], v8 offset:18432
    buffer_load_dwordx4 v[80:83], v7, s[8:11], s31 offen offset:2048 sc1
    s_waitcnt lgkmcnt(5)
    v_mfma_f32_16x16x32_bf16 v[104:107], v[136:139], v[40:43], v[104:107]
    ds_read_b128 v[128:131], v8 offset:19456
    s_waitcnt lgkmcnt(5)
    v_mfma_f32_16x16x32_bf16 v[108:111], v[140:143], v[40:43], v[108:111]
    ds_read_b128 v[132:135], v8 offset:20480
    s_waitcnt lgkmcnt(5)
    v_mfma_f32_16x16x32_bf16 v[112:115], v[144:147], v[40:43], v[112:115]
    ds_read_b128 v[136:139], v8 offset:21504
    s_waitcnt lgkmcnt(4)
    s_waitcnt vmcnt(9)
    v_mfma_f32_16x16x32_bf16 v[100:103], v[116:119], v[44:47], v[100:103]
    ds_read_b128 v[140:143], v8 offset:22528
    s_add_u32 s31, s31, 4096
    buffer_load_dwordx4 v[84:87], v7, s[8:11], s31 offen offset:0 sc1
    v_mfma_f32_16x16x32_bf16 v[104:107], v[120:123], v[44:47], v[104:107]
    ds_read_b128 v[144:147], v8 offset:23552
    s_waitcnt lgkmcnt(4)
    v_mfma_f32_16x16x32_bf16 v[108:111], v[124:127], v[44:47], v[108:111]
    ds_read_b128 v[116:119], v8 offset:24576
    v_mfma_f32_16x16x32_bf16 v[112:115], v[128:131], v[44:47], v[112:115]
    ds_read_b128 v[120:123], v8 offset:25600
    s_waitcnt lgkmcnt(4)
    s_waitcnt vmcnt(9)
    v_mfma_f32_16x16x32_bf16 v[100:103], v[132:135], v[48:51], v[100:103]
    ds_read_b128 v[124:127], v8 offset:26624
    buffer_load_dwordx4 v[88:91], v7, s[8:11], s31 offen offset:2048 sc1
    v_mfma_f32_16x16x32_bf16 v[104:107], v[136:139], v[48:51], v[104:107]
    ds_read_b128 v[128:131], v8 offset:27648
    s_waitcnt lgkmcnt(4)
    v_mfma_f32_16x16x32_bf16 v[108:111], v[140:143], v[48:51], v[108:111]
    ds_read_b128 v[132:135], v8 offset:28672
    v_mfma_f32_16x16x32_bf16 v[112:115], v[144:147], v[48:51], v[112:115]
    ds_read_b128 v[136:139], v8 offset:29696
    s_waitcnt lgkmcnt(4)
    s_waitcnt vmcnt(9)
    v_mfma_f32_16x16x32_bf16 v[100:103], v[116:119], v[52:55], v[100:103]
    ds_read_b128 v[140:143], v8 offset:30720
    v_mfma_f32_16x16x32_bf16 v[104:107], v[120:123], v[52:55], v[104:107]
    ds_read_b128 v[144:147], v8 offset:31744
    s_waitcnt lgkmcnt(4)
    v_mfma_f32_16x16x32_bf16 v[108:111], v[124:127], v[52:55], v[108:111]
    ds_read_b128 v[116:119], v8 offset:32768
    v_mfma_f32_16x16x32_bf16 v[112:115], v[128:131], v[52:55], v[112:115]
    ds_read_b128 v[120:123], v8 offset:33792
    s_waitcnt lgkmcnt(4)
    s_waitcnt vmcnt(8)
    v_mfma_f32_16x16x32_bf16 v[100:103], v[132:135], v[56:59], v[100:103]
    ds_read_b128 v[124:127], v8 offset:34816
    v_mfma_f32_16x16x32_bf16 v[104:107], v[136:139], v[56:59], v[104:107]
    ds_read_b128 v[128:131], v8 offset:35840
    s_waitcnt lgkmcnt(4)
    v_mfma_f32_16x16x32_bf16 v[108:111], v[140:143], v[56:59], v[108:111]
    ds_read_b128 v[132:135], v8 offset:36864
    s_add_u32 m0, s45, 65536
    s_add_u32 s47, s44, 0x210000
    buffer_load_dwordx4 v1, s[8:11], s47 offen offset:0 sc1 lds
    v_mfma_f32_16x16x32_bf16 v[112:115], v[144:147], v[56:59], v[112:115]
    ds_read_b128 v[136:139], v8 offset:37888
    s_waitcnt lgkmcnt(4)
    s_waitcnt vmcnt(8)
    v_mfma_f32_16x16x32_bf16 v[100:103], v[116:119], v[60:63], v[100:103]
    ds_read_b128 v[140:143], v8 offset:38912
    v_mfma_f32_16x16x32_bf16 v[104:107], v[120:123], v[60:63], v[104:107]
    ds_read_b128 v[144:147], v8 offset:39936
    buffer_load_dwordx4 v1, s[8:11], s47 offen offset:1024 sc1 lds
    s_waitcnt lgkmcnt(4)
    v_mfma_f32_16x16x32_bf16 v[108:111], v[124:127], v[60:63], v[108:111]
    ds_read_b128 v[116:119], v8 offset:40960
    v_mfma_f32_16x16x32_bf16 v[112:115], v[128:131], v[60:63], v[112:115]
    ds_read_b128 v[120:123], v8 offset:41984
    buffer_load_dwordx4 v1, s[8:11], s47 offen offset:2048 sc1 lds
    s_waitcnt lgkmcnt(4)
    s_waitcnt vmcnt(9)
    v_mfma_f32_16x16x32_bf16 v[100:103], v[132:135], v[64:67], v[100:103]
    ds_read_b128 v[124:127], v8 offset:43008
    v_mfma_f32_16x16x32_bf16 v[104:107], v[136:139], v[64:67], v[104:107]
    ds_read_b128 v[128:131], v8 offset:44032
    s_waitcnt lgkmcnt(4)
    v_mfma_f32_16x16x32_bf16 v[108:111], v[140:143], v[64:67], v[108:111]
    ds_read_b128 v[132:135], v8 offset:45056
    buffer_load_dwordx4 v1, s[8:11], s47 offen offset:3072 sc1 lds
    v_mfma_f32_16x16x32_bf16 v[112:115], v[144:147], v[64:67], v[112:115]
    ds_read_b128 v[136:139], v8 offset:46080
    s_waitcnt lgkmcnt(4)
    s_waitcnt vmcnt(9)
    v_mfma_f32_16x16x32_bf16 v[100:103], v[116:119], v[68:71], v[100:103]
    ds_read_b128 v[140:143], v8 offset:47104
    v_mfma_f32_16x16x32_bf16 v[104:107], v[120:123], v[68:71], v[104:107]
    ds_read_b128 v[144:147], v8 offset:48128
    s_add_u32 m0, s45, 69632
    s_add_u32 s47, s44, 0x211000
    buffer_load_dwordx4 v1, s[8:11], s47 offen offset:0 sc1 lds
    s_waitcnt lgkmcnt(4)
    v_mfma_f32_16x16x32_bf16 v[108:111], v[124:127], v[68:71], v[108:111]
    ds_read_b128 v[116:119], v8 offset:49152
    v_mfma_f32_16x16x32_bf16 v[112:115], v[128:131], v[68:71], v[112:115]
    ds_read_b128 v[120:123], v8 offset:50176
    buffer_load_dwordx4 v1, s[8:11], s47 offen offset:1024 sc1 lds
    s_waitcnt lgkmcnt(4)
    s_waitcnt vmcnt(10)
    v_mfma_f32_16x16x32_bf16 v[100:103], v[132:135], v[72:75], v[100:103]
    ds_read_b128 v[124:127], v8 offset:51200
    v_mfma_f32_16x16x32_bf16 v[104:107], v[136:139], v[72:75], v[104:107]
    ds_read_b128 v[128:131], v8 offset:52224
    s_waitcnt lgkmcnt(4)
    v_mfma_f32_16x16x32_bf16 v[108:111], v[140:143], v[72:75], v[108:111]
    ds_read_b128 v[132:135], v8 offset:53248
    buffer_load_dwordx4 v1, s[8:11], s47 offen offset:2048 sc1 lds
    v_mfma_f32_16x16x32_bf16 v[112:115], v[144:147], v[72:75], v[112:115]
    ds_read_b128 v[136:139], v8 offset:54272
    s_waitcnt lgkmcnt(4)
    s_waitcnt vmcnt(10)
    v_mfma_f32_16x16x32_bf16 v[100:103], v[116:119], v[76:79], v[100:103]
    ds_read_b128 v[140:143], v8 offset:55296
    v_mfma_f32_16x16x32_bf16 v[104:107], v[120:123], v[76:79], v[104:107]
    ds_read_b128 v[144:147], v8 offset:56320
    buffer_load_dwordx4 v1, s[8:11], s47 offen offset:3072 sc1 lds
    s_waitcnt lgkmcnt(4)
    v_mfma_f32_16x16x32_bf16 v[108:111], v[124:127], v[76:79], v[108:111]
    ds_read_b128 v[116:119], v8 offset:57344
    v_mfma_f32_16x16x32_bf16 v[112:115], v[128:131], v[76:79], v[112:115]
    ds_read_b128 v[120:123], v8 offset:58368
    s_lshl_b32 s49, s23, 1
    s_and_b32 s50, s3, 1
    s_add_u32 s49, s49, s50
    s_xor_b32 s50, s49, 1
    s_mul_i32 s51, s3, 28672
    s_mul_i32 s49, s49, 114688
    s_mul_i32 s50, s50, 114688
    s_add_u32 s49, s49, s51
    s_add_u32 s50, s50, s51
    s_add_u32 s51, s49, 0x580800
    buffer_load_dwordx4 a[0:3], v1, s[8:11], s51 offen sc1
    s_waitcnt lgkmcnt(4)
    s_waitcnt vmcnt(11)
    v_mfma_f32_16x16x32_bf16 v[100:103], v[132:135], v[80:83], v[100:103]
    ds_read_b128 v[124:127], v8 offset:59392
    v_mfma_f32_16x16x32_bf16 v[104:107], v[136:139], v[80:83], v[104:107]
    ds_read_b128 v[128:131], v8 offset:60416
    s_waitcnt lgkmcnt(4)
    v_mfma_f32_16x16x32_bf16 v[108:111], v[140:143], v[80:83], v[108:111]
    ds_read_b128 v[132:135], v8 offset:61440
    s_add_u32 s51, s50, 0x580800
    buffer_load_dwordx4 a[4:7], v1, s[8:11], s51 offen sc1
    v_mfma_f32_16x16x32_bf16 v[112:115], v[144:147], v[80:83], v[112:115]
    ds_read_b128 v[136:139], v8 offset:62464
    s_waitcnt lgkmcnt(4)
    s_waitcnt vmcnt(11)
    v_mfma_f32_16x16x32_bf16 v[100:103], v[116:119], v[84:87], v[100:103]
    ds_read_b128 v[140:143], v8 offset:63488
    v_mfma_f32_16x16x32_bf16 v[104:107], v[120:123], v[84:87], v[104:107]
    ds_read_b128 v[144:147], v8 offset:64512
    s_add_u32 s51, s49, 0x582400
    buffer_load_dwordx4 a[8:11], v1, s[8:11], s51 offen sc1
    s_waitcnt lgkmcnt(4)
    v_mfma_f32_16x16x32_bf16 v[108:111], v[124:127], v[84:87], v[108:111]
    v_mfma_f32_16x16x32_bf16 v[112:115], v[128:131], v[84:87], v[112:115]
    s_add_u32 s51, s50, 0x582400
    buffer_load_dwordx4 a[12:15], v1, s[8:11], s51 offen sc1
    s_waitcnt lgkmcnt(2)
    s_waitcnt vmcnt(12)
    v_mfma_f32_16x16x32_bf16 v[100:103], v[132:135], v[88:91], v[100:103]
    v_mfma_f32_16x16x32_bf16 v[104:107], v[136:139], v[88:91], v[104:107]
    s_waitcnt lgkmcnt(0)
    v_mfma_f32_16x16x32_bf16 v[108:111], v[140:143], v[88:91], v[108:111]
    v_mfma_f32_16x16x32_bf16 v[112:115], v[144:147], v[88:91], v[112:115]
    s_nop 3
    v_cvt_pk_bf16_f32 v148, v100, v101
    v_cvt_pk_bf16_f32 v149, v102, v103
    v_cvt_pk_bf16_f32 v150, v104, v105
    v_cvt_pk_bf16_f32 v151, v106, v107
    buffer_store_dwordx4 v[148:151], v7, s[8:11], s33 offen offset:0 sc1
    v_cvt_pk_bf16_f32 v152, v108, v109
    v_cvt_pk_bf16_f32 v153, v110, v111
    v_cvt_pk_bf16_f32 v154, v112, v113
    v_cvt_pk_bf16_f32 v155, v114, v115
    buffer_store_dwordx4 v[152:155], v7, s[8:11], s33 offen offset:2048 sc1
    v_mov_b32 v156, 0
    v_mov_b32 v157, 0
    v_dot2_f32_bf16 v156, v148, s25, v156
    v_dot2_f32_bf16 v157, v148, v148, v157
    v_dot2_f32_bf16 v156, v149, s25, v156
    v_dot2_f32_bf16 v157, v149, v149, v157
    v_dot2_f32_bf16 v156, v150, s25, v156
    v_dot2_f32_bf16 v157, v150, v150, v157
    v_dot2_f32_bf16 v156, v151, s25, v156
    v_dot2_f32_bf16 v157, v151, v151, v157
    v_dot2_f32_bf16 v156, v152, s25, v156
    v_dot2_f32_bf16 v157, v152, v152, v157
    v_dot2_f32_bf16 v156, v153, s25, v156
    v_dot2_f32_bf16 v157, v153, v153, v157
    v_dot2_f32_bf16 v156, v154, s25, v156
    v_dot2_f32_bf16 v157, v154, v154, v157
    v_dot2_f32_bf16 v156, v155, s25, v156
    v_dot2_f32_bf16 v157, v155, v155, v157
    s_nop 2
    v_permlane16_swap_b32 v156, v157
    v_add_f32 v156, v156, v157
    v_mov_b32 v157, v156
    s_nop 1
    v_permlane32_swap_b32 v156, v157
    v_add_f32 v156, v156, v157
    v_mov_b32 v3, 1
    buffer_store_dword v156, v9, s[8:11], s36 offen sc1
    s_barrier
    s_mul_i32 s44, s21, 229376
    s_lshl_b32 s45, s3, 13
    s_add_u32 s44, s44, s45
    s_add_u32 m0, s45, 98304
    s_add_u32 s47, s44, 0x218000
    buffer_load_dwordx4 v1, s[8:11], s47 offen offset:0 sc1 lds
    buffer_load_dwordx4 v1, s[8:11], s47 offen offset:1024 sc1 lds
    buffer_load_dwordx4 v1, s[8:11], s47 offen offset:2048 sc1 lds
    buffer_load_dwordx4 v1, s[8:11], s47 offen offset:3072 sc1 lds
    s_add_u32 m0, s45, 102400
    s_add_u32 s47, s44, 0x219000
    buffer_load_dwordx4 v1, s[8:11], s47 offen offset:0 sc1 lds
    buffer_load_dwordx4 v1, s[8:11], s47 offen offset:1024 sc1 lds
    buffer_load_dwordx4 v1, s[8:11], s47 offen offset:2048 sc1 lds
    buffer_load_dwordx4 v1, s[8:11], s47 offen offset:3072 sc1 lds
    s_waitcnt vmcnt(8)
    s_barrier
    s_cmp_lg_u32 s3, 0
    s_cbranch_scc1 L_sg4
    s_mov_b64 exec, 1
    buffer_atomic_add v3, off, s[8:11], s35 sc1
    s_mov_b64 exec, -1
L_sg4:
    s_lshl_b32 s34, s20, 9
    s_add_u32 s34, s34, 0x2304000
    s_lshl_b32 s48, s21, 11
    s_add_u32 s48, s48, 0x760000
    buffer_load_dwordx4 v[124:127], v1, s[8:11], s48 offen offset:0 sc1
    buffer_load_dwordx4 v[76:79], v1, s[8:11], s48 offen offset:1024 sc1
    s_add_u32 m0, s45, 131072
    s_add_u32 s47, s44, 0x220000
    buffer_load_dwordx4 v1, s[8:11], s47 offen offset:0 sc1 lds
    buffer_load_dwordx4 v1, s[8:11], s47 offen offset:1024 sc1 lds
    buffer_load_dwordx4 v1, s[8:11], s47 offen offset:2048 sc1 lds
    buffer_load_dwordx4 v1, s[8:11], s47 offen offset:3072 sc1 lds
    s_add_u32 m0, s45, 135168
    s_add_u32 s47, s44, 0x221000
    buffer_load_dwordx4 v1, s[8:11], s47 offen offset:0 sc1 lds
    buffer_load_dwordx4 v1, s[8:11], s47 offen offset:1024 sc1 lds
    buffer_load_dwordx4 v1, s[8:11], s47 offen offset:2048 sc1 lds
    buffer_load_dwordx4 v1, s[8:11], s47 offen offset:3072 sc1 lds
    s_add_u32 s51, s49, 0x584000
    buffer_load_dwordx4 a[16:19], v1, s[8:11], s51 offen sc1
    s_add_u32 s51, s50, 0x584000
    buffer_load_dwordx4 a[20:23], v1, s[8:11], s51 offen sc1
    s_add_u32 s51, s49, 0x585c00
    buffer_load_dwordx4 a[24:27], v1, s[8:11], s51 offen sc1
    s_add_u32 s51, s50, 0x585c00
    buffer_load_dwordx4 a[28:31], v1, s[8:11], s51 offen sc1
    s_add_u32 s51, s49, 0x580c00
    buffer_load_dwordx4 a[32:35], v1, s[8:11], s51 offen sc1
    s_add_u32 s51, s50, 0x580c00
    buffer_load_dwordx4 a[36:39], v1, s[8:11], s51 offen sc1
    s_cmp_lg_u32 s3, 0
    s_cbranch_scc1 L_ap5
    s_add_u32 s66, s34, 256
    s_load_dword s64, s[4:5], s34 glc
    s_load_dword s65, s[4:5], s66 glc
L_ap5:
    s_add_u32 s51, s49, 0x582800
    buffer_load_dwordx4 a[40:43], v1, s[8:11], s51 offen sc1
    s_add_u32 s51, s50, 0x582800
    buffer_load_dwordx4 a[44:47], v1, s[8:11], s51 offen sc1
    s_add_u32 s51, s49, 0x584400
    buffer_load_dwordx4 a[48:51], v1, s[8:11], s51 offen sc1
    s_add_u32 s51, s50, 0x584400
    buffer_load_dwordx4 a[52:55], v1, s[8:11], s51 offen sc1
    s_add_u32 s51, s49, 0x586000
    buffer_load_dwordx4 a[56:59], v1, s[8:11], s51 offen sc1
    s_add_u32 s51, s50, 0x586000
    buffer_load_dwordx4 a[60:63], v1, s[8:11], s51 offen sc1
    v_and_b32 v4, 31, v0
    v_lshrrev_b32 v5, 5, v0
    v_lshrrev_b32 v6, 4, v4
    v_lshlrev_b32 v6, 10, v6
    v_lshl_add_u32 v6, v5, 9, v6
    v_and_b32 v7, 15, v4
    v_lshl_add_u32 v6, v7, 3, v6
    v_add_u32 v8, 65536, v1
    v_add_u32 v9, 0x20000, v1
    v_lshlrev_b32 v10, 8, v0
    s_lshl_b32 s30, s20, 2
    s_add_u32 s30, s30, s3
    s_lshl_b32 s31, s30, 15
    s_add_u32 s31, s31, 0xc00000
    s_lshl_b32 s32, s30, 11
    s_add_u32 s32, s32, 0x2280000
    s_mul_i32 s33, s30, 114688
    s_mul_i32 s35, s21, 7168
    s_add_u32 s33, s33, s35
    s_add_u32 s33, s33, 0x1400000
    s_lshl_b32 s35, s20, 3
    s_lshr_b32 s36, s3, 1
    s_lshl_b32 s36, s36, 2
    s_add_u32 s35, s35, s36
    s_lshr_b32 s36, s21, 2
    s_add_u32 s35, s35, s36
    s_lshl_b32 s35, s35, 8
    s_and_b32 s36, s3, 1
    s_lshl_b32 s83, s23, 1
    s_add_u32 s83, s83, s36
    s_xor_b32 s75, s83, 1
    s_mul_i32 s36, s3, 28672
    s_add_u32 s85, s36, 0x580000
    s_mul_i32 s74, s83, 114688
    s_mul_i32 s75, s75, 114688
    s_add_u32 s74, s74, s85
    s_add_u32 s75, s75, s85
    s_add_u32 s76, s74, 4096
    s_add_u32 s77, s75, 4096
    s_lshl_b32 s82, s22, 1
    s_lshr_b32 s85, s3, 1
    s_add_u32 s82, s82, s85
    s_xor_b32 s79, s82, 1
    s_add_u32 s36, s36, 0x1400000
    s_mul_i32 s78, s82, 114688
    s_mul_i32 s79, s79, 114688
    s_add_u32 s78, s78, s36
    s_add_u32 s79, s79, s36
    s_lshl_b32 s84, s82, 15
    s_lshl_b32 s85, s83, 11
    s_add_u32 s84, s84, s85
    s_add_u32 s80, s78, 4096
    s_add_u32 s81, s79, 4096
    s_add_u32 s85, s84, 0xc00000
    v_add_u32 v15, 7168, v1
    v_add_u32 v7, 14336, v1
    v_add_u32 v10, 21504, v1
    s_lshl_b32 s36, s22, 2
    s_add_u32 s36, s36, s3
    s_lshl_b32 s36, s36, 8
    s_cmp_lg_u32 s3, 0
    s_cbranch_scc1 L_pw_done6
    s_mov_b32 s57, 100000
    s_add_u32 s66, s34, 256
    s_waitcnt lgkmcnt(0)
    s_min_u32 s64, s64, s65
    s_cmp_eq_u32 s64, 8
    s_cbranch_scc1 L_pw_done6
L_pw6:
    s_load_dword s64, s[4:5], s34 glc
    s_load_dword s65, s[4:5], s66 glc
    s_sub_u32 s57, s57, 1
    s_cbranch_scc1 L_pw_done6
    s_waitcnt lgkmcnt(0)
    s_min_u32 s64, s64, s65
    s_cmp_lg_u32 s64, 8
    s_cbranch_scc1 L_pw6
L_pw_done6:
    s_barrier
    buffer_load_dwordx4 v[128:131], v1, s[8:11], s31 offen offset:0 sc1
    buffer_load_dwordx4 v[132:135], v1, s[8:11], s31 offen offset:1024 sc1
    buffer_load_dwordx4 v[136:139], v1, s[8:11], s31 offen offset:2048 sc1
    buffer_load_dwordx4 v[140:143], v1, s[8:11], s31 offen offset:3072 sc1
L_pad15616:
    s_cbranch_execz L_ret_top
    s_add_u32 s31, s31, 4096
    buffer_load_dwordx4 v[144:147], v1, s[8:11], s31 offen offset:0 sc1
    buffer_load_dwordx4 v[148:151], v1, s[8:11], s31 offen offset:1024 sc1
    buffer_load_dwordx4 v[152:155], v1, s[8:11], s31 offen offset:2048 sc1
    buffer_load_dwordx4 v[156:159], v1, s[8:11], s31 offen offset:3072 sc1
    s_add_u32 s31, s31, 4096
    buffer_load_dwordx4 v[160:163], v1, s[8:11], s31 offen offset:0 sc1
    buffer_load_dwordx4 v[164:167], v1, s[8:11], s31 offen offset:1024 sc1
    buffer_load_dwordx4 v[168:171], v1, s[8:11], s31 offen offset:2048 sc1
    buffer_load_dwordx4 v[172:175], v1, s[8:11], s31 offen offset:3072 sc1
    s_add_u32 s31, s31, 4096
    buffer_load_dwordx4 v[176:179], v1, s[8:11], s31 offen offset:0 sc1
    s_mov_b64 exec, 0
    s_cmp_eq_u32 s3, 0
    s_cbranch_scc1 L_pad36096
    s_cmp_eq_u32 s3, 1
    s_cbranch_scc1 L_pad40192
    s_cmp_eq_u32 s3, 2
    s_cbranch_scc1 L_pad44288
    s_cmp_eq_u32 s3, 3
    s_cbranch_scc1 L_pad48384
L_ret_p3s0:
    s_mov_b64 exec, -1
    ds_read_b128 v[80:83], v1 offset:0
    ds_read_b128 v[84:87], v1 offset:32768
    ds_read_b128 v[88:91], v1 offset:1024
    ds_read_b128 v[92:95], v1 offset:33792
    ds_read_b128 v[96:99], v1 offset:2048
    ds_read_b128 v[100:103], v1 offset:34816
    ds_read_b128 v[104:107], v1 offset:3072
    s_waitcnt lgkmcnt(5)
    s_waitcnt vmcnt(12)
    v_mfma_f32_32x32x16_bf16 v[16:31], v[80:83], v[128:131], 0
    ds_read_b128 v[108:111], v1 offset:35840
    buffer_load_dwordx4 v[180:183], v1, s[8:11], s31 offen offset:1024 sc1
    v_mfma_f32_32x32x16_bf16 v[32:47], v[84:87], v[128:131], 0
    ds_read_b128 v[80:83], v1 offset:4096
    s_waitcnt lgkmcnt(5)
    s_waitcnt vmcnt(12)
    v_mfma_f32_32x32x16_bf16 v[16:31], v[88:91], v[132:135], v[16:31]
    ds_read_b128 v[84:87], v1 offset:36864
    buffer_load_dwordx4 v[184:187], v1, s[8:11], s31 offen offset:2048 sc1
    v_mfma_f32_32x32x16_bf16 v[32:47], v[92:95], v[132:135], v[32:47]
    ds_read_b128 v[88:91], v1 offset:5120
    s_waitcnt lgkmcnt(5)
    s_waitcnt vmcnt(12)
    v_mfma_f32_32x32x16_bf16 v[16:31], v[96:99], v[136:139], v[16:31]
    ds_read_b128 v[92:95], v1 offset:37888
    buffer_load_dwordx4 v[188:191], v1, s[8:11], s31 offen offset:3072 sc1
    v_mfma_f32_32x32x16_bf16 v[32:47], v[100:103], v[136:139], v[32:47]
    ds_read_b128 v[96:99], v1 offset:6144
    s_add_u32 s31, s31, 4096
    s_waitcnt lgkmcnt(5)
    s_waitcnt vmcnt(12)
    v_mfma_f32_32x32x16_bf16 v[16:31], v[104:107], v[140:143], v[16:31]
    ds_read_b128 v[100:103], v1 offset:38912
    buffer_load_dwordx4 v[192:195], v1, s[8:11], s31 offen offset:0 sc1
    v_mfma_f32_32x32x16_bf16 v[32:47], v[108:111], v[140:143], v[32:47]
    ds_read_b128 v[104:107], v1 offset:7168
    s_waitcnt lgkmcnt(5)
    s_waitcnt vmcnt(12)
    v_mfma_f32_32x32x16_bf16 v[16:31], v[80:83], v[144:147], v[16:31]
    ds_read_b128 v[108:111], v1 offset:39936
    buffer_load_dwordx4 v[196:199], v1, s[8:11], s31 offen offset:1024 sc1
    v_mfma_f32_32x32x16_bf16 v[32:47], v[84:87], v[144:147], v[32:47]
    ds_read_b128 v[80:83], v1 offset:8192
    buffer_load_dwordx4 v[200:203], v1, s[8:11], s31 offen offset:2048 sc1
    s_waitcnt lgkmcnt(5)
    s_waitcnt vmcnt(13)
    v_mfma_f32_32x32x16_bf16 v[16:31], v[88:91], v[148:151], v[16:31]
    ds_read_b128 v[84:87], v1 offset:40960
    v_mfma_f32_32x32x16_bf16 v[32:47], v[92:95], v[148:151], v[32:47]
    ds_read_b128 v[88:91], v1 offset:9216
    buffer_load_dwordx4 v[204:207], v1, s[8:11], s31 offen offset:3072 sc1
    s_waitcnt lgkmcnt(5)
    s_waitcnt vmcnt(13)
    v_mfma_f32_32x32x16_bf16 v[16:31], v[96:99], v[152:155], v[16:31]
    ds_read_b128 v[92:95], v1 offset:41984
    s_add_u32 s31, s31, 4096
    v_mfma_f32_32x32x16_bf16 v[32:47], v[100:103], v[152:155], v[32:47]
    ds_read_b128 v[96:99], v1 offset:10240
    buffer_load_dwordx2 v[112:113], v6, s[8:11], s32 offen offset:0 sc1
    s_waitcnt lgkmcnt(5)
    s_waitcnt vmcnt(13)
    v_mfma_f32_32x32x16_bf16 v[16:31], v[104:107], v[156:159], v[16:31]
    ds_read_b128 v[100:103], v1 offset:43008
    v_mfma_f32_32x32x16_bf16 v[32:47], v[108:111], v[156:159], v[32:47]
    ds_read_b128 v[104:107], v1 offset:11264
    buffer_load_dwordx2 v[114:115], v6, s[8:11], s32 offen offset:128 sc1
    s_waitcnt lgkmcnt(5)
    s_waitcnt vmcnt(13)
    v_mfma_f32_32x32x16_bf16 v[16:31], v[80:83], v[160:163], v[16:31]
    ds_read_b128 v[108:111], v1 offset:44032
    v_mfma_f32_32x32x16_bf16 v[32:47], v[84:87], v[160:163], v[32:47]
    ds_read_b128 v[80:83], v1 offset:12288
    buffer_load_dwordx2 v[116:117], v6, s[8:11], s32 offen offset:256 sc1
    s_waitcnt lgkmcnt(5)
    s_waitcnt vmcnt(13)
    v_mfma_f32_32x32x16_bf16 v[16:31], v[88:91], v[164:167], v[16:31]
    ds_read_b128 v[84:87], v1 offset:45056
    buffer_load_dwordx2 v[118:119], v6, s[8:11], s32 offen offset:384 sc1
    v_mfma_f32_32x32x16_bf16 v[32:47], v[92:95], v[164:167], v[32:47]
    ds_read_b128 v[88:91], v1 offset:13312
    s_waitcnt lgkmcnt(5)
    s_waitcnt vmcnt(13)
    v_mfma_f32_32x32x16_bf16 v[16:31], v[96:99], v[168:171], v[16:31]
    ds_read_b128 v[92:95], v1 offset:46080
    buffer_load_dwordx4 v[208:211], v1, s[8:11], s31 offen offset:0 sc1
    v_mfma_f32_32x32x16_bf16 v[32:47], v[100:103], v[168:171], v[32:47]
    ds_read_b128 v[96:99], v1 offset:14336
    s_waitcnt lgkmcnt(5)
    s_waitcnt vmcnt(13)
    v_mfma_f32_32x32x16_bf16 v[16:31], v[104:107], v[172:175], v[16:31]
    ds_read_b128 v[100:103], v1 offset:47104
    buffer_load_dwordx4 v[212:215], v1, s[8:11], s31 offen offset:1024 sc1
    v_mfma_f32_32x32x16_bf16 v[32:47], v[108:111], v[172:175], v[32:47]
    ds_read_b128 v[104:107], v1 offset:15360
    s_waitcnt lgkmcnt(5)
    s_waitcnt vmcnt(13)
    v_mfma_f32_32x32x16_bf16 v[16:31], v[80:83], v[176:179], v[16:31]
    ds_read_b128 v[108:111], v1 offset:48128
    buffer_load_dwordx4 v[216:219], v1, s[8:11], s31 offen offset:2048 sc1
    v_mfma_f32_32x32x16_bf16 v[32:47], v[84:87], v[176:179], v[32:47]
    ds_read_b128 v[80:83], v1 offset:16384
    s_waitcnt lgkmcnt(5)
    s_waitcnt vmcnt(13)
    v_mfma_f32_32x32x16_bf16 v[16:31], v[88:91], v[180:183], v[16:31]
    ds_read_b128 v[84:87], v1 offset:49152
    buffer_load_dwordx4 v[220:223], v1, s[8:11], s31 offen offset:3072 sc1
    v_mfma_f32_32x32x16_bf16 v[32:47], v[92:95], v[180:183], v[32:47]
    ds_read_b128 v[88:91], v1 offset:17408
    s_add_u32 s31, s31, 4096
    s_waitcnt lgkmcnt(5)
    s_waitcnt vmcnt(13)
    v_mfma_f32_32x32x16_bf16 v[16:31], v[96:99], v[184:187], v[16:31]
    ds_read_b128 v[92:95], v1 offset:50176
    buffer_load_dwordx4 v[224:227], v1, s[8:11], s31 offen offset:0 sc1
    v_mfma_f32_32x32x16_bf16 v[32:47], v[100:103], v[184:187], v[32:47]
    ds_read_b128 v[96:99], v1 offset:18432
    buffer_load_dwordx4 v[228:231], v1, s[8:11], s31 offen offset:1024 sc1
    s_waitcnt lgkmcnt(5)
    s_waitcnt vmcnt(14)
    v_mfma_f32_32x32x16_bf16 v[16:31], v[104:107], v[188:191], v[16:31]
    ds_read_b128 v[100:103], v1 offset:51200
    v_mfma_f32_32x32x16_bf16 v[32:47], v[108:111], v[188:191], v[32:47]
    ds_read_b128 v[104:107], v1 offset:19456
    buffer_load_dwordx4 v[232:235], v1, s[8:11], s31 offen offset:2048 sc1
    s_waitcnt lgkmcnt(5)
    s_waitcnt vmcnt(14)
    v_mfma_f32_32x32x16_bf16 v[16:31], v[80:83], v[192:195], v[16:31]
    ds_read_b128 v[108:111], v1 offset:52224
    v_mfma_f32_32x32x16_bf16 v[32:47], v[84:87], v[192:195], v[32:47]
    ds_read_b128 v[80:83], v1 offset:20480
    buffer_load_dwordx4 v[236:239], v1, s[8:11], s31 offen offset:3072 sc1
    s_waitcnt lgkmcnt(5)
    s_waitcnt vmcnt(14)
    v_mfma_f32_32x32x16_bf16 v[16:31], v[88:91], v[196:199], v[16:31]
    ds_read_b128 v[84:87], v1 offset:53248
    s_add_u32 s31, s31, 4096
    v_mfma_f32_32x32x16_bf16 v[32:47], v[92:95], v[196:199], v[32:47]
    ds_read_b128 v[88:91], v1 offset:21504
    buffer_load_dwordx4 v[240:243], v1, s[8:11], s31 offen offset:0 sc1
    s_waitcnt lgkmcnt(5)
    s_waitcnt vmcnt(14)
    v_mfma_f32_32x32x16_bf16 v[16:31], v[96:99], v[200:203], v[16:31]
    ds_read_b128 v[92:95], v1 offset:54272
    v_mfma_f32_32x32x16_bf16 v[32:47], v[100:103], v[200:203], v[32:47]
    ds_read_b128 v[96:99], v1 offset:22528
    buffer_load_dwordx4 v[244:247], v1, s[8:11], s31 offen offset:1024 sc1
    s_waitcnt lgkmcnt(5)
    s_waitcnt vmcnt(14)
    v_mfma_f32_32x32x16_bf16 v[16:31], v[104:107], v[204:207], v[16:31]
    ds_read_b128 v[100:103], v1 offset:55296
    buffer_load_dwordx4 v[248:251], v1, s[8:11], s31 offen offset:2048 sc1
    v_mfma_f32_32x32x16_bf16 v[32:47], v[108:111], v[204:207], v[32:47]
    ds_read_b128 v[104:107], v1 offset:23552
    s_waitcnt lgkmcnt(5)
    s_waitcnt vmcnt(10)
    v_mfma_f32_32x32x16_bf16 v[16:31], v[80:83], v[208:211], v[16:31]
    ds_read_b128 v[108:111], v1 offset:56320
    buffer_load_dwordx4 v[252:255], v1, s[8:11], s31 offen offset:3072 sc1
    v_mfma_f32_32x32x16_bf16 v[32:47], v[84:87], v[208:211], v[32:47]
    ds_read_b128 v[80:83], v1 offset:24576
    v_add_f32 v112, v112, v114
    s_waitcnt lgkmcnt(5)
    s_waitcnt vmcnt(10)
    v_mfma_f32_32x32x16_bf16 v[16:31], v[88:91], v[212:215], v[16:31]
    ds_read_b128 v[84:87], v1 offset:57344
    v_add_f32 v113, v113, v115
    v_add_f32 v112, v112, v116
    v_mfma_f32_32x32x16_bf16 v[32:47], v[92:95], v[212:215], v[32:47]
    ds_read_b128 v[88:91], v1 offset:25600
    v_add_f32 v113, v113, v117
    v_add_f32 v112, v112, v118
    v_add_f32 v113, v113, v119
    s_waitcnt lgkmcnt(5)
    s_waitcnt vmcnt(9)
    v_mfma_f32_32x32x16_bf16 v[16:31], v[96:99], v[216:219], v[16:31]
    ds_read_b128 v[92:95], v1 offset:58368
    v_permlane32_swap_b32 v112, v113
    v_add_f32 v112, v112, v113
    v_mfma_f32_32x32x16_bf16 v[32:47], v[100:103], v[216:219], v[32:47]
    ds_read_b128 v[96:99], v1 offset:26624
    v_mov_b32 v113, v112
    s_nop 1
    v_permlane32_swap_b32 v112, v113
    s_waitcnt lgkmcnt(5)
    s_waitcnt vmcnt(8)
    v_mfma_f32_32x32x16_bf16 v[16:31], v[104:107], v[220:223], v[16:31]
    ds_read_b128 v[100:103], v1 offset:59392
    v_mul_f32 v112, 0xbb000000, v112
    v_mul_f32 v114, v112, v112
    v_mov_b32 v115, 0x3b000000
    v_mfma_f32_32x32x16_bf16 v[32:47], v[108:111], v[220:223], v[32:47]
    ds_read_b128 v[104:107], v1 offset:27648
    v_fma_f32 v114, v113, v115, -v114
    v_max_f32 v114, 0, v114
    s_waitcnt lgkmcnt(5)
    s_waitcnt vmcnt(7)
    v_mfma_f32_32x32x16_bf16 v[16:31], v[80:83], v[224:227], v[16:31]
    ds_read_b128 v[108:111], v1 offset:60416
    v_add_f32 v114, s24, v114
    v_mov_b32 v113, v112
    v_mfma_f32_32x32x16_bf16 v[32:47], v[84:87], v[224:227], v[32:47]
    ds_read_b128 v[80:83], v1 offset:28672
    v_rsq_f32 v112, v114
    s_waitcnt lgkmcnt(5)
    s_waitcnt vmcnt(6)
    v_mfma_f32_32x32x16_bf16 v[16:31], v[88:91], v[228:231], v[16:31]
    ds_read_b128 v[84:87], v1 offset:61440
    v_cvt_pk_bf16_f32 v116, v113, v113
    v_mul_f32 v114, v112, v112
    v_and_b32 v117, 0xffff0000, v116
    v_mfma_f32_32x32x16_bf16 v[32:47], v[92:95], v[228:231], v[32:47]
    ds_read_b128 v[88:91], v1 offset:29696
    v_mul_f32 v12, 0xc0135761, v112
    v_sub_f32 v113, v113, v117
    s_waitcnt lgkmcnt(5)
    s_waitcnt vmcnt(5)
    v_mfma_f32_32x32x16_bf16 v[16:31], v[96:99], v[232:235], v[16:31]
    ds_read_b128 v[92:95], v1 offset:62464
    v_mul_f32 v115, v114, v112
    v_mov_b32 v64, 0
    v_mfma_f32_32x32x16_bf16 v[32:47], v[100:103], v[232:235], v[32:47]
    ds_read_b128 v[96:99], v1 offset:30720
    v_cvt_pk_bf16_f32 v117, v113, v64
    v_mul_f32 v13, 0xbdd2d3e8, v115
    s_waitcnt lgkmcnt(5)
    s_waitcnt vmcnt(4)
    v_mfma_f32_32x32x16_bf16 v[16:31], v[104:107], v[236:239], v[16:31]
    ds_read_b128 v[100:103], v1 offset:63488
    v_rcp_f32 v14, v114
    v_mov_b32 v65, 0
    v_mfma_f32_32x32x16_bf16 v[32:47], v[108:111], v[236:239], v[32:47]
    ds_read_b128 v[104:107], v1 offset:31744
    v_mov_b32 v68, 0
    v_mov_b32 v69, 0
    s_waitcnt lgkmcnt(5)
    s_waitcnt vmcnt(3)
    v_mfma_f32_32x32x16_bf16 v[16:31], v[80:83], v[240:243], v[16:31]
    ds_read_b128 v[108:111], v1 offset:64512
    v_mov_b32 v72, 0
    v_mov_b32 v73, 0
    v_mfma_f32_32x32x16_bf16 v[32:47], v[84:87], v[240:243], v[32:47]
    ds_read_b128 v[80:83], v8 offset:0
    s_mov_b32 s6, -1
    s_mov_b32 s7, 0
    v_cndmask_b32 v66, v64, v116, s[6:7]
    s_waitcnt lgkmcnt(5)
    s_waitcnt vmcnt(2)
    v_mfma_f32_32x32x16_bf16 v[16:31], v[88:91], v[244:247], v[16:31]
    ds_read_b128 v[84:87], v8 offset:1024
    v_cndmask_b32 v70, v116, v64, s[6:7]
    v_cndmask_b32 v78, v64, v78, s[6:7]
    v_cndmask_b32 v67, v64, v117, s[6:7]
    v_mfma_f32_32x32x16_bf16 v[32:47], v[92:95], v[244:247], v[32:47]
    ds_read_b128 v[88:91], v8 offset:2048
    v_cndmask_b32 v71, v117, v64, s[6:7]
    v_cndmask_b32 v79, v64, v79, s[6:7]
    s_waitcnt lgkmcnt(5)
    s_waitcnt vmcnt(1)
    v_mfma_f32_32x32x16_bf16 v[16:31], v[96:99], v[248:251], v[16:31]
    ds_read_b128 v[92:95], v8 offset:3072
    v_mfma_f32_32x32x16_bf16 v[32:47], v[100:103], v[248:251], v[32:47]
    ds_read_b128 v[96:99], v8 offset:4096
    s_waitcnt lgkmcnt(5)
    s_waitcnt vmcnt(0)
    v_mfma_f32_32x32x16_bf16 v[16:31], v[104:107], v[252:255], v[16:31]
    ds_read_b128 v[100:103], v8 offset:5120
    v_mfma_f32_32x32x16_bf16 v[32:47], v[108:111], v[252:255], v[32:47]
    ds_read_b128 v[104:107], v8 offset:6144
    v_mfma_f32_32x32x16_bf16 v[16:31], v[124:127], v[66:69], v[16:31]
    v_mfma_f32_32x32x16_bf16 v[32:47], v[124:127], v[64:67], v[32:47]
    s_barrier
    s_waitcnt lgkmcnt(3)
    v_mfma_f32_32x32x16_bf16 v[48:63], v[80:83], v[128:131], 0
    ds_read_b128 v[108:111], v8 offset:7168
    v_mfma_f32_32x32x16_bf16 v[48:63], v[84:87], v[132:135], v[48:63]
    ds_read_b128 v[80:83], v8 offset:8192
    s_nop 4
    v_mul_f32 v112, v16, v16
    s_mul_i32 s44, s21, 229376
    v_fma_f32 v112, v112, v13, v12
    v_mul_f32 v112, v112, v16
    v_mfma_f32_32x32x16_bf16 v[48:63], v[88:91], v[136:139], v[48:63]
    ds_read_b128 v[84:87], v8 offset:9216
    v_exp_f32 v112, v112
    s_lshl_b32 s45, s3, 13
    v_mul_f32 v16, v16, v24
    v_mul_f32 v113, v17, v17
    v_mfma_f32_32x32x16_bf16 v[48:63], v[92:95], v[140:143], v[48:63]
    ds_read_b128 v[88:91], v8 offset:10240
    v_fma_f32 v113, v113, v13, v12
    s_add_u32 s44, s44, s45
    v_mul_f32 v113, v113, v17
    s_waitcnt lgkmcnt(3)
    v_mfma_f32_32x32x16_bf16 v[48:63], v[96:99], v[144:147], v[48:63]
    ds_read_b128 v[92:95], v8 offset:11264
    v_exp_f32 v113, v113
    v_mul_f32 v17, v17, v25
    s_add_u32 m0, s45, 0
    v_fma_f32 v112, v112, v14, v14
    v_rcp_f32 v112, v112
    v_mfma_f32_32x32x16_bf16 v[48:63], v[100:103], v[148:151], v[48:63]
    ds_read_b128 v[96:99], v8 offset:12288
    v_mul_f32 v114, v18, v18
    s_add_u32 s47, s44, 0x228000
    v_fma_f32 v114, v114, v13, v12
    v_mul_f32 v114, v114, v18
    v_exp_f32 v114, v114
    v_mfma_f32_32x32x16_bf16 v[48:63], v[104:107], v[152:155], v[48:63]
    ds_read_b128 v[100:103], v8 offset:13312
    buffer_load_dwordx4 v1, s[8:11], s47 offen offset:0 sc1 lds
    v_mul_f32 v18, v18, v26
    v_mfma_f32_32x32x16_bf16 v[48:63], v[108:111], v[156:159], v[48:63]
    ds_read_b128 v[104:107], v8 offset:14336
    v_fma_f32 v113, v113, v14, v14
    v_rcp_f32 v113, v113
    s_waitcnt lgkmcnt(3)
    v_mfma_f32_32x32x16_bf16 v[48:63], v[80:83], v[160:163], v[48:63]
    ds_read_b128 v[108:111], v8 offset:15360
    buffer_load_dwordx4 v1, s[8:11], s47 offen offset:1024 sc1 lds
    v_mul_f32 v115, v19, v19
    v_mul_f32 v16, v16, v112
    v_fma_f32 v115, v115, v13, v12
    v_mfma_f32_32x32x16_bf16 v[48:63], v[84:87], v[164:167], v[48:63]
    ds_read_b128 v[80:83], v8 offset:16384
    buffer_load_dwordx4 v1, s[8:11], s47 offen offset:2048 sc1 lds
    v_mul_f32 v115, v115, v19
    v_exp_f32 v115, v115
    v_mfma_f32_32x32x16_bf16 v[48:63], v[88:91], v[168:171], v[48:63]
    ds_read_b128 v[84:87], v8 offset:17408
    v_mul_f32 v19, v19, v27
    buffer_load_dwordx4 v1, s[8:11], s47 offen offset:3072 sc1 lds
    v_fma_f32 v114, v114, v14, v14
    v_mfma_f32_32x32x16_bf16 v[48:63], v[92:95], v[172:175], v[48:63]
    ds_read_b128 v[88:91], v8 offset:18432
    v_rcp_f32 v114, v114
    v_mul_f32 v116, v20, v20
    s_add_u32 m0, s45, 4096
    v_mul_f32 v17, v17, v113
    s_waitcnt lgkmcnt(3)
    v_mfma_f32_32x32x16_bf16 v[48:63], v[96:99], v[176:179], v[48:63]
    ds_read_b128 v[92:95], v8 offset:19456
    v_cvt_pk_bf16_f32 v120, v16, v17
    v_fma_f32 v116, v116, v13, v12
    s_add_u32 s47, s44, 0x229000
    v_mul_f32 v116, v116, v20
    v_exp_f32 v116, v116
    v_mfma_f32_32x32x16_bf16 v[48:63], v[100:103], v[180:183], v[48:63]
    ds_read_b128 v[96:99], v8 offset:20480
    v_mul_f32 v20, v20, v28
    buffer_load_dwordx4 v1, s[8:11], s47 offen offset:0 sc1 lds
    v_fma_f32 v115, v115, v14, v14
    v_mfma_f32_32x32x16_bf16 v[48:63], v[104:107], v[184:187], v[48:63]
    ds_read_b128 v[100:103], v8 offset:21504
    v_rcp_f32 v115, v115
    v_mul_f32 v117, v21, v21
    v_mfma_f32_32x32x16_bf16 v[48:63], v[108:111], v[188:191], v[48:63]
    ds_read_b128 v[104:107], v8 offset:22528
    buffer_load_dwordx4 v1, s[8:11], s47 offen offset:1024 sc1 lds
    v_mul_f32 v18, v18, v114
    v_fma_f32 v117, v117, v13, v12
    v_mul_f32 v117, v117, v21
    s_waitcnt lgkmcnt(3)
    v_mfma_f32_32x32x16_bf16 v[48:63], v[80:83], v[192:195], v[48:63]
    ds_read_b128 v[108:111], v8 offset:23552
    buffer_load_dwordx4 v1, s[8:11], s47 offen offset:2048 sc1 lds
    v_exp_f32 v117, v117
    v_mul_f32 v21, v21, v29
    v_mfma_f32_32x32x16_bf16 v[48:63], v[84:87], v[196:199], v[48:63]
    ds_read_b128 v[80:83], v8 offset:24576
    v_fma_f32 v116, v116, v14, v14
    v_rcp_f32 v116, v116
    v_mfma_f32_32x32x16_bf16 v[48:63], v[88:91], v[200:203], v[48:63]
    ds_read_b128 v[84:87], v8 offset:25600
    buffer_load_dwordx4 v1, s[8:11], s47 offen offset:3072 sc1 lds
    v_mul_f32 v118, v22, v22
    v_mul_f32 v19, v19, v115
    v_cvt_pk_bf16_f32 v121, v18, v19
    s_add_u32 m0, s45, 32768
    v_mfma_f32_32x32x16_bf16 v[48:63], v[92:95], v[204:207], v[48:63]
    ds_read_b128 v[88:91], v8 offset:26624
    v_fma_f32 v118, v118, v13, v12
    v_mul_f32 v118, v118, v22
    v_exp_f32 v118, v118
    s_add_u32 s47, s44, 0x230000
    s_waitcnt lgkmcnt(3)
    v_mfma_f32_32x32x16_bf16 v[48:63], v[96:99], v[208:211], v[48:63]
    ds_read_b128 v[92:95], v8 offset:27648
    v_mul_f32 v22, v22, v30
    v_fma_f32 v117, v117, v14, v14
    v_rcp_f32 v117, v117
    v_mfma_f32_32x32x16_bf16 v[48:63], v[100:103], v[212:215], v[48:63]
    ds_read_b128 v[96:99], v8 offset:28672
    buffer_load_dwordx4 v1, s[8:11], s47 offen offset:0 sc1 lds
    v_mul_f32 v119, v23, v23
    v_mul_f32 v20, v20, v116
    v_fma_f32 v119, v119, v13, v12
    v_mfma_f32_32x32x16_bf16 v[48:63], v[104:107], v[216:219], v[48:63]
    ds_read_b128 v[100:103], v8 offset:29696
    buffer_load_dwordx4 v1, s[8:11], s47 offen offset:1024 sc1 lds
    v_mul_f32 v119, v119, v23
    v_mfma_f32_32x32x16_bf16 v[48:63], v[108:111], v[220:223], v[48:63]
    ds_read_b128 v[104:107], v8 offset:30720
    v_exp_f32 v119, v119
    v_mul_f32 v23, v23, v31
    buffer_load_dwordx4 v1, s[8:11], s47 offen offset:2048 sc1 lds
    s_waitcnt lgkmcnt(3)
    v_mfma_f32_32x32x16_bf16 v[48:63], v[80:83], v[224:227], v[48:63]
    ds_read_b128 v[108:111], v8 offset:31744
    v_fma_f32 v118, v118, v14, v14
    v_rcp_f32 v118, v118
    v_mul_f32 v21, v21, v117
    v_mfma_f32_32x32x16_bf16 v[48:63], v[84:87], v[228:231], v[48:63]
    buffer_load_dwordx4 v1, s[8:11], s47 offen offset:3072 sc1 lds
    v_cvt_pk_bf16_f32 v122, v20, v21
    v_fma_f32 v119, v119, v14, v14
    s_barrier
    ds_read_b128 v[80:83], v8 offset:32768
    v_mfma_f32_32x32x16_bf16 v[48:63], v[88:91], v[232:235], v[48:63]
    ds_read_b128 v[84:87], v8 offset:33792
    v_rcp_f32 v119, v119
    s_add_u32 m0, s45, 36864
    v_mul_f32 v22, v22, v118
    v_mul_f32 v23, v23, v119
    v_cvt_pk_bf16_f32 v123, v22, v23
    s_add_u32 s47, s44, 0x231000
    v_mfma_f32_32x32x16_bf16 v[48:63], v[92:95], v[236:239], v[48:63]
    ds_read_b128 v[88:91], v8 offset:34816
    buffer_store_dwordx4 v[120:123], v1, s[8:11], s33 offen offset:0 sc1
    v_mul_f32 v112, v32, v32
    s_waitcnt lgkmcnt(3)
    v_mfma_f32_32x32x16_bf16 v[48:63], v[96:99], v[240:243], v[48:63]
    ds_read_b128 v[92:95], v8 offset:35840
    v_fma_f32 v112, v112, v13, v12
    buffer_load_dwordx4 v1, s[8:11], s47 offen offset:0 sc1 lds
    v_mul_f32 v112, v112, v32
    v_mfma_f32_32x32x16_bf16 v[48:63], v[100:103], v[244:247], v[48:63]
    ds_read_b128 v[96:99], v8 offset:36864
    v_exp_f32 v112, v112
    v_mul_f32 v32, v32, v40
    v_mfma_f32_32x32x16_bf16 v[48:63], v[104:107], v[248:251], v[48:63]
    ds_read_b128 v[100:103], v8 offset:37888
    buffer_load_dwordx4 v1, s[8:11], s47 offen offset:1024 sc1 lds
    v_mul_f32 v113, v33, v33
    v_fma_f32 v113, v113, v13, v12
    v_mul_f32 v113, v113, v33
    v_mfma_f32_32x32x16_bf16 v[48:63], v[108:111], v[252:255], v[48:63]
    ds_read_b128 v[104:107], v8 offset:38912
    buffer_load_dwordx4 v1, s[8:11], s47 offen offset:2048 sc1 lds
    v_exp_f32 v113, v113
    v_mul_f32 v33, v33, v41
    v_mfma_f32_32x32x16_bf16 v[48:63], v[124:127], v[70:73], v[48:63]
    v_fma_f32 v112, v112, v14, v14
    buffer_load_dwordx4 v1, s[8:11], s47 offen offset:3072 sc1 lds
    v_rcp_f32 v112, v112
    v_mul_f32 v114, v34, v34
    v_fma_f32 v114, v114, v13, v12
    s_waitcnt lgkmcnt(3)
    v_mfma_f32_32x32x16_bf16 v[16:31], v[80:83], v[128:131], 0
    ds_read_b128 v[108:111], v8 offset:39936
    v_mul_f32 v114, v114, v34
    buffer_load_dwordx4 a[160:163], v1, s[8:11], s74 offen offset:0 sc1
    v_mfma_f32_32x32x16_bf16 v[16:31], v[84:87], v[132:135], v[16:31]
    ds_read_b128 v[80:83], v8 offset:40960
    v_exp_f32 v114, v114
    v_mul_f32 v34, v34, v42
    v_fma_f32 v113, v113, v14, v14
    v_mfma_f32_32x32x16_bf16 v[16:31], v[88:91], v[136:139], v[16:31]
    ds_read_b128 v[84:87], v8 offset:41984
    v_rcp_f32 v113, v113
    v_mul_f32 v115, v35, v35
    v_mul_f32 v32, v32, v112
    v_mfma_f32_32x32x16_bf16 v[16:31], v[92:95], v[140:143], v[16:31]
    ds_read_b128 v[88:91], v8 offset:43008
    buffer_load_dwordx4 a[164:167], v1, s[8:11], s75 offen offset:0 sc1
    s_waitcnt lgkmcnt(3)
    v_mfma_f32_32x32x16_bf16 v[16:31], v[96:99], v[144:147], v[16:31]
    ds_read_b128 v[92:95], v8 offset:44032
    v_fma_f32 v115, v115, v13, v12
    v_mul_f32 v115, v115, v35
    v_exp_f32 v115, v115
    v_mul_f32 v35, v35, v43
    v_mfma_f32_32x32x16_bf16 v[16:31], v[100:103], v[148:151], v[16:31]
    ds_read_b128 v[96:99], v8 offset:45056
    v_fma_f32 v114, v114, v14, v14
    v_rcp_f32 v114, v114
    v_mfma_f32_32x32x16_bf16 v[16:31], v[104:107], v[152:155], v[16:31]
    ds_read_b128 v[100:103], v8 offset:46080
    buffer_load_dwordx4 a[168:171], v15, s[8:11], s74 offen offset:0 sc1
    v_mul_f32 v116, v36, v36
    v_mfma_f32_32x32x16_bf16 v[16:31], v[108:111], v[156:159], v[16:31]
    ds_read_b128 v[104:107], v8 offset:47104
    v_mul_f32 v33, v33, v113
    v_cvt_pk_bf16_f32 v120, v32, v33
    v_fma_f32 v116, v116, v13, v12
    v_mul_f32 v116, v116, v36
    s_waitcnt lgkmcnt(3)
    v_mfma_f32_32x32x16_bf16 v[16:31], v[80:83], v[160:163], v[16:31]
    ds_read_b128 v[108:111], v8 offset:48128
    v_exp_f32 v116, v116
    v_mul_f32 v36, v36, v44
    v_mfma_f32_32x32x16_bf16 v[16:31], v[84:87], v[164:167], v[16:31]
    ds_read_b128 v[80:83], v8 offset:49152
    buffer_load_dwordx4 a[172:175], v15, s[8:11], s75 offen offset:0 sc1
    v_fma_f32 v115, v115, v14, v14
    v_rcp_f32 v115, v115
    v_mfma_f32_32x32x16_bf16 v[16:31], v[88:91], v[168:171], v[16:31]
    ds_read_b128 v[84:87], v8 offset:50176
    v_mul_f32 v117, v37, v37
    v_mul_f32 v34, v34, v114
    v_fma_f32 v117, v117, v13, v12
    v_mul_f32 v117, v117, v37
    v_mfma_f32_32x32x16_bf16 v[16:31], v[92:95], v[172:175], v[16:31]
    ds_read_b128 v[88:91], v8 offset:51200
    buffer_load_dwordx4 a[176:179], v7, s[8:11], s74 offen offset:0 sc1
    v_exp_f32 v117, v117
    s_waitcnt lgkmcnt(3)
    v_mfma_f32_32x32x16_bf16 v[16:31], v[96:99], v[176:179], v[16:31]
    ds_read_b128 v[92:95], v8 offset:52224
    v_mul_f32 v37, v37, v45
    v_fma_f32 v116, v116, v14, v14
    v_rcp_f32 v116, v116
    v_mul_f32 v118, v38, v38
    v_mfma_f32_32x32x16_bf16 v[16:31], v[100:103], v[180:183], v[16:31]
    ds_read_b128 v[96:99], v8 offset:53248
    v_mul_f32 v35, v35, v115
    buffer_load_dwordx4 a[180:183], v7, s[8:11], s75 offen offset:0 sc1
    v_mfma_f32_32x32x16_bf16 v[16:31], v[104:107], v[184:187], v[16:31]
    ds_read_b128 v[100:103], v8 offset:54272
    v_cvt_pk_bf16_f32 v121, v34, v35
    v_fma_f32 v118, v118, v13, v12
    v_mul_f32 v118, v118, v38
    v_exp_f32 v118, v118
    v_mfma_f32_32x32x16_bf16 v[16:31], v[108:111], v[188:191], v[16:31]
    ds_read_b128 v[104:107], v8 offset:55296
    v_mul_f32 v38, v38, v46
    v_fma_f32 v117, v117, v14, v14
    v_rcp_f32 v117, v117
    s_waitcnt lgkmcnt(3)
    v_mfma_f32_32x32x16_bf16 v[16:31], v[80:83], v[192:195], v[16:31]
    ds_read_b128 v[108:111], v8 offset:56320
    buffer_load_dwordx4 a[184:187], v10, s[8:11], s74 offen offset:0 sc1
    v_mul_f32 v119, v39, v39
    v_mfma_f32_32x32x16_bf16 v[16:31], v[84:87], v[196:199], v[16:31]
    ds_read_b128 v[80:83], v8 offset:57344
    v_mul_f32 v36, v36, v116
    v_fma_f32 v119, v119, v13, v12
    v_mul_f32 v119, v119, v39
    v_exp_f32 v119, v119
    v_mfma_f32_32x32x16_bf16 v[16:31], v[88:91], v[200:203], v[16:31]
    ds_read_b128 v[84:87], v8 offset:58368
    v_mul_f32 v39, v39, v47
    buffer_load_dwordx4 a[188:191], v10, s[8:11], s75 offen offset:0 sc1
    v_mfma_f32_32x32x16_bf16 v[16:31], v[92:95], v[204:207], v[16:31]
    ds_read_b128 v[88:91], v8 offset:59392
    v_fma_f32 v118, v118, v14, v14
    v_rcp_f32 v118, v118
    v_mul_f32 v37, v37, v117
    s_waitcnt lgkmcnt(3)
    v_mfma_f32_32x32x16_bf16 v[16:31], v[96:99], v[208:211], v[16:31]
    ds_read_b128 v[92:95], v8 offset:60416
    v_cvt_pk_bf16_f32 v122, v36, v37
    v_fma_f32 v119, v119, v14, v14
    v_rcp_f32 v119, v119
    v_mul_f32 v38, v38, v118
    v_mfma_f32_32x32x16_bf16 v[16:31], v[100:103], v[212:215], v[16:31]
    ds_read_b128 v[96:99], v8 offset:61440
    buffer_load_dwordx4 a[192:195], v1, s[8:11], s74 offen offset:1024 sc1
    v_mul_f32 v39, v39, v119
    v_mfma_f32_32x32x16_bf16 v[16:31], v[104:107], v[216:219], v[16:31]
    ds_read_b128 v[100:103], v8 offset:62464
    v_cvt_pk_bf16_f32 v123, v38, v39
    buffer_store_dwordx4 v[120:123], v1, s[8:11], s33 offen offset:1024 sc1
    v_mfma_f32_32x32x16_bf16 v[16:31], v[108:111], v[220:223], v[16:31]
    ds_read_b128 v[104:107], v8 offset:63488
    v_mul_f32 v112, v48, v48
    v_fma_f32 v112, v112, v13, v12
    v_mul_f32 v112, v112, v48
    s_waitcnt lgkmcnt(3)
    v_mfma_f32_32x32x16_bf16 v[16:31], v[80:83], v[224:227], v[16:31]
    ds_read_b128 v[108:111], v8 offset:64512
    buffer_load_dwordx4 a[196:199], v1, s[8:11], s75 offen offset:1024 sc1
    v_exp_f32 v112, v112
    v_mfma_f32_32x32x16_bf16 v[16:31], v[84:87], v[228:231], v[16:31]
    ds_read_b128 v[80:83], v9 offset:0
    v_mul_f32 v48, v48, v56
    v_mul_f32 v113, v49, v49
    v_fma_f32 v113, v113, v13, v12
    v_mul_f32 v113, v113, v49
    v_mfma_f32_32x32x16_bf16 v[16:31], v[88:91], v[232:235], v[16:31]
    ds_read_b128 v[84:87], v9 offset:1024
    v_exp_f32 v113, v113
    buffer_load_dwordx4 a[200:203], v15, s[8:11], s74 offen offset:1024 sc1
    v_mfma_f32_32x32x16_bf16 v[16:31], v[92:95], v[236:239], v[16:31]
    ds_read_b128 v[88:91], v9 offset:2048
    v_mul_f32 v49, v49, v57
    v_fma_f32 v112, v112, v14, v14
    v_rcp_f32 v112, v112
    v_mul_f32 v114, v50, v50
    s_waitcnt lgkmcnt(3)
    v_mfma_f32_32x32x16_bf16 v[16:31], v[96:99], v[240:243], v[16:31]
    ds_read_b128 v[92:95], v9 offset:3072
    v_fma_f32 v114, v114, v13, v12
    v_mul_f32 v114, v114, v50
    v_exp_f32 v114, v114
    v_mfma_f32_32x32x16_bf16 v[16:31], v[100:103], v[244:247], v[16:31]
    ds_read_b128 v[96:99], v9 offset:4096
L_pad19712:
    s_cbranch_execz L_ret_p2s0
    buffer_load_dwordx4 a[204:207], v15, s[8:11], s75 offen offset:1024 sc1
    v_mul_f32 v50, v50, v58
    v_mfma_f32_32x32x16_bf16 v[16:31], v[104:107], v[248:251], v[16:31]
    ds_read_b128 v[100:103], v9 offset:5120
    v_fma_f32 v113, v113, v14, v14
    v_rcp_f32 v113, v113
    v_mul_f32 v115, v51, v51
    v_mul_f32 v48, v48, v112
    v_mfma_f32_32x32x16_bf16 v[16:31], v[108:111], v[252:255], v[16:31]
    ds_read_b128 v[104:107], v9 offset:6144
    v_fma_f32 v115, v115, v13, v12
    buffer_load_dwordx4 a[208:211], v7, s[8:11], s74 offen offset:1024 sc1
    v_mfma_f32_32x32x16_bf16 v[16:31], v[124:127], v[68:71], v[16:31]
    v_mul_f32 v115, v115, v51
    v_exp_f32 v115, v115
    v_mul_f32 v51, v51, v59
    v_fma_f32 v114, v114, v14, v14
    v_rcp_f32 v114, v114
    v_mul_f32 v116, v52, v52
    s_waitcnt lgkmcnt(3)
    v_mfma_f32_32x32x16_bf16 v[32:47], v[80:83], v[128:131], 0
    ds_read_b128 v[108:111], v9 offset:7168
    v_mul_f32 v49, v49, v113
    buffer_load_dwordx4 a[212:215], v7, s[8:11], s75 offen offset:1024 sc1
    v_mfma_f32_32x32x16_bf16 v[32:47], v[84:87], v[132:135], v[32:47]
    ds_read_b128 v[80:83], v9 offset:8192
    v_cvt_pk_bf16_f32 v120, v48, v49
    v_fma_f32 v116, v116, v13, v12
    v_mul_f32 v116, v116, v52
    v_exp_f32 v116, v116
    v_mfma_f32_32x32x16_bf16 v[32:47], v[88:91], v[136:139], v[32:47]
    ds_read_b128 v[84:87], v9 offset:9216
    v_mul_f32 v52, v52, v60
    v_fma_f32 v115, v115, v14, v14
    v_mfma_f32_32x32x16_bf16 v[32:47], v[92:95], v[140:143], v[32:47]
    ds_read_b128 v[88:91], v9 offset:10240
    buffer_load_dwordx4 a[216:219], v10, s[8:11], s74 offen offset:1024 sc1
    s_waitcnt lgkmcnt(3)
    v_mfma_f32_32x32x16_bf16 v[32:47], v[96:99], v[144:147], v[32:47]
    v_lshlrev_b32 v6, 10, v5
    v_lshl_add_u32 v6, v4, 4, v6
    ds_read_b128 v[92:95], v9 offset:11264
    v_rcp_f32 v115, v115
    v_mul_f32 v117, v53, v53
    v_mul_f32 v50, v50, v114
    v_mfma_f32_32x32x16_bf16 v[32:47], v[100:103], v[148:151], v[32:47]
    ds_read_b128 v[96:99], v9 offset:12288
    v_fma_f32 v117, v117, v13, v12
    v_mul_f32 v117, v117, v53
    v_exp_f32 v117, v117
    v_mfma_f32_32x32x16_bf16 v[32:47], v[104:107], v[152:155], v[32:47]
    ds_read_b128 v[100:103], v9 offset:13312
    buffer_load_dwordx4 a[220:223], v10, s[8:11], s75 offen offset:1024 sc1
    v_mul_f32 v53, v53, v61
    v_fma_f32 v116, v116, v14, v14
    v_mfma_f32_32x32x16_bf16 v[32:47], v[108:111], v[156:159], v[32:47]
    ds_read_b128 v[104:107], v9 offset:14336
    v_rcp_f32 v116, v116
    v_mul_f32 v118, v54, v54
    v_mul_f32 v51, v51, v115
    v_cvt_pk_bf16_f32 v121, v50, v51
    s_waitcnt lgkmcnt(3)
    v_mfma_f32_32x32x16_bf16 v[32:47], v[80:83], v[160:163], v[32:47]
    ds_read_b128 v[108:111], v9 offset:15360
    v_fma_f32 v118, v118, v13, v12
    buffer_load_dwordx4 a[64:67], v1, s[8:11], s76 offen offset:0 sc1
    v_mfma_f32_32x32x16_bf16 v[32:47], v[84:87], v[164:167], v[32:47]
    s_add_u32 s38, s35, 0x230a000
    v_mov_b32 v3, 1
    v_mul_f32 v118, v118, v54
    v_exp_f32 v118, v118
    v_mul_f32 v54, v54, v62
    s_waitcnt vmcnt(8)
    s_mov_b64 exec, 1
    buffer_atomic_add v3, off, s[8:11], s38 sc1
    s_mov_b64 exec, -1
    ds_read_b128 v[80:83], v9 offset:16384
    v_mfma_f32_32x32x16_bf16 v[32:47], v[88:91], v[168:171], v[32:47]
    ds_read_b128 v[84:87], v9 offset:17408
    v_fma_f32 v117, v117, v14, v14
    v_rcp_f32 v117, v117
    v_mul_f32 v119, v55, v55
    v_mfma_f32_32x32x16_bf16 v[32:47], v[92:95], v[172:175], v[32:47]
    ds_read_b128 v[88:91], v9 offset:18432
    buffer_load_dwordx4 a[68:71], v1, s[8:11], s77 offen offset:0 sc1
    v_mul_f32 v52, v52, v116
    v_fma_f32 v119, v119, v13, v12
    s_waitcnt lgkmcnt(3)
    v_mfma_f32_32x32x16_bf16 v[32:47], v[96:99], v[176:179], v[32:47]
    ds_read_b128 v[92:95], v9 offset:19456
    v_mul_f32 v119, v119, v55
    v_exp_f32 v119, v119
    v_mul_f32 v55, v55, v63
    v_fma_f32 v118, v118, v14, v14
    v_mfma_f32_32x32x16_bf16 v[32:47], v[100:103], v[180:183], v[32:47]
    ds_read_b128 v[96:99], v9 offset:20480
    buffer_load_dwordx4 a[72:75], v15, s[8:11], s76 offen offset:0 sc1
    v_mfma_f32_32x32x16_bf16 v[32:47], v[104:107], v[184:187], v[32:47]
    ds_read_b128 v[100:103], v9 offset:21504
    v_rcp_f32 v118, v118
    v_mul_f32 v53, v53, v117
    v_cvt_pk_bf16_f32 v122, v52, v53
    v_fma_f32 v119, v119, v14, v14
    v_mfma_f32_32x32x16_bf16 v[32:47], v[108:111], v[188:191], v[32:47]
    ds_read_b128 v[104:107], v9 offset:22528
    v_rcp_f32 v119, v119
    v_mul_f32 v54, v54, v118
    v_mul_f32 v55, v55, v119
    s_waitcnt lgkmcnt(3)
    v_mfma_f32_32x32x16_bf16 v[32:47], v[80:83], v[192:195], v[32:47]
    ds_read_b128 v[108:111], v9 offset:23552
    buffer_load_dwordx4 a[76:79], v15, s[8:11], s77 offen offset:0 sc1
    v_cvt_pk_bf16_f32 v123, v54, v55
    v_mfma_f32_32x32x16_bf16 v[32:47], v[84:87], v[196:199], v[32:47]
    ds_read_b128 v[80:83], v9 offset:24576
    buffer_store_dwordx4 v[120:123], v1, s[8:11], s33 offen offset:2048 sc1
    v_mul_f32 v112, v16, v16
    v_mfma_f32_32x32x16_bf16 v[32:47], v[88:91], v[200:203], v[32:47]
    ds_read_b128 v[84:87], v9 offset:25600
    v_fma_f32 v112, v112, v13, v12
    v_mul_f32 v112, v112, v16
    v_exp_f32 v112, v112
    v_mfma_f32_32x32x16_bf16 v[32:47], v[92:95], v[204:207], v[32:47]
    ds_read_b128 v[88:91], v9 offset:26624
    buffer_load_dwordx4 a[80:83], v7, s[8:11], s76 offen offset:0 sc1
    v_mul_f32 v16, v16, v24
    v_mul_f32 v113, v17, v17
    s_waitcnt lgkmcnt(3)
    v_mfma_f32_32x32x16_bf16 v[32:47], v[96:99], v[208:211], v[32:47]
    ds_read_b128 v[92:95], v9 offset:27648
    v_fma_f32 v113, v113, v13, v12
    v_mul_f32 v113, v113, v17
    v_exp_f32 v113, v113
    v_mul_f32 v17, v17, v25
    v_mfma_f32_32x32x16_bf16 v[32:47], v[100:103], v[212:215], v[32:47]
    ds_read_b128 v[96:99], v9 offset:28672
    v_fma_f32 v112, v112, v14, v14
    buffer_load_dwordx4 a[84:87], v7, s[8:11], s77 offen offset:0 sc1
    v_mfma_f32_32x32x16_bf16 v[32:47], v[104:107], v[216:219], v[32:47]
    ds_read_b128 v[100:103], v9 offset:29696
    v_rcp_f32 v112, v112
    v_mul_f32 v114, v18, v18
    v_fma_f32 v114, v114, v13, v12
    v_mul_f32 v114, v114, v18
    v_mfma_f32_32x32x16_bf16 v[32:47], v[108:111], v[220:223], v[32:47]
    ds_read_b128 v[104:107], v9 offset:30720
    v_exp_f32 v114, v114
    v_mul_f32 v18, v18, v26
    s_waitcnt lgkmcnt(3)
    v_mfma_f32_32x32x16_bf16 v[32:47], v[80:83], v[224:227], v[32:47]
    ds_read_b128 v[108:111], v9 offset:31744
    buffer_load_dwordx4 a[88:91], v10, s[8:11], s76 offen offset:0 sc1
    v_fma_f32 v113, v113, v14, v14
    v_mfma_f32_32x32x16_bf16 v[32:47], v[84:87], v[228:231], v[32:47]
    v_rcp_f32 v113, v113
    v_mul_f32 v115, v19, v19
    v_mul_f32 v16, v16, v112
    v_fma_f32 v115, v115, v13, v12
    s_barrier
    ds_read_b128 v[80:83], v1 offset:0
    v_mfma_f32_32x32x16_bf16 v[32:47], v[88:91], v[232:235], v[32:47]
    ds_read_b128 v[84:87], v1 offset:1024
    v_mul_f32 v115, v115, v19
    buffer_load_dwordx4 a[92:95], v10, s[8:11], s77 offen offset:0 sc1
    v_mfma_f32_32x32x16_bf16 v[32:47], v[92:95], v[236:239], v[32:47]
    ds_read_b128 v[88:91], v1 offset:2048
    v_exp_f32 v115, v115
    v_mul_f32 v19, v19, v27
    v_fma_f32 v114, v114, v14, v14
    s_waitcnt lgkmcnt(3)
    v_mfma_f32_32x32x16_bf16 v[32:47], v[96:99], v[240:243], v[32:47]
    ds_read_b128 v[92:95], v1 offset:3072
    v_rcp_f32 v114, v114
    v_mul_f32 v116, v20, v20
    v_mul_f32 v17, v17, v113
    v_cvt_pk_bf16_f32 v120, v16, v17
    v_mfma_f32_32x32x16_bf16 v[32:47], v[100:103], v[244:247], v[32:47]
    ds_read_b128 v[96:99], v1 offset:4096
    buffer_load_dwordx4 a[96:99], v1, s[8:11], s76 offen offset:1024 sc1
    v_fma_f32 v116, v116, v13, v12
    v_mfma_f32_32x32x16_bf16 v[32:47], v[104:107], v[248:251], v[32:47]
    ds_read_b128 v[100:103], v1 offset:5120
    v_mul_f32 v116, v116, v20
    v_exp_f32 v116, v116
    v_mul_f32 v20, v20, v28
    v_fma_f32 v115, v115, v14, v14
    v_mfma_f32_32x32x16_bf16 v[32:47], v[108:111], v[252:255], v[32:47]
    ds_read_b128 v[104:107], v1 offset:6144
    v_rcp_f32 v115, v115
    v_mfma_f32_32x32x16_bf16 v[32:47], v[76:79], v[66:69], v[32:47]
    buffer_load_dwordx4 a[100:103], v1, s[8:11], s77 offen offset:1024 sc1
    v_mul_f32 v117, v21, v21
    v_mul_f32 v18, v18, v114
    v_fma_f32 v117, v117, v13, v12
    v_mul_f32 v117, v117, v21
    v_exp_f32 v117, v117
    v_mul_f32 v21, v21, v29
    s_waitcnt lgkmcnt(3)
    v_mfma_f32_32x32x16_bf16 v[48:63], v[80:83], v[128:131], 0
    ds_read_b128 v[108:111], v1 offset:7168
    v_fma_f32 v116, v116, v14, v14
    buffer_load_dwordx4 a[104:107], v15, s[8:11], s76 offen offset:1024 sc1
    v_mfma_f32_32x32x16_bf16 v[48:63], v[84:87], v[132:135], v[48:63]
    ds_read_b128 v[80:83], v1 offset:8192
    v_rcp_f32 v116, v116
    v_mul_f32 v118, v22, v22
    v_mul_f32 v19, v19, v115
    v_cvt_pk_bf16_f32 v121, v18, v19
    v_mfma_f32_32x32x16_bf16 v[48:63], v[88:91], v[136:139], v[48:63]
    ds_read_b128 v[84:87], v1 offset:9216
    v_fma_f32 v118, v118, v13, v12
    buffer_load_dwordx4 a[108:111], v15, s[8:11], s77 offen offset:1024 sc1
    v_mfma_f32_32x32x16_bf16 v[48:63], v[92:95], v[140:143], v[48:63]
    s_add_u32 s38, s35, 0x2312000
    v_mov_b32 v3, 1
    v_mul_f32 v118, v118, v22
    s_waitcnt vmcnt(8)
    s_mov_b64 exec, 1
    buffer_atomic_add v3, off, s[8:11], s38 sc1
    s_mov_b64 exec, -1
    ds_read_b128 v[88:91], v1 offset:10240
    s_waitcnt lgkmcnt(3)
    v_mfma_f32_32x32x16_bf16 v[48:63], v[96:99], v[144:147], v[48:63]
    ds_read_b128 v[92:95], v1 offset:11264
    v_exp_f32 v118, v118
    v_mul_f32 v22, v22, v30
    v_fma_f32 v117, v117, v14, v14
    v_mfma_f32_32x32x16_bf16 v[48:63], v[100:103], v[148:151], v[48:63]
    ds_read_b128 v[96:99], v1 offset:12288
    v_rcp_f32 v117, v117
    v_mul_f32 v119, v23, v23
    v_mfma_f32_32x32x16_bf16 v[48:63], v[104:107], v[152:155], v[48:63]
    ds_read_b128 v[100:103], v1 offset:13312
    buffer_load_dwordx4 a[112:115], v7, s[8:11], s76 offen offset:1024 sc1
    v_mul_f32 v20, v20, v116
    v_fma_f32 v119, v119, v13, v12
    v_mul_f32 v119, v119, v23
    v_mfma_f32_32x32x16_bf16 v[48:63], v[108:111], v[156:159], v[48:63]
    ds_read_b128 v[104:107], v1 offset:14336
    v_exp_f32 v119, v119
    v_mul_f32 v23, v23, v31
    v_fma_f32 v118, v118, v14, v14
    s_waitcnt lgkmcnt(3)
    v_mfma_f32_32x32x16_bf16 v[48:63], v[80:83], v[160:163], v[48:63]
    s_add_u32 s56, s36, 0x230a000
    s_load_dword s92, s[4:5], s56 glc
    ds_read_b128 v[108:111], v1 offset:15360
    buffer_load_dwordx4 a[116:119], v7, s[8:11], s77 offen offset:1024 sc1
    v_rcp_f32 v118, v118
    v_mfma_f32_32x32x16_bf16 v[48:63], v[84:87], v[164:167], v[48:63]
    ds_read_b128 v[80:83], v1 offset:16384
    v_mul_f32 v21, v21, v117
    v_cvt_pk_bf16_f32 v122, v20, v21
    v_fma_f32 v119, v119, v14, v14
    v_rcp_f32 v119, v119
    v_mfma_f32_32x32x16_bf16 v[48:63], v[88:91], v[168:171], v[48:63]
    ds_read_b128 v[84:87], v1 offset:17408
    v_mul_f32 v22, v22, v118
    buffer_load_dwordx4 a[120:123], v10, s[8:11], s76 offen offset:1024 sc1
    v_mfma_f32_32x32x16_bf16 v[48:63], v[92:95], v[172:175], v[48:63]
    ds_read_b128 v[88:91], v1 offset:18432
    v_mul_f32 v23, v23, v119
    v_cvt_pk_bf16_f32 v123, v22, v23
    s_waitcnt lgkmcnt(3)
    v_mfma_f32_32x32x16_bf16 v[48:63], v[96:99], v[176:179], v[48:63]
    ds_read_b128 v[92:95], v1 offset:19456
    buffer_store_dwordx4 v[120:123], v1, s[8:11], s33 offen offset:3072 sc1
    v_mul_f32 v112, v32, v32
    v_fma_f32 v112, v112, v13, v12
    v_mul_f32 v112, v112, v32
    v_mfma_f32_32x32x16_bf16 v[48:63], v[100:103], v[180:183], v[48:63]
    ds_read_b128 v[96:99], v1 offset:20480
    buffer_load_dwordx4 a[124:127], v10, s[8:11], s77 offen offset:1024 sc1
    v_exp_f32 v112, v112
    v_mfma_f32_32x32x16_bf16 v[48:63], v[104:107], v[184:187], v[48:63]
    ds_read_b128 v[100:103], v1 offset:21504
    v_mul_f32 v32, v32, v40
    v_mul_f32 v113, v33, v33
    v_fma_f32 v113, v113, v13, v12
    v_mul_f32 v113, v113, v33
    v_mfma_f32_32x32x16_bf16 v[48:63], v[108:111], v[188:191], v[48:63]
    ds_read_b128 v[104:107], v1 offset:22528
    v_exp_f32 v113, v113
    buffer_load_dwordx4 a[128:131], v1, s[8:11], s76 offen offset:2048 sc1
    s_waitcnt lgkmcnt(3)
    v_mfma_f32_32x32x16_bf16 v[48:63], v[80:83], v[192:195], v[48:63]
    ds_read_b128 v[108:111], v1 offset:23552
    v_mul_f32 v33, v33, v41
    v_fma_f32 v112, v112, v14, v14
    v_rcp_f32 v112, v112
    v_mul_f32 v114, v34, v34
    v_mfma_f32_32x32x16_bf16 v[48:63], v[84:87], v[196:199], v[48:63]
    ds_read_b128 v[80:83], v1 offset:24576
    v_fma_f32 v114, v114, v13, v12
    v_mul_f32 v114, v114, v34
    v_mfma_f32_32x32x16_bf16 v[48:63], v[88:91], v[200:203], v[48:63]
    ds_read_b128 v[84:87], v1 offset:25600
    buffer_load_dwordx4 a[132:135], v1, s[8:11], s77 offen offset:2048 sc1
    v_exp_f32 v114, v114
    v_mul_f32 v34, v34, v42
    v_mfma_f32_32x32x16_bf16 v[48:63], v[92:95], v[204:207], v[48:63]
    ds_read_b128 v[88:91], v1 offset:26624
    v_fma_f32 v113, v113, v14, v14
    v_rcp_f32 v113, v113
    v_mul_f32 v115, v35, v35
    v_mul_f32 v32, v32, v112
    s_waitcnt lgkmcnt(3)
    v_mfma_f32_32x32x16_bf16 v[48:63], v[96:99], v[208:211], v[48:63]
    ds_read_b128 v[92:95], v1 offset:27648
    buffer_load_dwordx4 a[136:139], v15, s[8:11], s76 offen offset:2048 sc1
    v_fma_f32 v115, v115, v13, v12
    v_mfma_f32_32x32x16_bf16 v[48:63], v[100:103], v[212:215], v[48:63]
    ds_read_b128 v[96:99], v1 offset:28672
    v_mul_f32 v115, v115, v35
    v_exp_f32 v115, v115
    v_mul_f32 v35, v35, v43
    v_fma_f32 v114, v114, v14, v14
    v_mfma_f32_32x32x16_bf16 v[48:63], v[104:107], v[216:219], v[48:63]
    ds_read_b128 v[100:103], v1 offset:29696
    v_rcp_f32 v114, v114
    v_mfma_f32_32x32x16_bf16 v[48:63], v[108:111], v[220:223], v[48:63]
    ds_read_b128 v[104:107], v1 offset:30720
    buffer_load_dwordx4 a[140:143], v15, s[8:11], s77 offen offset:2048 sc1
    v_mul_f32 v116, v36, v36
    v_mul_f32 v33, v33, v113
    v_cvt_pk_bf16_f32 v120, v32, v33
    v_fma_f32 v116, v116, v13, v12
    s_waitcnt lgkmcnt(3)
    v_mfma_f32_32x32x16_bf16 v[48:63], v[80:83], v[224:227], v[48:63]
    s_add_u32 s56, s36, 0x230a000
    v_mul_f32 v116, v116, v36
    v_exp_f32 v116, v116
    s_waitcnt lgkmcnt(0)
    s_mov_b32 s57, 100000
    s_cmp_eq_u32 s92, 8
    s_cbranch_scc1 L_pc_ok7
L_pc7:
    s_load_dword s92, s[4:5], s56 glc
    s_sub_u32 s57, s57, 1
    s_cbranch_scc1 L_pc_ok7
    s_waitcnt lgkmcnt(0)
    s_cmp_lg_u32 s92, 8
    s_cbranch_scc1 L_pc7
L_pc_ok7:
    buffer_load_dwordx4 a[224:227], v1, s[8:11], s79 offen offset:0 sc1
    ds_read_b128 v[108:111], v1 offset:31744
    v_mfma_f32_32x32x16_bf16 v[48:63], v[84:87], v[228:231], v[48:63]
    ds_read_b128 v[80:83], v1 offset:32768
    buffer_load_dwordx4 a[144:147], v7, s[8:11], s76 offen offset:2048 sc1
    v_mul_f32 v36, v36, v44
    v_fma_f32 v115, v115, v14, v14
    v_mfma_f32_32x32x16_bf16 v[48:63], v[88:91], v[232:235], v[48:63]
    buffer_load_dwordx4 a[228:231], v15, s[8:11], s79 offen offset:0 sc1
    ds_read_b128 v[84:87], v1 offset:33792
    v_rcp_f32 v115, v115
    v_mul_f32 v117, v37, v37
    v_mul_f32 v34, v34, v114
    v_fma_f32 v117, v117, v13, v12
    v_mfma_f32_32x32x16_bf16 v[48:63], v[92:95], v[236:239], v[48:63]
    ds_read_b128 v[88:91], v1 offset:34816
    buffer_load_dwordx4 a[148:151], v7, s[8:11], s77 offen offset:2048 sc1
    v_mul_f32 v117, v117, v37
    s_waitcnt lgkmcnt(3)
    v_mfma_f32_32x32x16_bf16 v[48:63], v[96:99], v[240:243], v[48:63]
    buffer_load_dwordx4 a[232:235], v7, s[8:11], s79 offen offset:0 sc1
    ds_read_b128 v[92:95], v1 offset:35840
    v_exp_f32 v117, v117
    v_mul_f32 v37, v37, v45
    v_fma_f32 v116, v116, v14, v14
    v_mfma_f32_32x32x16_bf16 v[48:63], v[100:103], v[244:247], v[48:63]
    ds_read_b128 v[96:99], v1 offset:36864
    v_rcp_f32 v116, v116
    v_mul_f32 v118, v38, v38
    v_mfma_f32_32x32x16_bf16 v[48:63], v[104:107], v[248:251], v[48:63]
    ds_read_b128 v[100:103], v1 offset:37888
    buffer_load_dwordx4 a[152:155], v10, s[8:11], s76 offen offset:2048 sc1
    v_mul_f32 v35, v35, v115
    v_cvt_pk_bf16_f32 v121, v34, v35
    v_fma_f32 v118, v118, v13, v12
    v_mul_f32 v118, v118, v38
    v_mfma_f32_32x32x16_bf16 v[48:63], v[108:111], v[252:255], v[48:63]
    buffer_load_dwordx4 a[236:239], v10, s[8:11], s79 offen offset:0 sc1
    s_add_u32 s38, s35, 0x231a000
    v_mov_b32 v3, 1
    v_exp_f32 v118, v118
    v_mul_f32 v38, v38, v46
    s_waitcnt vmcnt(12)
    s_mov_b64 exec, 1
    buffer_atomic_add v3, off, s[8:11], s38 sc1
    s_mov_b64 exec, -1
    ds_read_b128 v[104:107], v1 offset:38912
    v_mfma_f32_32x32x16_bf16 v[48:63], v[76:79], v[64:67], v[48:63]
    buffer_load_dwordx4 a[156:159], v10, s[8:11], s77 offen offset:2048 sc1
    v_fma_f32 v117, v117, v14, v14
    v_rcp_f32 v117, v117
    v_mul_f32 v119, v39, v39
    v_mul_f32 v36, v36, v116
    v_fma_f32 v119, v119, v13, v12
    s_waitcnt lgkmcnt(3)
    v_mfma_f32_32x32x16_bf16 v[16:31], v[80:83], v[128:131], 0
    buffer_load_dwordx4 a[240:243], v1, s[8:11], s79 offen offset:1024 sc1
    ds_read_b128 v[108:111], v1 offset:39936
    v_mul_f32 v119, v119, v39
    v_mfma_f32_32x32x16_bf16 v[16:31], v[84:87], v[132:135], v[16:31]
    ds_read_b128 v[80:83], v1 offset:40960
    v_exp_f32 v119, v119
    v_mul_f32 v39, v39, v47
    v_fma_f32 v118, v118, v14, v14
    v_mfma_f32_32x32x16_bf16 v[16:31], v[88:91], v[136:139], v[16:31]
    ds_read_b128 v[84:87], v1 offset:41984
    v_rcp_f32 v118, v118
    v_mul_f32 v37, v37, v117
    v_cvt_pk_bf16_f32 v122, v36, v37
    v_fma_f32 v119, v119, v14, v14
    v_mfma_f32_32x32x16_bf16 v[16:31], v[92:95], v[140:143], v[16:31]
    buffer_load_dwordx4 a[244:247], v15, s[8:11], s79 offen offset:1024 sc1
    ds_read_b128 v[88:91], v1 offset:43008
    s_waitcnt lgkmcnt(3)
    v_mfma_f32_32x32x16_bf16 v[16:31], v[96:99], v[144:147], v[16:31]
    ds_read_b128 v[92:95], v1 offset:44032
    v_rcp_f32 v119, v119
    v_mul_f32 v38, v38, v118
    v_mul_f32 v39, v39, v119
    v_cvt_pk_bf16_f32 v123, v38, v39
    v_mfma_f32_32x32x16_bf16 v[16:31], v[100:103], v[148:151], v[16:31]
    buffer_load_dwordx4 a[248:251], v7, s[8:11], s79 offen offset:1024 sc1
    ds_read_b128 v[96:99], v1 offset:45056
    s_add_u32 s33, s33, 4096
    v_mfma_f32_32x32x16_bf16 v[16:31], v[104:107], v[152:155], v[16:31]
    ds_read_b128 v[100:103], v1 offset:46080
    buffer_store_dwordx4 v[120:123], v1, s[8:11], s33 offen offset:0 sc1
    v_mul_f32 v112, v48, v48
    v_mfma_f32_32x32x16_bf16 v[16:31], v[108:111], v[156:159], v[16:31]
    buffer_load_dwordx4 a[252:255], v10, s[8:11], s79 offen offset:1024 sc1
    ds_read_b128 v[104:107], v1 offset:47104
    v_fma_f32 v112, v112, v13, v12
    v_mul_f32 v112, v112, v48
    s_waitcnt lgkmcnt(3)
    v_mfma_f32_32x32x16_bf16 v[16:31], v[80:83], v[160:163], v[16:31]
    ds_read_b128 v[108:111], v1 offset:48128
    v_exp_f32 v112, v112
    v_mul_f32 v48, v48, v56
    v_mul_f32 v113, v49, v49
    v_fma_f32 v113, v113, v13, v12
    v_mfma_f32_32x32x16_bf16 v[16:31], v[84:87], v[164:167], v[16:31]
    ds_read_b128 v[80:83], v1 offset:49152
    v_mul_f32 v113, v113, v49
    v_exp_f32 v113, v113
    v_mul_f32 v49, v49, v57
    v_fma_f32 v112, v112, v14, v14
    v_mfma_f32_32x32x16_bf16 v[16:31], v[88:91], v[168:171], v[16:31]
    buffer_load_dwordx4 v[128:131], v1, s[8:11], s78 offen offset:0 sc1
    ds_read_b128 v[84:87], v1 offset:50176
    v_mfma_f32_32x32x16_bf16 v[16:31], v[92:95], v[172:175], v[16:31]
    ds_read_b128 v[88:91], v1 offset:51200
    v_rcp_f32 v112, v112
    v_mul_f32 v114, v50, v50
    v_fma_f32 v114, v114, v13, v12
    s_waitcnt lgkmcnt(3)
    v_mfma_f32_32x32x16_bf16 v[16:31], v[96:99], v[176:179], v[16:31]
    buffer_load_dwordx4 v[132:135], v15, s[8:11], s78 offen offset:0 sc1
    ds_read_b128 v[92:95], v1 offset:52224
    v_mul_f32 v114, v114, v50
    v_mfma_f32_32x32x16_bf16 v[16:31], v[100:103], v[180:183], v[16:31]
    s_add_u32 s56, s36, 0x2312000
    s_load_dword s93, s[4:5], s56 glc
    ds_read_b128 v[96:99], v1 offset:53248
    v_exp_f32 v114, v114
    v_mul_f32 v50, v50, v58
    v_fma_f32 v113, v113, v14, v14
    v_mfma_f32_32x32x16_bf16 v[16:31], v[104:107], v[184:187], v[16:31]
    ds_read_b128 v[100:103], v1 offset:54272
    v_rcp_f32 v113, v113
    v_mul_f32 v115, v51, v51
    v_mul_f32 v48, v48, v112
    v_fma_f32 v115, v115, v13, v12
    v_mfma_f32_32x32x16_bf16 v[16:31], v[108:111], v[188:191], v[16:31]
    buffer_load_dwordx4 v[136:139], v7, s[8:11], s78 offen offset:0 sc1
    ds_read_b128 v[104:107], v1 offset:55296
    v_mul_f32 v115, v115, v51
    s_waitcnt lgkmcnt(3)
    v_mfma_f32_32x32x16_bf16 v[16:31], v[80:83], v[192:195], v[16:31]
    ds_read_b128 v[108:111], v1 offset:56320
    v_exp_f32 v115, v115
    v_mul_f32 v51, v51, v59
    v_fma_f32 v114, v114, v14, v14
    v_mfma_f32_32x32x16_bf16 v[16:31], v[84:87], v[196:199], v[16:31]
    buffer_load_dwordx4 v[140:143], v10, s[8:11], s78 offen offset:0 sc1
    ds_read_b128 v[80:83], v1 offset:57344
    v_rcp_f32 v114, v114
    v_mul_f32 v116, v52, v52
    v_mfma_f32_32x32x16_bf16 v[16:31], v[88:91], v[200:203], v[16:31]
    ds_read_b128 v[84:87], v1 offset:58368
    v_mul_f32 v49, v49, v113
    v_cvt_pk_bf16_f32 v120, v48, v49
    v_fma_f32 v116, v116, v13, v12
    v_mul_f32 v116, v116, v52
    v_mfma_f32_32x32x16_bf16 v[16:31], v[92:95], v[204:207], v[16:31]
    buffer_load_dwordx4 v[144:147], v1, s[8:11], s78 offen offset:1024 sc1
    ds_read_b128 v[88:91], v1 offset:59392
    v_exp_f32 v116, v116
    v_mul_f32 v52, v52, v60
    s_waitcnt lgkmcnt(3)
    v_mfma_f32_32x32x16_bf16 v[16:31], v[96:99], v[208:211], v[16:31]
    ds_read_b128 v[92:95], v1 offset:60416
    v_fma_f32 v115, v115, v14, v14
    v_rcp_f32 v115, v115
    v_mul_f32 v117, v53, v53
    v_mul_f32 v50, v50, v114
    v_mfma_f32_32x32x16_bf16 v[16:31], v[100:103], v[212:215], v[16:31]
    ds_read_b128 v[96:99], v1 offset:61440
    v_fma_f32 v117, v117, v13, v12
    v_mul_f32 v117, v117, v53
    v_exp_f32 v117, v117
    v_mul_f32 v53, v53, v61
    v_mfma_f32_32x32x16_bf16 v[16:31], v[104:107], v[216:219], v[16:31]
    buffer_load_dwordx4 v[148:151], v15, s[8:11], s78 offen offset:1024 sc1
    ds_read_b128 v[100:103], v1 offset:62464
    v_fma_f32 v116, v116, v14, v14
    v_mfma_f32_32x32x16_bf16 v[16:31], v[108:111], v[220:223], v[16:31]
    ds_read_b128 v[104:107], v1 offset:63488
    v_rcp_f32 v116, v116
    v_mul_f32 v118, v54, v54
    v_mul_f32 v51, v51, v115
    s_waitcnt lgkmcnt(3)
    v_mfma_f32_32x32x16_bf16 v[16:31], v[80:83], v[224:227], v[16:31]
    buffer_load_dwordx4 v[152:155], v7, s[8:11], s78 offen offset:1024 sc1
    ds_read_b128 v[108:111], v1 offset:64512
    v_cvt_pk_bf16_f32 v121, v50, v51
    v_mfma_f32_32x32x16_bf16 v[16:31], v[84:87], v[228:231], v[16:31]
    s_add_u32 s38, s35, 0x2322000
    v_mov_b32 v3, 1
    v_fma_f32 v118, v118, v13, v12
    v_mul_f32 v118, v118, v54
    v_exp_f32 v118, v118
    s_waitcnt vmcnt(8)
    s_mov_b64 exec, 1
    buffer_atomic_add v3, off, s[8:11], s38 sc1
    s_mov_b64 exec, -1
    v_mfma_f32_32x32x16_bf16 v[16:31], v[88:91], v[232:235], v[16:31]
    v_mul_f32 v54, v54, v62
    v_fma_f32 v117, v117, v14, v14
    v_rcp_f32 v117, v117
    v_mul_f32 v119, v55, v55
    v_mul_f32 v52, v52, v116
    v_mfma_f32_32x32x16_bf16 v[16:31], v[92:95], v[236:239], v[16:31]
    buffer_load_dwordx4 v[156:159], v10, s[8:11], s78 offen offset:1024 sc1
    v_fma_f32 v119, v119, v13, v12
    s_waitcnt lgkmcnt(0)
    v_mfma_f32_32x32x16_bf16 v[16:31], v[96:99], v[240:243], v[16:31]
    v_mul_f32 v119, v119, v55
    v_exp_f32 v119, v119
    v_mul_f32 v55, v55, v63
    v_fma_f32 v118, v118, v14, v14
    v_mfma_f32_32x32x16_bf16 v[16:31], v[100:103], v[244:247], v[16:31]
    s_add_u32 s56, s36, 0x2312000
    s_waitcnt lgkmcnt(0)
    s_mov_b32 s57, 100000
    s_cmp_eq_u32 s93, 8
    s_cbranch_scc1 L_pc_ok8
L_pc8:
    s_load_dword s93, s[4:5], s56 glc
    s_sub_u32 s57, s57, 1
    s_cbranch_scc1 L_pc_ok8
    s_waitcnt lgkmcnt(0)
    s_cmp_lg_u32 s93, 8
    s_cbranch_scc1 L_pc8
L_pc_ok8:
    buffer_load_dwordx4 v[160:163], v1, s[8:11], s79 offen offset:2048 sc1
    v_mfma_f32_32x32x16_bf16 v[16:31], v[104:107], v[248:251], v[16:31]
    v_rcp_f32 v118, v118
    v_mul_f32 v53, v53, v117
    v_cvt_pk_bf16_f32 v122, v52, v53
    v_fma_f32 v119, v119, v14, v14
    v_mfma_f32_32x32x16_bf16 v[16:31], v[108:111], v[252:255], v[16:31]
    buffer_load_dwordx4 v[164:167], v15, s[8:11], s79 offen offset:2048 sc1
    v_rcp_f32 v119, v119
    v_mfma_f32_32x32x16_bf16 v[16:31], v[76:79], v[70:73], v[16:31]
    v_mul_f32 v54, v54, v118
    v_mul_f32 v55, v55, v119
    v_cvt_pk_bf16_f32 v123, v54, v55
    buffer_store_dwordx4 v[120:123], v1, s[8:11], s33 offen offset:1024 sc1
    s_nop 7
    v_mul_f32 v112, v16, v16
    v_fma_f32 v112, v112, v13, v12
    v_mul_f32 v112, v112, v16
    v_exp_f32 v112, v112
    v_mul_f32 v16, v16, v24
    v_mul_f32 v113, v17, v17
    v_fma_f32 v113, v113, v13, v12
    v_mul_f32 v113, v113, v17
    v_exp_f32 v113, v113
    v_mul_f32 v17, v17, v25
    buffer_load_dwordx4 v[168:171], v7, s[8:11], s79 offen offset:2048 sc1
    v_fma_f32 v112, v112, v14, v14
    v_rcp_f32 v112, v112
    v_mul_f32 v114, v18, v18
    v_fma_f32 v114, v114, v13, v12
    v_mul_f32 v114, v114, v18
    v_exp_f32 v114, v114
    v_mul_f32 v18, v18, v26
    v_fma_f32 v113, v113, v14, v14
    v_rcp_f32 v113, v113
    v_mul_f32 v115, v19, v19
    buffer_load_dwordx4 v[172:175], v10, s[8:11], s79 offen offset:2048 sc1
    v_mul_f32 v16, v16, v112
    v_fma_f32 v115, v115, v13, v12
    v_mul_f32 v115, v115, v19
    v_exp_f32 v115, v115
    v_mul_f32 v19, v19, v27
    v_fma_f32 v114, v114, v14, v14
    v_rcp_f32 v114, v114
    v_mul_f32 v116, v20, v20
    v_mul_f32 v17, v17, v113
    v_cvt_pk_bf16_f32 v120, v16, v17
    v_fma_f32 v116, v116, v13, v12
    v_mul_f32 v116, v116, v20
    v_exp_f32 v116, v116
    v_mul_f32 v20, v20, v28
    v_fma_f32 v115, v115, v14, v14
    v_rcp_f32 v115, v115
    buffer_load_dwordx4 v[176:179], v1, s[8:11], s78 offen offset:2048 sc1
    v_mul_f32 v117, v21, v21
    v_mul_f32 v18, v18, v114
    v_fma_f32 v117, v117, v13, v12
    v_mul_f32 v117, v117, v21
    v_exp_f32 v117, v117
    v_mul_f32 v21, v21, v29
    v_fma_f32 v116, v116, v14, v14
    v_rcp_f32 v116, v116
    v_mul_f32 v118, v22, v22
    v_mul_f32 v19, v19, v115
    v_cvt_pk_bf16_f32 v121, v18, v19
    buffer_load_dwordx4 v[180:183], v15, s[8:11], s78 offen offset:2048 sc1
    v_fma_f32 v118, v118, v13, v12
    v_mul_f32 v118, v118, v22
    v_exp_f32 v118, v118
    v_mul_f32 v22, v22, v30
    v_fma_f32 v117, v117, v14, v14
    v_rcp_f32 v117, v117
    v_mul_f32 v119, v23, v23
    v_mul_f32 v20, v20, v116
    v_fma_f32 v119, v119, v13, v12
    v_mul_f32 v119, v119, v23
    buffer_load_dwordx4 v[184:187], v7, s[8:11], s78 offen offset:2048 sc1
    v_exp_f32 v119, v119
    v_mul_f32 v23, v23, v31
    v_fma_f32 v118, v118, v14, v14
    v_rcp_f32 v118, v118
    v_mul_f32 v21, v21, v117
    v_cvt_pk_bf16_f32 v122, v20, v21
    v_fma_f32 v119, v119, v14, v14
    v_rcp_f32 v119, v119
    v_mul_f32 v22, v22, v118
    v_mul_f32 v23, v23, v119
    v_cvt_pk_bf16_f32 v123, v22, v23
    buffer_store_dwordx4 v[120:123], v1, s[8:11], s33 offen offset:2048 sc1
    v_mfma_f32_32x32x16_bf16 v[80:95], a[164:167], a[224:227], 0
    buffer_load_dwordx4 v[188:191], v10, s[8:11], s78 offen offset:2048 sc1
L_pad23808:
    s_cbranch_execz L_ret_p2s0
    s_xor_b32 s37, s3, 1
    s_mul_i32 s37, s37, 12288
    s_add_u32 s37, s37, 65536
    v_mfma_f32_32x32x16_bf16 v[64:79], a[160:163], a[224:227], 0
    v_add_u32 v114, s37, v1
    s_xor_b32 s37, s3, 2
    s_mul_i32 s37, s37, 12288
    v_mfma_f32_32x32x16_bf16 v[80:95], a[172:175], a[228:231], v[80:95]
    s_mul_i32 s40, s17, 49152
    s_add_u32 s41, s40, 0x0
    buffer_load_dwordx4 v[192:195], v1, s[8:11], s41 offen offset:0 sc1
    s_add_u32 s37, s37, 69632
    v_add_u32 v8, s37, v1
    s_xor_b32 s37, s3, 3
    v_mfma_f32_32x32x16_bf16 v[64:79], a[168:171], a[228:231], v[64:79]
    s_add_u32 s56, s36, 0x231a000
    s_load_dword s94, s[4:5], s56 glc
    s_mul_i32 s37, s37, 12288
    s_add_u32 s37, s37, 73728
    v_add_u32 v9, s37, v1
    v_mfma_f32_32x32x16_bf16 v[80:95], a[180:183], a[232:235], v[80:95]
    s_mul_i32 s37, s3, 12288
    s_add_u32 s37, s37, 65536
    v_add_u32 v115, s37, v1
    v_mfma_f32_32x32x16_bf16 v[64:79], a[176:179], a[232:235], v[64:79]
    buffer_load_dwordx4 v[96:99], v6, s[8:11], s85 offen sc1
    buffer_load_dwordx4 v[100:103], v6, s[8:11], s85 offen offset:512 sc1
    v_mfma_f32_32x32x16_bf16 v[80:95], a[188:191], a[236:239], v[80:95]
    v_mfma_f32_32x32x16_bf16 v[64:79], a[184:187], a[236:239], v[64:79]
    s_add_u32 s38, s35, 0x232a000
    v_mov_b32 v3, 1
    s_waitcnt vmcnt(10)
    s_mov_b64 exec, 1
    buffer_atomic_add v3, off, s[8:11], s38 sc1
    s_mov_b64 exec, -1
    v_mfma_f32_32x32x16_bf16 v[80:95], a[196:199], a[240:243], v[80:95]
    v_mfma_f32_32x32x16_bf16 v[64:79], a[192:195], a[240:243], v[64:79]
    buffer_load_dwordx4 v[196:199], v1, s[8:11], s41 offen offset:1024 sc1
    v_mfma_f32_32x32x16_bf16 v[80:95], a[204:207], a[244:247], v[80:95]
    v_mfma_f32_32x32x16_bf16 v[64:79], a[200:203], a[244:247], v[64:79]
    v_mfma_f32_32x32x16_bf16 v[80:95], a[212:215], a[248:251], v[80:95]
    buffer_load_dwordx4 v[200:203], v1, s[8:11], s41 offen offset:2048 sc1
    v_mfma_f32_32x32x16_bf16 v[64:79], a[208:211], a[248:251], v[64:79]
    v_mfma_f32_32x32x16_bf16 v[80:95], a[220:223], a[252:255], v[80:95]
    buffer_load_dwordx4 v[204:207], v1, s[8:11], s41 offen offset:3072 sc1
    v_mfma_f32_32x32x16_bf16 v[64:79], a[216:219], a[252:255], v[64:79]
    v_mfma_f32_32x32x16_bf16 v[48:63], a[164:167], v[128:131], 0
    v_mfma_f32_32x32x16_bf16 v[32:47], a[160:163], v[128:131], 0
    s_add_u32 s41, s40, 0x1000
    buffer_load_dwordx4 v[208:211], v1, s[8:11], s41 offen offset:0 sc1
    v_mfma_f32_32x32x16_bf16 v[48:63], a[172:175], v[132:135], v[48:63]
    v_mfma_f32_32x32x16_bf16 v[32:47], a[168:171], v[132:135], v[32:47]
    s_add_u32 s56, s36, 0x231a000
    s_waitcnt lgkmcnt(0)
    s_mov_b32 s57, 100000
    s_cmp_eq_u32 s94, 8
    s_cbranch_scc1 L_pc_ok9
L_pc9:
    s_load_dword s94, s[4:5], s56 glc
    s_sub_u32 s57, s57, 1
    s_cbranch_scc1 L_pc_ok9
    s_waitcnt lgkmcnt(0)
    s_cmp_lg_u32 s94, 8
    s_cbranch_scc1 L_pc9
L_pc_ok9:
    buffer_load_dwordx4 v[128:131], v1, s[8:11], s79 offen offset:3072 sc1
    v_mfma_f32_32x32x16_bf16 v[48:63], a[180:183], v[136:139], v[48:63]
    s_add_u32 s38, s35, 0x2332000
    v_mov_b32 v3, 1
    s_waitcnt vmcnt(10)
    s_mov_b64 exec, 1
    buffer_atomic_add v3, off, s[8:11], s38 sc1
    s_mov_b64 exec, -1
    v_mfma_f32_32x32x16_bf16 v[32:47], a[176:179], v[136:139], v[32:47]
    buffer_load_dwordx4 v[132:135], v15, s[8:11], s79 offen offset:3072 sc1
    v_mfma_f32_32x32x16_bf16 v[48:63], a[188:191], v[140:143], v[48:63]
    s_add_u32 s56, s36, 0x2322000
    s_load_dword s95, s[4:5], s56 glc
    v_mfma_f32_32x32x16_bf16 v[32:47], a[184:187], v[140:143], v[32:47]
    v_mfma_f32_32x32x16_bf16 v[48:63], a[196:199], v[144:147], v[48:63]
    buffer_load_dwordx4 v[136:139], v7, s[8:11], s79 offen offset:3072 sc1
    v_mfma_f32_32x32x16_bf16 v[32:47], a[192:195], v[144:147], v[32:47]
    v_mfma_f32_32x32x16_bf16 v[48:63], a[204:207], v[148:151], v[48:63]
    buffer_load_dwordx4 v[140:143], v10, s[8:11], s79 offen offset:3072 sc1
    v_mfma_f32_32x32x16_bf16 v[32:47], a[200:203], v[148:151], v[32:47]
    v_mfma_f32_32x32x16_bf16 v[48:63], a[212:215], v[152:155], v[48:63]
    v_mfma_f32_32x32x16_bf16 v[32:47], a[208:211], v[152:155], v[32:47]
    buffer_load_dwordx4 v[144:147], v1, s[8:11], s78 offen offset:3072 sc1
    v_mfma_f32_32x32x16_bf16 v[48:63], a[220:223], v[156:159], v[48:63]
    v_mfma_f32_32x32x16_bf16 v[32:47], a[216:219], v[156:159], v[32:47]
    buffer_load_dwordx4 v[148:151], v15, s[8:11], s78 offen offset:3072 sc1
    v_mfma_f32_32x32x16_bf16 v[80:95], a[4:7], v[160:163], v[80:95]
    v_mfma_f32_32x32x16_bf16 v[64:79], a[0:3], v[160:163], v[64:79]
    buffer_load_dwordx4 v[152:155], v7, s[8:11], s78 offen offset:3072 sc1
    v_mfma_f32_32x32x16_bf16 v[80:95], a[12:15], v[164:167], v[80:95]
    v_mfma_f32_32x32x16_bf16 v[64:79], a[8:11], v[164:167], v[64:79]
    v_mfma_f32_32x32x16_bf16 v[80:95], a[20:23], v[168:171], v[80:95]
    buffer_load_dwordx4 v[156:159], v10, s[8:11], s78 offen offset:3072 sc1
    v_mfma_f32_32x32x16_bf16 v[64:79], a[16:19], v[168:171], v[64:79]
    v_mfma_f32_32x32x16_bf16 v[80:95], a[28:31], v[172:175], v[80:95]
    s_add_u32 s56, s36, 0x2322000
    s_waitcnt lgkmcnt(0)
    s_mov_b32 s57, 100000
    s_cmp_eq_u32 s95, 8
    s_cbranch_scc1 L_pc_ok10
L_pc10:
    s_load_dword s95, s[4:5], s56 glc
    s_sub_u32 s57, s57, 1
    s_cbranch_scc1 L_pc_ok10
    s_waitcnt lgkmcnt(0)
    s_cmp_lg_u32 s95, 8
    s_cbranch_scc1 L_pc10
L_pc_ok10:
    buffer_load_dwordx4 v[160:163], v1, s[8:11], s81 offen offset:0 sc1
    v_mfma_f32_32x32x16_bf16 v[64:79], a[24:27], v[172:175], v[64:79]
    v_mfma_f32_32x32x16_bf16 v[48:63], a[4:7], v[176:179], v[48:63]
    v_mfma_f32_32x32x16_bf16 v[32:47], a[0:3], v[176:179], v[32:47]
    buffer_load_dwordx4 v[164:167], v15, s[8:11], s81 offen offset:0 sc1
    s_add_u32 s56, s36, 0x232a000
    s_load_dword s96, s[4:5], s56 glc
    v_mfma_f32_32x32x16_bf16 v[48:63], a[12:15], v[180:183], v[48:63]
    v_mfma_f32_32x32x16_bf16 v[32:47], a[8:11], v[180:183], v[32:47]
    buffer_load_dwordx4 v[168:171], v7, s[8:11], s81 offen offset:0 sc1
    v_mfma_f32_32x32x16_bf16 v[48:63], a[20:23], v[184:187], v[48:63]
    v_mfma_f32_32x32x16_bf16 v[32:47], a[16:19], v[184:187], v[32:47]
    buffer_load_dwordx4 v[172:175], v10, s[8:11], s81 offen offset:0 sc1
    s_waitcnt vmcnt(21)
    v_mfma_f32_32x32x16_bf16 v[48:63], a[28:31], v[188:191], v[48:63]
    v_mfma_f32_32x32x16_bf16 v[32:47], a[24:27], v[188:191], v[32:47]
    s_waitcnt vmcnt(12)
    v_mfma_f32_32x32x16_bf16 v[80:95], a[36:39], v[128:131], v[80:95]
    buffer_load_dwordx4 v[176:179], v1, s[8:11], s80 offen offset:0 sc1
    v_mfma_f32_32x32x16_bf16 v[64:79], a[32:35], v[128:131], v[64:79]
    s_waitcnt vmcnt(11)
    v_mfma_f32_32x32x16_bf16 v[80:95], a[44:47], v[132:135], v[80:95]
    buffer_load_dwordx4 v[180:183], v15, s[8:11], s80 offen offset:0 sc1
    v_mfma_f32_32x32x16_bf16 v[64:79], a[40:43], v[132:135], v[64:79]
    s_waitcnt vmcnt(11)
    v_mfma_f32_32x32x16_bf16 v[80:95], a[52:55], v[136:139], v[80:95]
    v_mfma_f32_32x32x16_bf16 v[64:79], a[48:51], v[136:139], v[64:79]
    buffer_load_dwordx4 v[184:187], v7, s[8:11], s80 offen offset:0 sc1
    s_waitcnt vmcnt(11)
    v_mfma_f32_32x32x16_bf16 v[80:95], a[60:63], v[140:143], v[80:95]
    v_mfma_f32_32x32x16_bf16 v[64:79], a[56:59], v[140:143], v[64:79]
    buffer_load_dwordx4 v[188:191], v10, s[8:11], s80 offen offset:0 sc1
    s_waitcnt vmcnt(11)
    v_mfma_f32_32x32x16_bf16 v[48:63], a[36:39], v[144:147], v[48:63]
    v_mfma_f32_32x32x16_bf16 v[32:47], a[32:35], v[144:147], v[32:47]
    s_add_u32 s56, s36, 0x232a000
    s_waitcnt lgkmcnt(0)
    s_mov_b32 s57, 100000
    s_cmp_eq_u32 s96, 8
    s_cbranch_scc1 L_pc_ok11
L_pc11:
    s_load_dword s96, s[4:5], s56 glc
    s_sub_u32 s57, s57, 1
    s_cbranch_scc1 L_pc_ok11
    s_waitcnt lgkmcnt(0)
    s_cmp_lg_u32 s96, 8
    s_cbranch_scc1 L_pc11
L_pc_ok11:
    buffer_load_dwordx4 v[128:131], v1, s[8:11], s81 offen offset:1024 sc1
    s_waitcnt vmcnt(11)
    v_mfma_f32_32x32x16_bf16 v[48:63], a[44:47], v[148:151], v[48:63]
    v_mfma_f32_32x32x16_bf16 v[32:47], a[40:43], v[148:151], v[32:47]
    s_waitcnt vmcnt(10)
    v_mfma_f32_32x32x16_bf16 v[48:63], a[52:55], v[152:155], v[48:63]
    buffer_load_dwordx4 v[132:135], v15, s[8:11], s81 offen offset:1024 sc1
    v_mfma_f32_32x32x16_bf16 v[32:47], a[48:51], v[152:155], v[32:47]
    s_add_u32 s56, s36, 0x2332000
    s_load_dword s97, s[4:5], s56 glc
    s_waitcnt vmcnt(10)
    v_mfma_f32_32x32x16_bf16 v[48:63], a[60:63], v[156:159], v[48:63]
    buffer_load_dwordx4 v[136:139], v7, s[8:11], s81 offen offset:1024 sc1
    v_mfma_f32_32x32x16_bf16 v[32:47], a[56:59], v[156:159], v[32:47]
    s_waitcnt vmcnt(10)
    v_mfma_f32_32x32x16_bf16 v[80:95], a[68:71], v[160:163], v[80:95]
    v_lshlrev_b32 v112, 16, v96
    s_nop 8
    v_add_f32 v32, v32, v112
    v_and_b32 v112, 0xffff0000, v96
    v_add_f32 v33, v33, v112
    v_mfma_f32_32x32x16_bf16 v[64:79], a[64:67], v[160:163], v[64:79]
    buffer_load_dwordx4 v[140:143], v10, s[8:11], s81 offen offset:1024 sc1
    v_lshlrev_b32 v113, 16, v97
    v_add_f32 v34, v34, v113
    v_and_b32 v113, 0xffff0000, v97
    v_add_f32 v35, v35, v113
    v_lshlrev_b32 v112, 16, v98
    s_waitcnt vmcnt(10)
    v_mfma_f32_32x32x16_bf16 v[80:95], a[76:79], v[164:167], v[80:95]
    v_add_f32 v36, v36, v112
    v_and_b32 v112, 0xffff0000, v98
    v_add_f32 v37, v37, v112
    v_lshlrev_b32 v113, 16, v99
    v_mfma_f32_32x32x16_bf16 v[64:79], a[72:75], v[164:167], v[64:79]
    buffer_load_dwordx4 v[144:147], v1, s[8:11], s80 offen offset:1024 sc1
    v_add_f32 v38, v38, v113
    v_and_b32 v113, 0xffff0000, v99
    v_add_f32 v39, v39, v113
    v_lshlrev_b32 v112, 16, v100
    v_add_f32 v40, v40, v112
    s_waitcnt vmcnt(10)
    v_mfma_f32_32x32x16_bf16 v[80:95], a[84:87], v[168:171], v[80:95]
    v_and_b32 v112, 0xffff0000, v100
    v_add_f32 v41, v41, v112
    v_lshlrev_b32 v113, 16, v101
    v_add_f32 v42, v42, v113
    v_mfma_f32_32x32x16_bf16 v[64:79], a[80:83], v[168:171], v[64:79]
    buffer_load_dwordx4 v[148:151], v15, s[8:11], s80 offen offset:1024 sc1
    v_and_b32 v113, 0xffff0000, v101
    v_add_f32 v43, v43, v113
    v_lshlrev_b32 v112, 16, v102
    v_add_f32 v44, v44, v112
    v_and_b32 v112, 0xffff0000, v102
    s_waitcnt vmcnt(10)
    v_mfma_f32_32x32x16_bf16 v[80:95], a[92:95], v[172:175], v[80:95]
    v_add_f32 v45, v45, v112
    v_lshlrev_b32 v113, 16, v103
    v_add_f32 v46, v46, v113
    v_and_b32 v113, 0xffff0000, v103
    v_add_f32 v47, v47, v113
    v_mfma_f32_32x32x16_bf16 v[64:79], a[88:91], v[172:175], v[64:79]
    s_waitcnt vmcnt(9)
    v_mfma_f32_32x32x16_bf16 v[48:63], a[68:71], v[176:179], v[48:63]
    buffer_load_dwordx4 v[152:155], v7, s[8:11], s80 offen offset:1024 sc1
    v_mfma_f32_32x32x16_bf16 v[32:47], a[64:67], v[176:179], v[32:47]
    s_waitcnt vmcnt(9)
    v_mfma_f32_32x32x16_bf16 v[48:63], a[76:79], v[180:183], v[48:63]
    buffer_load_dwordx4 v[156:159], v10, s[8:11], s80 offen offset:1024 sc1
    v_mfma_f32_32x32x16_bf16 v[32:47], a[72:75], v[180:183], v[32:47]
    s_waitcnt vmcnt(9)
    v_mfma_f32_32x32x16_bf16 v[48:63], a[84:87], v[184:187], v[48:63]
    v_mfma_f32_32x32x16_bf16 v[32:47], a[80:83], v[184:187], v[32:47]
    s_add_u32 s56, s36, 0x2332000
    s_waitcnt lgkmcnt(0)
    s_mov_b32 s57, 100000
    s_cmp_eq_u32 s97, 8
    s_cbranch_scc1 L_pc_ok12
L_pc12:
    s_load_dword s97, s[4:5], s56 glc
    s_sub_u32 s57, s57, 1
    s_cbranch_scc1 L_pc_ok12
    s_waitcnt lgkmcnt(0)
    s_cmp_lg_u32 s97, 8
    s_cbranch_scc1 L_pc12
L_pc_ok12:
    buffer_load_dwordx4 v[160:163], v1, s[8:11], s81 offen offset:2048 sc1
    s_waitcnt vmcnt(9)
    v_mfma_f32_32x32x16_bf16 v[48:63], a[92:95], v[188:191], v[48:63]
    v_mfma_f32_32x32x16_bf16 v[32:47], a[88:91], v[188:191], v[32:47]
    buffer_load_dwordx4 v[164:167], v15, s[8:11], s81 offen offset:2048 sc1
    s_waitcnt vmcnt(9)
    v_mfma_f32_32x32x16_bf16 v[80:95], a[100:103], v[128:131], v[80:95]
    v_mfma_f32_32x32x16_bf16 v[64:79], a[96:99], v[128:131], v[64:79]
    buffer_load_dwordx4 v[168:171], v7, s[8:11], s81 offen offset:2048 sc1
    s_waitcnt vmcnt(9)
    v_mfma_f32_32x32x16_bf16 v[80:95], a[108:111], v[132:135], v[80:95]
    v_mfma_f32_32x32x16_bf16 v[64:79], a[104:107], v[132:135], v[64:79]
    s_waitcnt vmcnt(8)
    v_mfma_f32_32x32x16_bf16 v[80:95], a[116:119], v[136:139], v[80:95]
    buffer_load_dwordx4 v[172:175], v10, s[8:11], s81 offen offset:2048 sc1
    v_mfma_f32_32x32x16_bf16 v[64:79], a[112:115], v[136:139], v[64:79]
    s_waitcnt vmcnt(8)
    v_mfma_f32_32x32x16_bf16 v[80:95], a[124:127], v[140:143], v[80:95]
    buffer_load_dwordx4 v[176:179], v1, s[8:11], s80 offen offset:2048 sc1
    v_mfma_f32_32x32x16_bf16 v[64:79], a[120:123], v[140:143], v[64:79]
    s_waitcnt vmcnt(8)
    v_mfma_f32_32x32x16_bf16 v[48:63], a[100:103], v[144:147], v[48:63]
    v_mfma_f32_32x32x16_bf16 v[32:47], a[96:99], v[144:147], v[32:47]
    buffer_load_dwordx4 v[180:183], v15, s[8:11], s80 offen offset:2048 sc1
    s_waitcnt vmcnt(8)
    v_mfma_f32_32x32x16_bf16 v[48:63], a[108:111], v[148:151], v[48:63]
    v_mfma_f32_32x32x16_bf16 v[32:47], a[104:107], v[148:151], v[32:47]
    buffer_load_dwordx4 v[184:187], v7, s[8:11], s80 offen offset:2048 sc1
    s_waitcnt vmcnt(8)
    v_mfma_f32_32x32x16_bf16 v[48:63], a[116:119], v[152:155], v[48:63]
    v_mfma_f32_32x32x16_bf16 v[32:47], a[112:115], v[152:155], v[32:47]
    buffer_load_dwordx4 v[188:191], v10, s[8:11], s80 offen offset:2048 sc1
    s_waitcnt vmcnt(8)
    v_mfma_f32_32x32x16_bf16 v[48:63], a[124:127], v[156:159], v[48:63]
    v_mfma_f32_32x32x16_bf16 v[32:47], a[120:123], v[156:159], v[32:47]
    s_waitcnt vmcnt(7)
    v_mfma_f32_32x32x16_bf16 v[80:95], a[132:135], v[160:163], v[80:95]
    buffer_load_dwordx4 v[212:215], v1, s[8:11], s41 offen offset:1024 sc1
    v_mfma_f32_32x32x16_bf16 v[64:79], a[128:131], v[160:163], v[64:79]
    s_waitcnt vmcnt(7)
    v_mfma_f32_32x32x16_bf16 v[80:95], a[140:143], v[164:167], v[80:95]
    buffer_load_dwordx4 v[216:219], v1, s[8:11], s41 offen offset:2048 sc1
    v_mfma_f32_32x32x16_bf16 v[64:79], a[136:139], v[164:167], v[64:79]
    s_waitcnt vmcnt(7)
    v_mfma_f32_32x32x16_bf16 v[80:95], a[148:151], v[168:171], v[80:95]
    v_mfma_f32_32x32x16_bf16 v[64:79], a[144:147], v[168:171], v[64:79]
    buffer_load_dwordx4 v[220:223], v1, s[8:11], s41 offen offset:3072 sc1
    s_waitcnt vmcnt(7)
    v_mfma_f32_32x32x16_bf16 v[80:95], a[156:159], v[172:175], v[80:95]
    v_mfma_f32_32x32x16_bf16 v[64:79], a[152:155], v[172:175], v[64:79]
    s_add_u32 s41, s40, 0x2000
    buffer_load_dwordx4 v[224:227], v1, s[8:11], s41 offen offset:0 sc1
    s_waitcnt vmcnt(7)
    v_mfma_f32_32x32x16_bf16 v[48:63], a[132:135], v[176:179], v[48:63]
    s_nop 6
    ds_write_b128 v9, v[80:83] offset:0
    s_waitcnt vmcnt(6)
    v_mfma_f32_32x32x16_bf16 v[48:63], a[140:143], v[180:183], v[48:63]
    buffer_load_dwordx4 v[228:231], v1, s[8:11], s41 offen offset:1024 sc1
    ds_write_b128 v9, v[84:87] offset:1024
    s_waitcnt vmcnt(6)
    v_mfma_f32_32x32x16_bf16 v[48:63], a[148:151], v[184:187], v[48:63]
    ds_write_b128 v9, v[88:91] offset:2048
    s_waitcnt vmcnt(5)
    v_mfma_f32_32x32x16_bf16 v[48:63], a[156:159], v[188:191], v[48:63]
    ds_write_b128 v9, v[92:95] offset:3072
    v_mfma_f32_32x32x16_bf16 v[32:47], a[128:131], v[176:179], v[32:47]
    buffer_load_dwordx4 v[232:235], v1, s[8:11], s41 offen offset:2048 sc1
    ds_write_b128 v8, v[64:67] offset:0
    v_mfma_f32_32x32x16_bf16 v[32:47], a[136:139], v[180:183], v[32:47]
    ds_write_b128 v8, v[68:71] offset:1024
    v_mfma_f32_32x32x16_bf16 v[32:47], a[144:147], v[184:187], v[32:47]
    ds_write_b128 v8, v[72:75] offset:2048
    v_mfma_f32_32x32x16_bf16 v[32:47], a[152:155], v[188:191], v[32:47]
    ds_write_b128 v8, v[76:79] offset:3072
    s_nop 1
    ds_write_b128 v114, v[48:51] offset:0
    ds_write_b128 v114, v[52:55] offset:1024
    ds_write_b128 v114, v[56:59] offset:2048
    ds_write_b128 v114, v[60:63] offset:3072
    s_waitcnt lgkmcnt(0)
    s_barrier
    ds_read_b128 v[128:131], v115 offset:0
    ds_read_b128 v[132:135], v115 offset:1024
    ds_read_b128 v[136:139], v115 offset:2048
    ds_read_b128 v[140:143], v115 offset:3072
    ds_read_b128 v[144:147], v115 offset:4096
    ds_read_b128 v[148:151], v115 offset:5120
    ds_read_b128 v[152:155], v115 offset:6144
    ds_read_b128 v[156:159], v115 offset:7168
    ds_read_b128 v[160:163], v115 offset:8192
    ds_read_b128 v[164:167], v115 offset:9216
    ds_read_b128 v[168:171], v115 offset:10240
    ds_read_b128 v[172:175], v115 offset:11264
    s_waitcnt lgkmcnt(11)
    v_pk_add_f32 v[32:33], v[32:33], v[128:129]
    v_pk_add_f32 v[34:35], v[34:35], v[130:131]
    s_waitcnt lgkmcnt(10)
    v_pk_add_f32 v[36:37], v[36:37], v[132:133]
    v_pk_add_f32 v[38:39], v[38:39], v[134:135]
    s_waitcnt lgkmcnt(9)
    v_pk_add_f32 v[40:41], v[40:41], v[136:137]
    v_pk_add_f32 v[42:43], v[42:43], v[138:139]
    s_waitcnt lgkmcnt(8)
    v_pk_add_f32 v[44:45], v[44:45], v[140:141]
    v_pk_add_f32 v[46:47], v[46:47], v[142:143]
    s_waitcnt lgkmcnt(7)
    v_pk_add_f32 v[32:33], v[32:33], v[144:145]
    v_pk_add_f32 v[34:35], v[34:35], v[146:147]
    s_waitcnt lgkmcnt(6)
    v_pk_add_f32 v[36:37], v[36:37], v[148:149]
    v_pk_add_f32 v[38:39], v[38:39], v[150:151]
    s_waitcnt lgkmcnt(5)
    v_pk_add_f32 v[40:41], v[40:41], v[152:153]
    v_pk_add_f32 v[42:43], v[42:43], v[154:155]
    s_waitcnt lgkmcnt(4)
    v_pk_add_f32 v[44:45], v[44:45], v[156:157]
    v_pk_add_f32 v[46:47], v[46:47], v[158:159]
    s_waitcnt lgkmcnt(3)
    v_pk_add_f32 v[32:33], v[32:33], v[160:161]
    v_pk_add_f32 v[34:35], v[34:35], v[162:163]
    s_waitcnt lgkmcnt(2)
    v_pk_add_f32 v[36:37], v[36:37], v[164:165]
    v_pk_add_f32 v[38:39], v[38:39], v[166:167]
    s_waitcnt lgkmcnt(1)
    v_pk_add_f32 v[40:41], v[40:41], v[168:169]
    v_pk_add_f32 v[42:43], v[42:43], v[170:171]
    s_waitcnt lgkmcnt(0)
    v_pk_add_f32 v[44:45], v[44:45], v[172:173]
    v_pk_add_f32 v[46:47], v[46:47], v[174:175]
    v_cvt_pk_bf16_f32 v104, v32, v33
    v_cvt_pk_bf16_f32 v105, v34, v35
    v_cvt_pk_bf16_f32 v106, v36, v37
    v_cvt_pk_bf16_f32 v107, v38, v39
    v_cvt_pk_bf16_f32 v108, v40, v41
    v_cvt_pk_bf16_f32 v109, v42, v43
    v_cvt_pk_bf16_f32 v110, v44, v45
    v_cvt_pk_bf16_f32 v111, v46, v47
    s_add_u32 s32, s84, 0xe00000
    buffer_store_dwordx4 v[104:107], v6, s[8:11], s32 offen sc1
    buffer_store_dwordx4 v[108:111], v6, s[8:11], s32 offen offset:512 sc1
    v_mov_b32 v112, 0
    v_mov_b32 v113, 0
    v_dot2_f32_bf16 v112, v104, s25, v112
    v_dot2_f32_bf16 v113, v104, v104, v113
    v_dot2_f32_bf16 v112, v105, s25, v112
    v_dot2_f32_bf16 v113, v105, v105, v113
    v_dot2_f32_bf16 v112, v106, s25, v112
    v_dot2_f32_bf16 v113, v106, v106, v113
    v_dot2_f32_bf16 v112, v107, s25, v112
    v_dot2_f32_bf16 v113, v107, v107, v113
    v_dot2_f32_bf16 v112, v108, s25, v112
    v_dot2_f32_bf16 v113, v108, v108, v113
    v_dot2_f32_bf16 v112, v109, s25, v112
    v_dot2_f32_bf16 v113, v109, v109, v113
    v_dot2_f32_bf16 v112, v110, s25, v112
    v_dot2_f32_bf16 v113, v110, v110, v113
    v_dot2_f32_bf16 v112, v111, s25, v112
    v_dot2_f32_bf16 v113, v111, v111, v113
    v_lshlrev_b32 v7, 2, v5
    v_lshl_add_u32 v7, v4, 3, v7
    s_lshl_b32 s32, s82, 12
    s_lshl_b32 s33, s83, 8
    s_add_u32 s32, s32, s33
    s_add_u32 s32, s32, 0x2240000
    v_permlane32_swap_b32 v112, v113
    v_add_f32 v112, v112, v113
    s_lshl_b32 s30, s22, 8
    s_add_u32 s30, s30, 0x2308000
    v_mov_b32 v3, 1
    buffer_store_dword v112, v7, s[8:11], s32 offen sc1
    s_mul_i32 s40, s17, 49152
    s_add_u32 s41, s40, 0x2000
    buffer_load_dwordx4 v[236:239], v1, s[8:11], s41 offen offset:3072 sc1
    s_add_u32 s41, s40, 0x3000
    buffer_load_dwordx4 v[240:243], v1, s[8:11], s41 offen offset:0 sc1
    buffer_load_dwordx4 v[244:247], v1, s[8:11], s41 offen offset:1024 sc1
    buffer_load_dwordx4 v[248:251], v1, s[8:11], s41 offen offset:2048 sc1
    buffer_load_dwordx4 v[252:255], v1, s[8:11], s41 offen offset:3072 sc1
    s_add_u32 s41, s40, 0x4000
    buffer_load_dwordx4 a[224:227], v1, s[8:11], s41 offen offset:0 sc1
    buffer_load_dwordx4 a[228:231], v1, s[8:11], s41 offen offset:1024 sc1
    buffer_load_dwordx4 a[232:235], v1, s[8:11], s41 offen offset:2048 sc1
    s_waitcnt vmcnt(8)
    s_barrier
    s_cmp_lg_u32 s3, 0
    s_cbranch_scc1 L_sg19
    s_mov_b64 exec, 1
    buffer_atomic_add v3, off, s[8:11], s30 sc1
    s_mov_b64 exec, -1
L_sg19:
    s_sub_u32 s36, s16, 1
    s_max_i32 s36, s36, 0
    s_lshl_b32 s36, s36, 8
    s_add_u32 s36, s36, 0x2308000
    s_cmp_eq_u32 s16, 0
    s_cselect_b32 s37, 0, 256
    buffer_load_dwordx4 a[236:239], v1, s[8:11], s41 offen offset:3072 sc1
    v_and_b32 v3, 15, v0
    v_lshrrev_b32 v4, 4, v0
    s_add_u32 s41, s40, 0x5000
    v_lshlrev_b32 v7, 9, v4
    v_lshl_add_u32 v7, v3, 4, v7
    buffer_load_dwordx4 a[240:243], v1, s[8:11], s41 offen offset:0 sc1
    v_add_u32 v6, 65536, v1
    buffer_load_dwordx4 a[244:247], v1, s[8:11], s41 offen offset:1024 sc1
    v_lshlrev_b32 v8, 3, v3
    v_add_u32 v8, 81920, v8
    buffer_load_dwordx4 a[248:251], v1, s[8:11], s41 offen offset:2048 sc1
    v_lshlrev_b32 v9, 5, v4
    v_add_u32 v9, 81920, v9
    buffer_load_dwordx4 a[252:255], v1, s[8:11], s41 offen offset:3072 sc1
    s_lshl_b32 s30, s17, 6
    s_add_u32 s41, s40, 0x6000
    s_add_u32 s30, s30, 0x740000
    v_lshlrev_b32 v132, 4, v4
    buffer_load_dwordx4 a[164:167], v1, s[8:11], s41 offen offset:1024 sc1
    v_lshlrev_b32 v133, 2, v3
    buffer_load_dwordx4 v[18:21], v132, s[8:11], s30 offen sc1
    buffer_load_dwordx4 a[168:171], v1, s[8:11], s41 offen offset:2048 sc1
    buffer_load_dwordx4 v[22:25], v132, s[8:11], s30 offen offset:2048 sc1
    s_add_u32 s41, s40, 0x7000
    s_add_u32 s30, s30, 4096
    buffer_load_dword v26, v133, s[8:11], s30 offen sc1
    buffer_load_dwordx4 a[176:179], v1, s[8:11], s41 offen offset:0 sc1
    v_and_b32 v134, 1, v3
    v_lshl_add_u32 v135, v4, 2, v134
    buffer_load_dwordx4 a[180:183], v1, s[8:11], s41 offen offset:1024 sc1
    v_add_u32 v136, 2, v135
    buffer_load_dwordx4 a[188:191], v1, s[8:11], s41 offen offset:3072 sc1
    v_add_u32 v137, 2, v3
    v_mov_b32 v138, 0xf149f2ca
    s_add_u32 s41, s40, 0x8000
    v_mov_b32 v139, 0
    v_cmp_ge_u32 vcc, v135, v137
    buffer_load_dwordx4 a[192:195], v1, s[8:11], s41 offen offset:0 sc1
    s_nop 0
    v_cndmask_b32 v10, v138, v139, vcc
    buffer_load_dwordx4 a[200:203], v1, s[8:11], s41 offen offset:2048 sc1
    s_cmp_lg_u32 s3, 0
    s_cbranch_scc1 L_ap20
    s_add_u32 s66, s36, s37
    s_load_dword s64, s[4:5], s36 glc
    s_load_dword s65, s[4:5], s66 glc
L_ap20:
    v_cmp_ge_u32 vcc, v136, v137
    s_nop 1
    v_cndmask_b32 v11, v138, v139, vcc
    buffer_load_dwordx4 a[204:207], v1, s[8:11], s41 offen offset:3072 sc1
    v_cmp_le_u32 vcc, v135, v3
    s_nop 1
    v_cndmask_b32 v12, v138, v139, vcc
    s_add_u32 s41, s40, 0x9000
    v_cmp_le_u32 vcc, v136, v3
    buffer_load_dwordx4 a[212:215], v1, s[8:11], s41 offen offset:1024 sc1
    s_nop 0
    v_cndmask_b32 v13, v138, v139, vcc
    s_cmp_eq_u32 s16, 0
    s_cselect_b64 s[58:59], -1, 0
    buffer_load_dwordx4 a[216:219], v1, s[8:11], s41 offen offset:2048 sc1
    v_cndmask_b32 v14, v10, v138, s[58:59]
    v_cndmask_b32 v15, v11, v138, s[58:59]
    s_add_u32 s41, s40, 0xa000
    v_mov_b32 v135, 0x0c0c0100
    buffer_load_dwordx4 v[160:163], v1, s[8:11], s41 offen offset:0 sc1
    v_mov_b32 v136, 0x01000c0c
    v_cndmask_b32 v16, v135, v136, s[28:29]
    buffer_load_dwordx4 v[164:167], v1, s[8:11], s41 offen offset:1024 sc1
    v_mov_b32 v135, 0x0c0c0302
    v_mov_b32 v136, 0x03020c0c
    buffer_load_dwordx4 v[172:175], v1, s[8:11], s41 offen offset:3072 sc1
    v_cndmask_b32 v17, v135, v136, s[28:29]
    v_lshlrev_b32 v140, 10, v4
    v_lshl_add_u32 v140, v3, 3, v140
    s_lshl_b32 s30, s16, 16
    s_sub_u32 s31, s30, 32512
    s_cmp_eq_u32 s16, 0
    s_cselect_b32 s31, 0, s31
    s_lshl_b32 s32, s3, 12
    s_add_u32 s31, s31, s32
    s_add_u32 s31, s31, 0xe00000
    s_add_u32 s30, s30, s32
    s_add_u32 s30, s30, 0xe00000
    s_lshl_b32 s33, s16, 13
    s_sub_u32 s34, s33, 3968
    s_cmp_eq_u32 s16, 0
    s_cselect_b32 s34, 0, s34
    s_add_u32 s34, s34, 0x2240000
    s_lshr_b32 s35, s3, 1
    s_lshl_b32 s35, s35, 12
    s_and_b32 s38, s3, 1
    s_lshl_b32 s38, s38, 7
    s_add_u32 s33, s33, s35
    s_add_u32 s33, s33, s38
    s_add_u32 s33, s33, 0x2240000
    s_lshl_b32 s35, s3, 11
    s_cmp_lg_u32 s3, 0
    s_cbranch_scc1 L_pw_done21
    s_mov_b32 s57, 100000
    s_add_u32 s66, s36, s37
    s_waitcnt lgkmcnt(0)
    s_min_u32 s64, s64, s65
    s_cmp_eq_u32 s64, 8
    s_cbranch_scc1 L_pw_done21
L_pw21:
    s_load_dword s64, s[4:5], s36 glc
    s_load_dword s65, s[4:5], s66 glc
    s_sub_u32 s57, s57, 1
    s_cbranch_scc1 L_pw_done21
    s_waitcnt lgkmcnt(0)
    s_min_u32 s64, s64, s65
    s_cmp_lg_u32 s64, 8
    s_cbranch_scc1 L_pw21
L_pw_done21:
    s_barrier
    s_add_u32 m0, s35, 0
    s_add_u32 s56, s31, 0
    buffer_load_dwordx4 v7, s[8:11], s56 offen offset:0 sc1 lds
    s_add_u32 s56, s31, 1024
    buffer_load_dwordx4 v7, s[8:11], s56 offen offset:1024 sc1 lds
    s_add_u32 m0, s35, 16384
    s_add_u32 s56, s30, 0
    buffer_load_dwordx4 v7, s[8:11], s56 offen offset:0 sc1 lds
    s_add_u32 s56, s30, 1024
    buffer_load_dwordx4 v7, s[8:11], s56 offen offset:1024 sc1 lds
    s_add_u32 m0, s35, 32768
    s_add_u32 s56, s30, 256
    buffer_load_dwordx4 v7, s[8:11], s56 offen offset:0 sc1 lds
    s_add_u32 s56, s30, 1280
    buffer_load_dwordx4 v7, s[8:11], s56 offen offset:1024 sc1 lds
    buffer_load_dwordx2 v[142:143], v140, s[8:11], s33 offen offset:0 sc1
    buffer_load_dwordx2 v[144:145], v140, s[8:11], s33 offen offset:256 sc1
    buffer_load_dwordx2 v[146:147], v140, s[8:11], s33 offen offset:512 sc1
    buffer_load_dwordx2 v[148:149], v140, s[8:11], s33 offen offset:768 sc1
    s_waitcnt vmcnt(8)
    s_barrier
    ds_read_b128 v[84:87], v1 offset:0
    ds_read_b128 v[88:91], v1 offset:1024
    ds_read_b128 v[92:95], v1 offset:2048
    s_waitcnt lgkmcnt(2)
    v_mfma_f32_16x16x32_bf16 v[28:31], v[196:199], v[84:87], 0
    buffer_load_dwordx2 v[150:151], v140, s[8:11], s34 offen offset:0 sc1
    buffer_load_dwordx2 v[152:153], v140, s[8:11], s34 offen offset:256 sc1
    buffer_load_dwordx2 v[154:155], v140, s[8:11], s34 offen offset:512 sc1
    buffer_load_dwordx2 v[156:157], v140, s[8:11], s34 offen offset:768 sc1
    s_add_u32 m0, s35, 8192
    s_add_u32 s56, s31, 16384
    buffer_load_dwordx4 v7, s[8:11], s56 offen offset:0 sc1 lds
    v_mfma_f32_16x16x32_bf16 v[32:35], v[84:87], v[200:203], 0
    ds_read_b128 v[96:99], v1 offset:3072
    s_add_u32 s56, s31, 17408
    buffer_load_dwordx4 v7, s[8:11], s56 offen offset:1024 sc1 lds
    s_waitcnt lgkmcnt(2)
    v_mfma_f32_16x16x32_bf16 v[28:31], v[208:211], v[88:91], v[28:31]
    v_mfma_f32_16x16x32_bf16 v[32:35], v[88:91], v[212:215], v[32:35]
    ds_read_b128 v[84:87], v1 offset:4096
    s_waitcnt lgkmcnt(2)
    v_mfma_f32_16x16x32_bf16 v[28:31], v[220:223], v[92:95], v[28:31]
    s_mul_i32 s40, s17, 49152
    s_add_u32 s41, s40, 0xb000
    buffer_load_dwordx4 v[176:179], v1, s[8:11], s41 offen offset:0 sc1
    v_mfma_f32_16x16x32_bf16 v[32:35], v[92:95], v[224:227], v[32:35]
    ds_read_b128 v[88:91], v1 offset:5120
    s_waitcnt lgkmcnt(2)
    v_mfma_f32_16x16x32_bf16 v[28:31], v[232:235], v[96:99], v[28:31]
    v_mfma_f32_16x16x32_bf16 v[32:35], v[96:99], v[236:239], v[32:35]
    ds_read_b128 v[92:95], v1 offset:6144
    buffer_load_dwordx4 v[184:187], v1, s[8:11], s41 offen offset:2048 sc1
    s_waitcnt lgkmcnt(2)
    v_mfma_f32_16x16x32_bf16 v[28:31], v[244:247], v[84:87], v[28:31]
    v_mfma_f32_16x16x32_bf16 v[32:35], v[84:87], v[248:251], v[32:35]
    ds_read_b128 v[96:99], v1 offset:7168
    s_waitcnt lgkmcnt(2)
    v_mfma_f32_16x16x32_bf16 v[28:31], a[224:227], v[88:91], v[28:31]
    buffer_load_dwordx4 v[188:191], v1, s[8:11], s41 offen offset:3072 sc1
    v_mfma_f32_16x16x32_bf16 v[32:35], v[88:91], a[228:231], v[32:35]
    s_waitcnt vmcnt(15)
    s_barrier
    ds_read_b128 v[84:87], v1 offset:16384
    s_waitcnt lgkmcnt(2)
    v_mfma_f32_16x16x32_bf16 v[28:31], a[236:239], v[92:95], v[28:31]
    v_mfma_f32_16x16x32_bf16 v[32:35], v[92:95], a[240:243], v[32:35]
    ds_read_b128 v[88:91], v1 offset:17408
    s_add_u32 s41, s40, 0x6000
L_pad27904:
    s_cbranch_execz L_ret_p2s0
    buffer_load_dwordx4 a[160:163], v1, s[8:11], s41 offen offset:0 sc1
    s_waitcnt lgkmcnt(2)
    v_mfma_f32_16x16x32_bf16 v[28:31], a[248:251], v[96:99], v[28:31]
    v_mfma_f32_16x16x32_bf16 v[32:35], v[96:99], a[252:255], v[32:35]
    ds_read_b128 v[92:95], v1 offset:18432
    s_waitcnt lgkmcnt(2)
    v_mfma_f32_16x16x32_bf16 v[36:39], v[196:199], v[84:87], 0
    buffer_load_dwordx4 a[172:175], v1, s[8:11], s41 offen offset:3072 sc1
    v_mfma_f32_16x16x32_bf16 v[40:43], v[84:87], v[200:203], 0
    ds_read_b128 v[96:99], v1 offset:19456
    v_mfma_f32_16x16x32_bf16 v[44:47], v[192:195], v[84:87], 0
    s_waitcnt lgkmcnt(2)
    v_mfma_f32_16x16x32_bf16 v[36:39], v[208:211], v[88:91], v[36:39]
    s_add_u32 s41, s40, 0x7000
    buffer_load_dwordx4 a[184:187], v1, s[8:11], s41 offen offset:2048 sc1
    v_mfma_f32_16x16x32_bf16 v[40:43], v[88:91], v[212:215], v[40:43]
    ds_read_b128 v[84:87], v1 offset:20480
    v_mfma_f32_16x16x32_bf16 v[44:47], v[204:207], v[88:91], v[44:47]
    s_waitcnt lgkmcnt(2)
    v_mfma_f32_16x16x32_bf16 v[36:39], v[220:223], v[92:95], v[36:39]
    s_add_u32 s41, s40, 0x8000
    buffer_load_dwordx4 a[196:199], v1, s[8:11], s41 offen offset:1024 sc1
    v_mfma_f32_16x16x32_bf16 v[40:43], v[92:95], v[224:227], v[40:43]
    ds_read_b128 v[88:91], v1 offset:21504
    v_mfma_f32_16x16x32_bf16 v[44:47], v[216:219], v[92:95], v[44:47]
    s_waitcnt lgkmcnt(2)
    v_mfma_f32_16x16x32_bf16 v[36:39], v[232:235], v[96:99], v[36:39]
    s_add_u32 s41, s40, 0x9000
    buffer_load_dwordx4 a[208:211], v1, s[8:11], s41 offen offset:0 sc1
    v_mfma_f32_16x16x32_bf16 v[40:43], v[96:99], v[236:239], v[40:43]
    ds_read_b128 v[92:95], v1 offset:22528
    v_mfma_f32_16x16x32_bf16 v[44:47], v[228:231], v[96:99], v[44:47]
    s_waitcnt lgkmcnt(2)
    v_mfma_f32_16x16x32_bf16 v[36:39], v[244:247], v[84:87], v[36:39]
    buffer_load_dwordx4 a[220:223], v1, s[8:11], s41 offen offset:3072 sc1
    v_mfma_f32_16x16x32_bf16 v[40:43], v[84:87], v[248:251], v[40:43]
    ds_read_b128 v[96:99], v1 offset:23552
    v_mfma_f32_16x16x32_bf16 v[44:47], v[240:243], v[84:87], v[44:47]
    s_waitcnt lgkmcnt(2)
    v_mfma_f32_16x16x32_bf16 v[36:39], a[224:227], v[88:91], v[36:39]
    s_add_u32 s41, s40, 0xa000
    buffer_load_dwordx4 v[168:171], v1, s[8:11], s41 offen offset:2048 sc1
    v_mfma_f32_16x16x32_bf16 v[40:43], v[88:91], a[228:231], v[40:43]
    s_waitcnt vmcnt(20)
    s_barrier
    ds_read_b128 v[84:87], v1 offset:32768
    v_mfma_f32_16x16x32_bf16 v[44:47], v[252:255], v[88:91], v[44:47]
    s_waitcnt lgkmcnt(2)
    v_mfma_f32_16x16x32_bf16 v[36:39], a[236:239], v[92:95], v[36:39]
    s_add_u32 s41, s40, 0xb000
    buffer_load_dwordx4 v[180:183], v1, s[8:11], s41 offen offset:1024 sc1
    v_mfma_f32_16x16x32_bf16 v[40:43], v[92:95], a[240:243], v[40:43]
    ds_read_b128 v[88:91], v1 offset:33792
    v_mfma_f32_16x16x32_bf16 v[44:47], a[232:235], v[92:95], v[44:47]
    s_waitcnt lgkmcnt(2)
    v_mfma_f32_16x16x32_bf16 v[36:39], a[248:251], v[96:99], v[36:39]
    s_add_u32 m0, s35, 24576
    s_add_u32 s56, s30, 16384
    buffer_load_dwordx4 v7, s[8:11], s56 offen offset:0 sc1 lds
    v_mfma_f32_16x16x32_bf16 v[40:43], v[96:99], a[252:255], v[40:43]
    ds_read_b128 v[92:95], v1 offset:34816
    v_mfma_f32_16x16x32_bf16 v[44:47], a[244:247], v[96:99], v[44:47]
    s_waitcnt lgkmcnt(2)
    v_mfma_f32_16x16x32_bf16 v[48:51], v[196:199], v[84:87], 0
    s_add_u32 s56, s30, 17408
    buffer_load_dwordx4 v7, s[8:11], s56 offen offset:1024 sc1 lds
    s_waitcnt vmcnt(21)
    v_add_f32 v142, v142, v144
    v_add_f32 v143, v143, v145
    v_mfma_f32_16x16x32_bf16 v[52:55], v[84:87], v[200:203], 0
    ds_read_b128 v[96:99], v1 offset:35840
    s_waitcnt vmcnt(20)
    v_add_f32 v142, v142, v146
    v_add_f32 v143, v143, v147
    v_mfma_f32_16x16x32_bf16 v[56:59], v[192:195], v[84:87], 0
    s_waitcnt vmcnt(19)
    v_add_f32 v142, v142, v148
    v_add_f32 v143, v143, v149
    s_waitcnt lgkmcnt(2)
    v_mfma_f32_16x16x32_bf16 v[48:51], v[208:211], v[88:91], v[48:51]
    s_add_u32 m0, s35, 40960
    s_add_u32 s56, s30, 16640
    buffer_load_dwordx4 v7, s[8:11], s56 offen offset:0 sc1 lds
    s_waitcnt vmcnt(18)
    v_add_f32 v150, v150, v152
    v_mfma_f32_16x16x32_bf16 v[52:55], v[88:91], v[212:215], v[52:55]
    ds_read_b128 v[84:87], v1 offset:36864
    v_add_f32 v151, v151, v153
    s_waitcnt vmcnt(17)
    v_add_f32 v150, v150, v154
    v_mfma_f32_16x16x32_bf16 v[56:59], v[204:207], v[88:91], v[56:59]
    v_add_f32 v151, v151, v155
    s_waitcnt vmcnt(16)
    v_add_f32 v150, v150, v156
    s_waitcnt lgkmcnt(2)
    v_mfma_f32_16x16x32_bf16 v[48:51], v[220:223], v[92:95], v[48:51]
    s_add_u32 s56, s30, 17664
    buffer_load_dwordx4 v7, s[8:11], s56 offen offset:1024 sc1 lds
    v_add_f32 v151, v151, v157
    v_mfma_f32_16x16x32_bf16 v[52:55], v[92:95], v[224:227], v[52:55]
    ds_read_b128 v[88:91], v1 offset:37888
    v_permlane16_swap_b32 v142, v143
    v_permlane16_swap_b32 v150, v151
    v_mfma_f32_16x16x32_bf16 v[56:59], v[216:219], v[92:95], v[56:59]
    v_add_f32 v142, v142, v143
    v_add_f32 v150, v150, v151
    s_waitcnt lgkmcnt(2)
    v_mfma_f32_16x16x32_bf16 v[48:51], v[232:235], v[96:99], v[48:51]
    v_mov_b32 v143, v142
    v_mfma_f32_16x16x32_bf16 v[52:55], v[96:99], v[236:239], v[52:55]
    ds_read_b128 v[92:95], v1 offset:38912
    v_mov_b32 v151, v150
    s_add_u32 m0, s35, 49152
    s_add_u32 s56, s30, 32768
    buffer_load_dwordx4 v7, s[8:11], s56 offen offset:0 sc1 lds
    v_permlane32_swap_b32 v142, v143
    v_mfma_f32_16x16x32_bf16 v[56:59], v[228:231], v[96:99], v[56:59]
    v_permlane32_swap_b32 v150, v151
    v_add_f32 v142, v142, v143
    s_waitcnt lgkmcnt(2)
    v_mfma_f32_16x16x32_bf16 v[48:51], v[244:247], v[84:87], v[48:51]
    v_add_f32 v150, v150, v151
    v_mov_b32 v143, v142
    v_mfma_f32_16x16x32_bf16 v[52:55], v[84:87], v[248:251], v[52:55]
    ds_read_b128 v[96:99], v1 offset:39936
    v_mov_b32 v151, v150
    v_mfma_f32_16x16x32_bf16 v[56:59], v[240:243], v[84:87], v[56:59]
    v_permlane16_swap_b32 v142, v143
    v_permlane16_swap_b32 v150, v151
    s_waitcnt lgkmcnt(2)
    v_mfma_f32_16x16x32_bf16 v[48:51], a[224:227], v[88:91], v[48:51]
    s_add_u32 s56, s30, 33792
    buffer_load_dwordx4 v7, s[8:11], s56 offen offset:1024 sc1 lds
    v_mul_f32 v142, 0xbb000000, v142
    v_mul_f32 v144, v142, v142
    v_mfma_f32_16x16x32_bf16 v[52:55], v[88:91], a[228:231], v[52:55]
    v_mov_b32 v145, 0x3b000000
    s_waitcnt vmcnt(17)
    s_barrier
    ds_read_b128 v[84:87], v1 offset:8192
    v_mfma_f32_16x16x32_bf16 v[56:59], v[252:255], v[88:91], v[56:59]
    v_fma_f32 v144, v143, v145, -v144
    v_max_f32 v144, 0, v144
    s_waitcnt lgkmcnt(2)
    v_mfma_f32_16x16x32_bf16 v[48:51], a[236:239], v[92:95], v[48:51]
    v_add_f32 v144, s24, v144
    v_mov_b32 v143, v142
    v_mfma_f32_16x16x32_bf16 v[52:55], v[92:95], a[240:243], v[52:55]
    ds_read_b128 v[88:91], v1 offset:9216
    v_rsq_f32 v142, v144
    s_add_u32 m0, s35, 57344
    s_add_u32 s56, s30, 49152
    buffer_load_dwordx4 v7, s[8:11], s56 offen offset:0 sc1 lds
    v_mfma_f32_16x16x32_bf16 v[56:59], a[232:235], v[92:95], v[56:59]
    v_mul_f32 v150, 0xbb000000, v150
    s_waitcnt lgkmcnt(2)
    v_mfma_f32_16x16x32_bf16 v[48:51], a[248:251], v[96:99], v[48:51]
    v_mul_f32 v152, v150, v150
    v_mov_b32 v153, 0x3b000000
    v_mfma_f32_16x16x32_bf16 v[52:55], v[96:99], a[252:255], v[52:55]
    ds_read_b128 v[92:95], v1 offset:10240
    v_fma_f32 v152, v151, v153, -v152
    v_max_f32 v152, 0, v152
    v_mfma_f32_16x16x32_bf16 v[56:59], a[244:247], v[96:99], v[56:59]
    v_add_f32 v152, s24, v152
    s_waitcnt lgkmcnt(2)
    v_mfma_f32_16x16x32_bf16 v[28:31], a[164:167], v[84:87], v[28:31]
    s_add_u32 s56, s30, 50176
    buffer_load_dwordx4 v7, s[8:11], s56 offen offset:1024 sc1 lds
    v_mov_b32 v151, v150
    v_rsq_f32 v150, v152
    v_mfma_f32_16x16x32_bf16 v[32:35], v[84:87], a[168:171], v[32:35]
    ds_read_b128 v[96:99], v1 offset:11264
    s_lshl_b32 s38, s3, 7
    s_waitcnt lgkmcnt(2)
    v_mfma_f32_16x16x32_bf16 v[28:31], a[176:179], v[88:91], v[28:31]
    v_add_u32 v146, s38, v8
    ds_write_b64 v146, v[142:143] offset:128
    v_mfma_f32_16x16x32_bf16 v[32:35], v[88:91], a[180:183], v[32:35]
    ds_read_b128 v[84:87], v1 offset:12288
    ds_write_b64 v8, v[150:151]
    s_waitcnt lgkmcnt(4)
    v_mfma_f32_16x16x32_bf16 v[28:31], a[188:191], v[92:95], v[28:31]
    s_add_u32 m0, s35, 65536
    s_add_u32 s56, s30, 33024
    buffer_load_dwordx4 v7, s[8:11], s56 offen offset:0 sc1 lds
    v_mfma_f32_16x16x32_bf16 v[32:35], v[92:95], a[192:195], v[32:35]
    ds_read_b128 v[88:91], v1 offset:13312
    s_waitcnt lgkmcnt(4)
    v_mfma_f32_16x16x32_bf16 v[28:31], a[200:203], v[96:99], v[28:31]
    v_mfma_f32_16x16x32_bf16 v[32:35], v[96:99], a[204:207], v[32:35]
    ds_read_b128 v[92:95], v1 offset:14336
    s_waitcnt lgkmcnt(3)
    v_mfma_f32_16x16x32_bf16 v[28:31], a[212:215], v[84:87], v[28:31]
    v_mfma_f32_16x16x32_bf16 v[32:35], v[84:87], a[216:219], v[32:35]
    ds_read_b128 v[96:99], v1 offset:15360
    s_add_u32 s56, s30, 34048
    buffer_load_dwordx4 v7, s[8:11], s56 offen offset:1024 sc1 lds
    s_waitcnt lgkmcnt(2)
    v_mfma_f32_16x16x32_bf16 v[28:31], v[160:163], v[88:91], v[28:31]
    v_mfma_f32_16x16x32_bf16 v[32:35], v[88:91], v[164:167], v[32:35]
    s_waitcnt vmcnt(6)
    s_barrier
    ds_read_b128 v[84:87], v1 offset:24576
    s_waitcnt lgkmcnt(2)
    v_mfma_f32_16x16x32_bf16 v[28:31], v[172:175], v[92:95], v[28:31]
    v_mfma_f32_16x16x32_bf16 v[32:35], v[92:95], v[176:179], v[32:35]
    ds_read_b128 v[88:91], v1 offset:25600
    s_add_u32 m0, s35, 73728
    s_add_u32 s56, s30, 49408
    buffer_load_dwordx4 v7, s[8:11], s56 offen offset:0 sc1 lds
    s_waitcnt lgkmcnt(2)
    v_mfma_f32_16x16x32_bf16 v[28:31], v[184:187], v[96:99], v[28:31]
    v_mfma_f32_16x16x32_bf16 v[32:35], v[96:99], v[188:191], v[32:35]
    ds_read_b128 v[92:95], v1 offset:26624
    s_waitcnt lgkmcnt(2)
    v_mfma_f32_16x16x32_bf16 v[36:39], a[164:167], v[84:87], v[36:39]
    ds_read_b64 v[132:133], v8 offset:0
    v_mfma_f32_16x16x32_bf16 v[40:43], v[84:87], a[168:171], v[40:43]
    ds_read_b128 v[96:99], v1 offset:27648
    ds_read_b128 v[134:137], v9 offset:0
    v_mfma_f32_16x16x32_bf16 v[44:47], a[160:163], v[84:87], v[44:47]
    s_add_u32 s56, s30, 50432
    buffer_load_dwordx4 v7, s[8:11], s56 offen offset:1024 sc1 lds
    ds_read_b128 v[138:141], v9 offset:16
    s_waitcnt lgkmcnt(5)
    v_mfma_f32_16x16x32_bf16 v[36:39], a[176:179], v[88:91], v[36:39]
    s_waitcnt lgkmcnt(3)
    v_fmac_f32 v28, v133, v22
    v_mfma_f32_16x16x32_bf16 v[40:43], v[88:91], a[180:183], v[40:43]
    ds_read_b128 v[84:87], v1 offset:28672
    v_fmac_f32 v29, v133, v23
    v_mfma_f32_16x16x32_bf16 v[44:47], a[172:175], v[88:91], v[44:47]
    v_fmac_f32 v30, v133, v24
    v_mfma_f32_16x16x32_bf16 v[36:39], a[188:191], v[92:95], v[36:39]
    v_fmac_f32 v31, v133, v25
    s_lshl_b32 s42, s19, 16
    s_lshl_b32 s43, s3, 14
    s_add_u32 s42, s42, s43
    s_add_u32 m0, s43, 98304
    s_add_u32 s42, s42, 0x180000
    buffer_load_dwordx4 v1, s[8:11], s42 offen offset:0 sc1 lds
    v_mfma_f32_16x16x32_bf16 v[40:43], v[92:95], a[192:195], v[40:43]
    ds_read_b128 v[88:91], v1 offset:29696
    v_mul_f32 v28, v132, v28
    v_mfma_f32_16x16x32_bf16 v[44:47], a[184:187], v[92:95], v[44:47]
    v_mul_f32 v29, v132, v29
    s_waitcnt lgkmcnt(4)
    v_mfma_f32_16x16x32_bf16 v[36:39], a[200:203], v[96:99], v[36:39]
    v_mul_f32 v30, v132, v30
    v_mfma_f32_16x16x32_bf16 v[40:43], v[96:99], a[204:207], v[40:43]
    ds_read_b128 v[92:95], v1 offset:30720
    v_mul_f32 v31, v132, v31
    v_mfma_f32_16x16x32_bf16 v[44:47], a[196:199], v[96:99], v[44:47]
    buffer_load_dwordx4 v1, s[8:11], s42 offen offset:1024 sc1 lds
    v_cvt_pk_bf16_f32 v100, v28, v29
    s_waitcnt lgkmcnt(2)
    v_mfma_f32_16x16x32_bf16 v[36:39], a[212:215], v[84:87], v[36:39]
    v_cvt_pk_bf16_f32 v101, v30, v31
    v_mfma_f32_16x16x32_bf16 v[40:43], v[84:87], a[216:219], v[40:43]
    ds_read_b128 v[96:99], v1 offset:31744
    v_fmac_f32 v32, v135, v26
    v_mfma_f32_16x16x32_bf16 v[44:47], a[208:211], v[84:87], v[44:47]
    v_fmac_f32 v33, v137, v26
    s_waitcnt lgkmcnt(2)
    v_mfma_f32_16x16x32_bf16 v[36:39], v[160:163], v[88:91], v[36:39]
    buffer_load_dwordx4 v1, s[8:11], s42 offen offset:2048 sc1 lds
    v_fmac_f32 v34, v139, v26
    v_mfma_f32_16x16x32_bf16 v[40:43], v[88:91], v[164:167], v[40:43]
    ds_read_b128 v[84:87], v1 offset:40960
    v_fmac_f32 v35, v141, v26
    v_mfma_f32_16x16x32_bf16 v[44:47], a[220:223], v[88:91], v[44:47]
    v_mul_f32 v32, v134, v32
    s_waitcnt lgkmcnt(2)
    v_mfma_f32_16x16x32_bf16 v[36:39], v[172:175], v[92:95], v[36:39]
    v_mul_f32 v33, v136, v33
    v_mfma_f32_16x16x32_bf16 v[40:43], v[92:95], v[176:179], v[40:43]
    ds_read_b128 v[88:91], v1 offset:41984
    v_mul_f32 v34, v138, v34
    v_mfma_f32_16x16x32_bf16 v[44:47], v[168:171], v[92:95], v[44:47]
    buffer_load_dwordx4 v1, s[8:11], s42 offen offset:3072 sc1 lds
    v_mul_f32 v35, v140, v35
    s_waitcnt lgkmcnt(2)
    v_mfma_f32_16x16x32_bf16 v[36:39], v[184:187], v[96:99], v[36:39]
    v_cvt_pk_bf16_f32 v110, v32, v33
    v_mfma_f32_16x16x32_bf16 v[40:43], v[96:99], v[188:191], v[40:43]
    ds_read_b128 v[92:95], v1 offset:43008
    v_cvt_pk_bf16_f32 v111, v34, v35
    v_mfma_f32_16x16x32_bf16 v[44:47], v[180:183], v[96:99], v[44:47]
    s_waitcnt lgkmcnt(2)
    v_mfma_f32_16x16x32_bf16 v[48:51], a[164:167], v[84:87], v[48:51]
    ds_read_b64 v[132:133], v8 offset:128
    s_add_u32 m0, s43, 102400
    s_add_u32 s42, s42, 4096
    buffer_load_dwordx4 v1, s[8:11], s42 offen offset:0 sc1 lds
    ds_read_b128 v[134:137], v9 offset:128
    v_mfma_f32_16x16x32_bf16 v[52:55], v[84:87], a[168:171], v[52:55]
    ds_read_b128 v[96:99], v1 offset:44032
    ds_read_b128 v[138:141], v9 offset:144
    v_mfma_f32_16x16x32_bf16 v[56:59], a[160:163], v[84:87], v[56:59]
    s_waitcnt lgkmcnt(3)
    v_fmac_f32 v36, v133, v22
    v_mfma_f32_16x16x32_bf16 v[48:51], a[176:179], v[88:91], v[48:51]
    v_fmac_f32 v37, v133, v23
    v_mfma_f32_16x16x32_bf16 v[52:55], v[88:91], a[180:183], v[52:55]
    ds_read_b128 v[84:87], v1 offset:45056
    v_fmac_f32 v38, v133, v24
    v_fmac_f32 v39, v133, v25
    v_mfma_f32_16x16x32_bf16 v[56:59], a[172:175], v[88:91], v[56:59]
    buffer_load_dwordx4 v1, s[8:11], s42 offen offset:1024 sc1 lds
    v_fmac_f32 v44, v133, v18
    v_mfma_f32_16x16x32_bf16 v[48:51], a[188:191], v[92:95], v[48:51]
    v_fmac_f32 v45, v133, v19
    v_mfma_f32_16x16x32_bf16 v[52:55], v[92:95], a[192:195], v[52:55]
    ds_read_b128 v[88:91], v1 offset:46080
    v_fmac_f32 v46, v133, v20
    v_mfma_f32_16x16x32_bf16 v[56:59], a[184:187], v[92:95], v[56:59]
    v_fmac_f32 v47, v133, v21
    v_mul_f32 v36, v132, v36
    s_waitcnt lgkmcnt(3)
    v_mfma_f32_16x16x32_bf16 v[48:51], a[200:203], v[96:99], v[48:51]
    buffer_load_dwordx4 v1, s[8:11], s42 offen offset:2048 sc1 lds
    v_mul_f32 v37, v132, v37
    v_mfma_f32_16x16x32_bf16 v[52:55], v[96:99], a[204:207], v[52:55]
    ds_read_b128 v[92:95], v1 offset:47104
    v_mul_f32 v38, v132, v38
    v_mfma_f32_16x16x32_bf16 v[56:59], a[196:199], v[96:99], v[56:59]
    v_mul_f32 v39, v132, v39
    s_waitcnt lgkmcnt(2)
    v_mfma_f32_16x16x32_bf16 v[48:51], a[212:215], v[84:87], v[48:51]
    v_mul_f32 v128, s26, v132
    v_cvt_pk_bf16_f32 v120, v44, v45
    v_mfma_f32_16x16x32_bf16 v[52:55], v[84:87], a[216:219], v[52:55]
    ds_read_b128 v[96:99], v1 offset:48128
    v_cvt_pk_bf16_f32 v121, v46, v47
    v_mfma_f32_16x16x32_bf16 v[56:59], a[208:211], v[84:87], v[56:59]
    buffer_load_dwordx4 v1, s[8:11], s42 offen offset:3072 sc1 lds
    v_cvt_pk_bf16_f32 v102, v36, v37
    s_waitcnt lgkmcnt(2)
    v_mfma_f32_16x16x32_bf16 v[48:51], v[160:163], v[88:91], v[48:51]
    v_cvt_pk_bf16_f32 v103, v38, v39
    v_mfma_f32_16x16x32_bf16 v[52:55], v[88:91], v[164:167], v[52:55]
    v_fmac_f32 v40, v135, v26
    v_fmac_f32 v41, v137, v26
    s_waitcnt vmcnt(12)
    s_barrier
    ds_read_b128 v[84:87], v1 offset:49152
    v_mfma_f32_16x16x32_bf16 v[56:59], a[220:223], v[88:91], v[56:59]
    v_fmac_f32 v42, v139, v26
    s_waitcnt lgkmcnt(2)
    v_mfma_f32_16x16x32_bf16 v[48:51], v[172:175], v[92:95], v[48:51]
    v_fmac_f32 v43, v141, v26
    s_add_u32 m0, s43, 106496
    s_add_u32 s42, s42, 4096
    buffer_load_dwordx4 v1, s[8:11], s42 offen offset:0 sc1 lds
    v_mfma_f32_16x16x32_bf16 v[52:55], v[92:95], v[176:179], v[52:55]
    ds_read_b128 v[88:91], v1 offset:50176
    v_mul_f32 v40, v134, v40
    v_mfma_f32_16x16x32_bf16 v[56:59], v[168:171], v[92:95], v[56:59]
    v_mul_f32 v41, v136, v41
    v_mul_f32 v42, v138, v42
    s_waitcnt lgkmcnt(2)
    v_mfma_f32_16x16x32_bf16 v[48:51], v[184:187], v[96:99], v[48:51]
    v_mul_f32 v43, v140, v43
    v_mfma_f32_16x16x32_bf16 v[52:55], v[96:99], v[188:191], v[52:55]
    ds_read_b128 v[92:95], v1 offset:51200
    v_cvt_pk_bf16_f32 v112, v40, v41
    v_mfma_f32_16x16x32_bf16 v[56:59], v[180:183], v[96:99], v[56:59]
    buffer_load_dwordx4 v1, s[8:11], s42 offen offset:1024 sc1 lds
    v_cvt_pk_bf16_f32 v113, v42, v43
    s_waitcnt lgkmcnt(2)
    v_mfma_f32_16x16x32_bf16 v[60:63], v[196:199], v[84:87], 0
    ds_read_b64 v[132:133], v8 offset:256
    ds_read_b128 v[134:137], v9 offset:256
    v_mfma_f32_16x16x32_bf16 v[64:67], v[84:87], v[200:203], 0
    ds_read_b128 v[96:99], v1 offset:52224
    ds_read_b128 v[138:141], v9 offset:272
    s_waitcnt lgkmcnt(3)
    v_fmac_f32 v48, v133, v22
    v_mfma_f32_16x16x32_bf16 v[68:71], v[192:195], v[84:87], 0
    v_fmac_f32 v49, v133, v23
    v_fmac_f32 v50, v133, v24
    v_mfma_f32_16x16x32_bf16 v[60:63], v[208:211], v[88:91], v[60:63]
    v_fmac_f32 v51, v133, v25
    buffer_load_dwordx4 v1, s[8:11], s42 offen offset:2048 sc1 lds
    v_fmac_f32 v56, v133, v18
    v_mfma_f32_16x16x32_bf16 v[64:67], v[88:91], v[212:215], v[64:67]
    ds_read_b128 v[84:87], v1 offset:53248
    v_fmac_f32 v57, v133, v19
    v_fmac_f32 v58, v133, v20
    v_mfma_f32_16x16x32_bf16 v[68:71], v[204:207], v[88:91], v[68:71]
    v_fmac_f32 v59, v133, v21
    v_mul_f32 v48, v132, v48
    v_mfma_f32_16x16x32_bf16 v[60:63], v[220:223], v[92:95], v[60:63]
    v_mul_f32 v49, v132, v49
    v_mul_f32 v50, v132, v50
    v_mfma_f32_16x16x32_bf16 v[64:67], v[92:95], v[224:227], v[64:67]
    ds_read_b128 v[88:91], v1 offset:54272
    v_mul_f32 v51, v132, v51
    v_mfma_f32_16x16x32_bf16 v[68:71], v[216:219], v[92:95], v[68:71]
    buffer_load_dwordx4 v1, s[8:11], s42 offen offset:3072 sc1 lds
    v_mul_f32 v129, s26, v132
    v_cvt_pk_bf16_f32 v122, v56, v57
    s_waitcnt lgkmcnt(3)
    v_mfma_f32_16x16x32_bf16 v[60:63], v[232:235], v[96:99], v[60:63]
    v_cvt_pk_bf16_f32 v123, v58, v59
    v_cvt_pk_bf16_f32 v104, v48, v49
    v_mfma_f32_16x16x32_bf16 v[64:67], v[96:99], v[236:239], v[64:67]
    ds_read_b128 v[92:95], v1 offset:55296
    v_cvt_pk_bf16_f32 v105, v50, v51
    v_fmac_f32 v52, v135, v26
    v_mfma_f32_16x16x32_bf16 v[68:71], v[228:231], v[96:99], v[68:71]
    v_fmac_f32 v53, v137, v26
    s_waitcnt lgkmcnt(3)
    v_fmac_f32 v54, v139, v26
    s_waitcnt lgkmcnt(2)
    v_mfma_f32_16x16x32_bf16 v[60:63], v[244:247], v[84:87], v[60:63]
    v_fmac_f32 v55, v141, v26
    s_add_u32 m0, s43, 110592
    s_add_u32 s42, s42, 4096
    buffer_load_dwordx4 v1, s[8:11], s42 offen offset:0 sc1 lds
    v_mul_f32 v52, v134, v52
    v_mfma_f32_16x16x32_bf16 v[64:67], v[84:87], v[248:251], v[64:67]
    ds_read_b128 v[96:99], v1 offset:56320
    v_mul_f32 v53, v136, v53
    v_mul_f32 v54, v138, v54
    v_mfma_f32_16x16x32_bf16 v[68:71], v[240:243], v[84:87], v[68:71]
    v_mul_f32 v55, v140, v55
    v_cvt_pk_bf16_f32 v114, v52, v53
    s_waitcnt lgkmcnt(2)
    v_mfma_f32_16x16x32_bf16 v[60:63], a[224:227], v[88:91], v[60:63]
    v_cvt_pk_bf16_f32 v115, v54, v55
    v_mfma_f32_16x16x32_bf16 v[64:67], v[88:91], a[228:231], v[64:67]
    ds_read_b128 v[84:87], v1 offset:57344
    v_mfma_f32_16x16x16_bf16 v[28:31], v[100:101], v[120:121], 0
    v_mfma_f32_16x16x16_bf16 v[32:35], v[102:103], v[120:121], 0
    v_mfma_f32_16x16x32_bf16 v[68:71], v[252:255], v[88:91], v[68:71]
    buffer_load_dwordx4 v1, s[8:11], s42 offen offset:1024 sc1 lds
    v_mfma_f32_16x16x16_bf16 v[36:39], v[102:103], v[122:123], 0
    s_waitcnt lgkmcnt(2)
    v_mfma_f32_16x16x32_bf16 v[60:63], a[236:239], v[92:95], v[60:63]
    v_mfma_f32_16x16x16_bf16 v[40:43], v[104:105], v[122:123], 0
    v_mfma_f32_16x16x32_bf16 v[64:67], v[92:95], a[240:243], v[64:67]
    ds_read_b128 v[88:91], v1 offset:58368
    s_lshl_b32 s38, s16, 16
    v_mfma_f32_16x16x32_bf16 v[68:71], a[232:235], v[92:95], v[68:71]
    s_lshl_b32 s39, s17, 10
    s_add_u32 s38, s38, s39
    s_add_u32 s38, s38, 0x1000000
    v_cndmask_b32 v44, v28, v29, s[28:29]
    s_waitcnt lgkmcnt(2)
    v_mfma_f32_16x16x32_bf16 v[60:63], a[248:251], v[96:99], v[60:63]
    v_cndmask_b32 v45, v30, v31, s[28:29]
    buffer_load_dwordx4 v1, s[8:11], s42 offen offset:2048 sc1 lds
    v_cndmask_b32 v46, v32, v33, s[28:29]
    v_mfma_f32_16x16x32_bf16 v[64:67], v[96:99], a[252:255], v[64:67]
    ds_read_b128 v[92:95], v1 offset:59392
    v_cndmask_b32 v47, v34, v35, s[28:29]
    v_cndmask_b32 v48, v36, v37, s[28:29]
    v_mfma_f32_16x16x32_bf16 v[68:71], a[244:247], v[96:99], v[68:71]
    v_cndmask_b32 v49, v38, v39, s[28:29]
    v_cndmask_b32 v50, v40, v41, s[28:29]
    s_waitcnt lgkmcnt(2)
    v_mfma_f32_16x16x32_bf16 v[60:63], a[164:167], v[84:87], v[60:63]
    v_cndmask_b32 v51, v42, v43, s[28:29]
    v_fma_f32 v44, v44, v128, v14
    v_fma_f32 v45, v45, v128, v15
    v_mfma_f32_16x16x32_bf16 v[64:67], v[84:87], a[168:171], v[64:67]
    ds_read_b128 v[96:99], v1 offset:60416
    v_fma_f32 v46, v46, v128, v12
    v_fma_f32 v47, v47, v128, v13
    v_mfma_f32_16x16x32_bf16 v[68:71], a[160:163], v[84:87], v[68:71]
    buffer_load_dwordx4 v1, s[8:11], s42 offen offset:3072 sc1 lds
    v_fma_f32 v48, v48, v129, v10
    v_fma_f32 v49, v49, v129, v11
    s_waitcnt lgkmcnt(2)
    v_mfma_f32_16x16x32_bf16 v[60:63], a[176:179], v[88:91], v[60:63]
    v_fma_f32 v50, v50, v129, v12
    v_fma_f32 v51, v51, v129, v13
    v_mfma_f32_16x16x32_bf16 v[64:67], v[88:91], a[180:183], v[64:67]
    ds_read_b128 v[84:87], v1 offset:61440
    v_max3_f32 v142, v44, v45, v46
    v_max3_f32 v143, v48, v49, v50
    v_mfma_f32_16x16x32_bf16 v[68:71], a[172:175], v[88:91], v[68:71]
    v_max_f32 v142, v142, v47
    v_max_f32 v143, v143, v51
    s_waitcnt lgkmcnt(2)
    v_mfma_f32_16x16x32_bf16 v[60:63], a[188:191], v[92:95], v[60:63]
    v_permlane16_swap_b32 v142, v143
    v_max_f32 v142, v142, v143
    v_mfma_f32_16x16x32_bf16 v[64:67], v[92:95], a[192:195], v[64:67]
    ds_read_b128 v[88:91], v1 offset:62464
    v_mov_b32 v143, v142
    s_nop 1
    v_permlane32_swap_b32 v142, v143
    v_mfma_f32_16x16x32_bf16 v[68:71], a[184:187], v[92:95], v[68:71]
    v_max_f32 v142, v142, v143
    v_mov_b32 v143, v142
    s_waitcnt lgkmcnt(2)
    v_mfma_f32_16x16x32_bf16 v[60:63], a[200:203], v[96:99], v[60:63]
    v_permlane16_swap_b32 v142, v143
    v_sub_f32 v44, v44, v142
    v_sub_f32 v45, v45, v142
    v_mfma_f32_16x16x32_bf16 v[64:67], v[96:99], a[204:207], v[64:67]
    ds_read_b128 v[92:95], v1 offset:63488
    v_sub_f32 v46, v46, v142
    v_sub_f32 v47, v47, v142
    v_mfma_f32_16x16x32_bf16 v[68:71], a[196:199], v[96:99], v[68:71]
    v_sub_f32 v48, v48, v143
    v_sub_f32 v49, v49, v143
    s_waitcnt lgkmcnt(2)
    v_mfma_f32_16x16x32_bf16 v[60:63], a[212:215], v[84:87], v[60:63]
    v_sub_f32 v50, v50, v143
    v_sub_f32 v51, v51, v143
    v_mfma_f32_16x16x32_bf16 v[64:67], v[84:87], a[216:219], v[64:67]
    ds_read_b128 v[96:99], v1 offset:64512
    v_exp_f32 v44, v44
    v_mfma_f32_16x16x32_bf16 v[68:71], a[208:211], v[84:87], v[68:71]
    v_exp_f32 v45, v45
    s_waitcnt lgkmcnt(2)
    v_mfma_f32_16x16x32_bf16 v[60:63], v[160:163], v[88:91], v[60:63]
    v_exp_f32 v46, v46
    v_mfma_f32_16x16x32_bf16 v[64:67], v[88:91], v[164:167], v[64:67]
    v_exp_f32 v47, v47
    s_waitcnt vmcnt(16)
    s_barrier
    ds_read_b128 v[84:87], v6 offset:0
    v_mfma_f32_16x16x32_bf16 v[68:71], a[220:223], v[88:91], v[68:71]
    v_exp_f32 v48, v48
    s_waitcnt lgkmcnt(2)
    v_mfma_f32_16x16x32_bf16 v[60:63], v[172:175], v[92:95], v[60:63]
    v_exp_f32 v49, v49
    v_exp_f32 v50, v50
    v_mfma_f32_16x16x32_bf16 v[64:67], v[92:95], v[176:179], v[64:67]
    ds_read_b128 v[88:91], v6 offset:1024
    v_exp_f32 v51, v51
    v_mfma_f32_16x16x32_bf16 v[68:71], v[168:171], v[92:95], v[68:71]
    v_cvt_pk_bf16_f32 v28, v44, v45
    s_waitcnt lgkmcnt(2)
    v_mfma_f32_16x16x32_bf16 v[60:63], v[184:187], v[96:99], v[60:63]
    v_cvt_pk_bf16_f32 v29, v46, v47
    v_perm_b32 v52, v28, v28, v16
    v_mfma_f32_16x16x32_bf16 v[64:67], v[96:99], v[188:191], v[64:67]
    ds_read_b128 v[92:95], v6 offset:2048
    v_perm_b32 v53, v28, v28, v17
    v_perm_b32 v54, v29, v29, v16
    v_mfma_f32_16x16x32_bf16 v[68:71], v[180:183], v[96:99], v[68:71]
    v_perm_b32 v55, v29, v29, v17
    v_add_f32 v144, v44, v45
    s_waitcnt lgkmcnt(2)
    v_mfma_f32_16x16x32_bf16 v[72:75], v[196:199], v[84:87], 0
    v_add_f32 v46, v46, v47
    v_mfma_f32_16x16x32_bf16 v[146:149], v[110:113], v[52:55], 0
    v_mfma_f32_16x16x32_bf16 v[76:79], v[84:87], v[200:203], 0
    ds_read_b128 v[96:99], v6 offset:3072
    v_add_f32 v144, v144, v46
    v_mfma_f32_16x16x32_bf16 v[80:83], v[192:195], v[84:87], 0
    v_cvt_pk_bf16_f32 v36, v48, v49
    v_cvt_pk_bf16_f32 v37, v50, v51
    v_perm_b32 v56, v36, v36, v16
    s_waitcnt lgkmcnt(2)
    v_mfma_f32_16x16x32_bf16 v[72:75], v[208:211], v[88:91], v[72:75]
    v_perm_b32 v57, v36, v36, v17
    v_perm_b32 v58, v37, v37, v16
    v_mfma_f32_16x16x32_bf16 v[76:79], v[88:91], v[212:215], v[76:79]
    ds_read_b128 v[84:87], v6 offset:4096
    v_perm_b32 v59, v37, v37, v17
    v_add_f32 v145, v48, v49
    v_mfma_f32_16x16x32_bf16 v[80:83], v[204:207], v[88:91], v[80:83]
    v_add_f32 v50, v50, v51
    v_mfma_f32_16x16x32_bf16 v[150:153], v[112:115], v[56:59], 0
    s_waitcnt lgkmcnt(2)
    v_mfma_f32_16x16x32_bf16 v[72:75], v[220:223], v[92:95], v[72:75]
    v_add_f32 v145, v145, v50
    v_mfma_f32_16x16x32_bf16 v[76:79], v[92:95], v[224:227], v[76:79]
    ds_read_b128 v[88:91], v6 offset:5120
    v_permlane16_swap_b32 v144, v145
    v_add_f32 v144, v144, v145
    v_mfma_f32_16x16x32_bf16 v[80:83], v[216:219], v[92:95], v[80:83]
    v_mov_b32 v145, v144
    s_nop 1
    v_permlane32_swap_b32 v144, v145
    s_waitcnt lgkmcnt(2)
    v_mfma_f32_16x16x32_bf16 v[72:75], v[232:235], v[96:99], v[72:75]
    v_add_f32 v144, v144, v145
    v_rcp_f32 v144, v144
    v_mfma_f32_16x16x32_bf16 v[76:79], v[96:99], v[236:239], v[76:79]
    ds_read_b128 v[92:95], v6 offset:6144
    v_mov_b32 v145, v144
    v_mfma_f32_16x16x32_bf16 v[80:83], v[228:231], v[96:99], v[80:83]
    s_nop 0
    v_permlane16_swap_b32 v144, v145
    v_mul_f32 v146, v146, v144
    v_mul_f32 v147, v147, v144
    s_waitcnt lgkmcnt(2)
    v_mfma_f32_16x16x32_bf16 v[72:75], v[244:247], v[84:87], v[72:75]
    v_mul_f32 v148, v148, v144
    v_mul_f32 v149, v149, v144
    v_mfma_f32_16x16x32_bf16 v[76:79], v[84:87], v[248:251], v[76:79]
    ds_read_b128 v[96:99], v6 offset:7168
    v_mul_f32 v150, v150, v145
    v_mul_f32 v151, v151, v145
    v_mfma_f32_16x16x32_bf16 v[80:83], v[240:243], v[84:87], v[80:83]
    v_mul_f32 v152, v152, v145
    v_mul_f32 v153, v153, v145
    s_waitcnt lgkmcnt(2)
    v_mfma_f32_16x16x32_bf16 v[72:75], a[224:227], v[88:91], v[72:75]
    v_cvt_pk_bf16_f32 v154, v146, v147
    v_cvt_pk_bf16_f32 v155, v148, v149
    v_mfma_f32_16x16x32_bf16 v[76:79], v[88:91], a[228:231], v[76:79]
    ds_read_b128 v[84:87], v6 offset:8192
    v_cvt_pk_bf16_f32 v156, v150, v151
    v_cvt_pk_bf16_f32 v157, v152, v153
    v_mfma_f32_16x16x32_bf16 v[80:83], v[252:255], v[88:91], v[80:83]
    v_permlane16_swap_b32 v154, v156
    v_permlane16_swap_b32 v155, v157
    s_waitcnt lgkmcnt(2)
    v_mfma_f32_16x16x32_bf16 v[72:75], a[236:239], v[92:95], v[72:75]
    buffer_store_dwordx4 v[154:157], v1, s[8:11], s38 offen sc1
    v_mfma_f32_16x16x32_bf16 v[76:79], v[92:95], a[240:243], v[76:79]
    ds_read_b128 v[88:91], v6 offset:9216
    v_mfma_f32_16x16x32_bf16 v[80:83], a[232:235], v[92:95], v[80:83]
    ds_read_b64 v[132:133], v8 offset:384
    ds_read_b128 v[134:137], v9 offset:384
    s_waitcnt lgkmcnt(4)
    v_mfma_f32_16x16x32_bf16 v[72:75], a[248:251], v[96:99], v[72:75]
    ds_read_b128 v[138:141], v9 offset:400
    v_mfma_f32_16x16x32_bf16 v[76:79], v[96:99], a[252:255], v[76:79]
    ds_read_b128 v[92:95], v6 offset:10240
L_pad32000:
    s_cbranch_execz L_ret_p2s0
    s_waitcnt lgkmcnt(3)
    v_fmac_f32 v60, v133, v22
    v_mfma_f32_16x16x32_bf16 v[80:83], a[244:247], v[96:99], v[80:83]
    v_fmac_f32 v61, v133, v23
    v_mfma_f32_16x16x32_bf16 v[72:75], a[164:167], v[84:87], v[72:75]
    v_fmac_f32 v62, v133, v24
    v_mfma_f32_16x16x32_bf16 v[76:79], v[84:87], a[168:171], v[76:79]
    ds_read_b128 v[96:99], v6 offset:11264
    v_fmac_f32 v63, v133, v25
    v_mfma_f32_16x16x32_bf16 v[80:83], a[160:163], v[84:87], v[80:83]
    v_fmac_f32 v68, v133, v18
    v_mfma_f32_16x16x32_bf16 v[72:75], a[176:179], v[88:91], v[72:75]
    v_fmac_f32 v69, v133, v19
    v_mfma_f32_16x16x32_bf16 v[76:79], v[88:91], a[180:183], v[76:79]
    ds_read_b128 v[84:87], v6 offset:12288
    v_fmac_f32 v70, v133, v20
    v_mfma_f32_16x16x32_bf16 v[80:83], a[172:175], v[88:91], v[80:83]
    v_fmac_f32 v71, v133, v21
    s_waitcnt lgkmcnt(2)
    v_mfma_f32_16x16x32_bf16 v[72:75], a[188:191], v[92:95], v[72:75]
    v_mul_f32 v60, v132, v60
    v_mfma_f32_16x16x32_bf16 v[76:79], v[92:95], a[192:195], v[76:79]
    ds_read_b128 v[88:91], v6 offset:13312
    v_mul_f32 v61, v132, v61
    v_mfma_f32_16x16x32_bf16 v[80:83], a[184:187], v[92:95], v[80:83]
    v_mul_f32 v62, v132, v62
    s_waitcnt lgkmcnt(2)
    v_mfma_f32_16x16x32_bf16 v[72:75], a[200:203], v[96:99], v[72:75]
    v_mul_f32 v63, v132, v63
    v_mfma_f32_16x16x32_bf16 v[76:79], v[96:99], a[204:207], v[76:79]
    ds_read_b128 v[92:95], v6 offset:14336
    v_mul_f32 v130, s26, v132
    v_cvt_pk_bf16_f32 v124, v68, v69
    v_mfma_f32_16x16x32_bf16 v[80:83], a[196:199], v[96:99], v[80:83]
    v_cvt_pk_bf16_f32 v125, v70, v71
    s_waitcnt lgkmcnt(2)
    v_mfma_f32_16x16x32_bf16 v[72:75], a[212:215], v[84:87], v[72:75]
    v_cvt_pk_bf16_f32 v106, v60, v61
    v_mfma_f32_16x16x32_bf16 v[76:79], v[84:87], a[216:219], v[76:79]
    ds_read_b128 v[96:99], v6 offset:15360
    v_cvt_pk_bf16_f32 v107, v62, v63
    v_mfma_f32_16x16x32_bf16 v[80:83], a[208:211], v[84:87], v[80:83]
    v_fmac_f32 v64, v135, v26
    s_waitcnt lgkmcnt(2)
    v_mfma_f32_16x16x32_bf16 v[72:75], v[160:163], v[88:91], v[72:75]
    v_fmac_f32 v65, v137, v26
    v_mfma_f32_16x16x32_bf16 v[76:79], v[88:91], v[164:167], v[76:79]
    v_fmac_f32 v66, v139, v26
    v_mfma_f32_16x16x32_bf16 v[80:83], a[220:223], v[88:91], v[80:83]
    v_fmac_f32 v67, v141, v26
    s_waitcnt lgkmcnt(1)
    v_mfma_f32_16x16x32_bf16 v[72:75], v[172:175], v[92:95], v[72:75]
    v_mul_f32 v64, v134, v64
    v_mfma_f32_16x16x32_bf16 v[76:79], v[92:95], v[176:179], v[76:79]
    v_mul_f32 v65, v136, v65
    v_mfma_f32_16x16x32_bf16 v[80:83], v[168:171], v[92:95], v[80:83]
    v_mul_f32 v66, v138, v66
    s_waitcnt lgkmcnt(0)
    v_mfma_f32_16x16x32_bf16 v[72:75], v[184:187], v[96:99], v[72:75]
    v_mul_f32 v67, v140, v67
    v_mfma_f32_16x16x32_bf16 v[76:79], v[96:99], v[188:191], v[76:79]
    v_cvt_pk_bf16_f32 v116, v64, v65
    v_mfma_f32_16x16x32_bf16 v[80:83], v[180:183], v[96:99], v[80:83]
    v_cvt_pk_bf16_f32 v117, v66, v67
    ds_read_b64 v[132:133], v8 offset:512
    ds_read_b128 v[134:137], v9 offset:512
    ds_read_b128 v[138:141], v9 offset:528
    s_waitcnt vmcnt(1)
    s_waitcnt lgkmcnt(0)
    s_barrier
    s_lshl_b32 s30, s16, 8
    s_add_u32 s30, s30, 0x2302000
    v_mov_b32 v3, 1
    s_mov_b64 exec, 1
    buffer_atomic_add v3, off, s[8:11], s30 sc1
    s_mov_b64 exec, -1
    v_pk_fma_f32 v[72:73], v[132:133], v[22:23], v[72:73] op_sel:[1,0,0] op_sel_hi:[1,1,1]
    s_mul_i32 s44, s21, 229376
    v_pk_fma_f32 v[74:75], v[132:133], v[24:25], v[74:75] op_sel:[1,0,0] op_sel_hi:[1,1,1]
    v_pk_fma_f32 v[80:81], v[132:133], v[18:19], v[80:81] op_sel:[1,0,0] op_sel_hi:[1,1,1]
    v_pk_fma_f32 v[82:83], v[132:133], v[20:21], v[82:83] op_sel:[1,0,0] op_sel_hi:[1,1,1]
    v_pk_mul_f32 v[72:73], v[132:133], v[72:73] op_sel:[0,0] op_sel_hi:[0,1]
    v_pk_mul_f32 v[74:75], v[132:133], v[74:75] op_sel:[0,0] op_sel_hi:[0,1]
    s_lshl_b32 s45, s3, 13
    v_mul_f32 v131, s26, v132
    v_cvt_pk_bf16_f32 v126, v80, v81
    v_cvt_pk_bf16_f32 v127, v82, v83
    v_cvt_pk_bf16_f32 v108, v72, v73
    v_cvt_pk_bf16_f32 v109, v74, v75
    s_add_u32 s44, s44, s45
    v_fmac_f32 v76, v135, v26
    v_fmac_f32 v77, v137, v26
    v_fmac_f32 v78, v139, v26
    v_fmac_f32 v79, v141, v26
    v_mul_f32 v76, v134, v76
    s_add_u32 m0, s45, 0
    v_mul_f32 v77, v136, v77
    v_mul_f32 v78, v138, v78
    v_mul_f32 v79, v140, v79
    v_cvt_pk_bf16_f32 v118, v76, v77
    v_cvt_pk_bf16_f32 v119, v78, v79
    s_add_u32 s47, s44, 0x200000
    v_mfma_f32_16x16x16_bf16 v[28:31], v[104:105], v[124:125], 0
    v_mfma_f32_16x16x16_bf16 v[32:35], v[106:107], v[124:125], 0
    v_mfma_f32_16x16x16_bf16 v[36:39], v[106:107], v[126:127], 0
    v_mfma_f32_16x16x16_bf16 v[40:43], v[108:109], v[126:127], 0
    s_add_u32 s38, s38, 32768
    s_nop 3
    v_cndmask_b32 v44, v28, v29, s[28:29]
    buffer_load_dwordx4 v1, s[8:11], s47 offen offset:0 sc1 lds
    v_cndmask_b32 v45, v30, v31, s[28:29]
    v_cndmask_b32 v46, v32, v33, s[28:29]
    v_cndmask_b32 v47, v34, v35, s[28:29]
    v_cndmask_b32 v48, v36, v37, s[28:29]
    v_cndmask_b32 v49, v38, v39, s[28:29]
    buffer_load_dwordx4 v1, s[8:11], s47 offen offset:1024 sc1 lds
    v_cndmask_b32 v50, v40, v41, s[28:29]
    v_cndmask_b32 v51, v42, v43, s[28:29]
    v_pk_fma_f32 v[44:45], v[44:45], v[130:131], v[10:11] op_sel:[0,0,0] op_sel_hi:[1,0,1]
    v_pk_fma_f32 v[46:47], v[46:47], v[130:131], v[12:13] op_sel:[0,0,0] op_sel_hi:[1,0,1]
    v_pk_fma_f32 v[48:49], v[48:49], v[130:131], v[10:11] op_sel:[0,1,0] op_sel_hi:[1,1,1]
    buffer_load_dwordx4 v1, s[8:11], s47 offen offset:2048 sc1 lds
    v_pk_fma_f32 v[50:51], v[50:51], v[130:131], v[12:13] op_sel:[0,1,0] op_sel_hi:[1,1,1]
    v_max3_f32 v142, v44, v45, v46
    v_max3_f32 v143, v48, v49, v50
    v_max_f32 v142, v142, v47
    v_max_f32 v143, v143, v51
    buffer_load_dwordx4 v1, s[8:11], s47 offen offset:3072 sc1 lds
    s_nop 0
    v_permlane16_swap_b32 v142, v143
    v_max_f32 v142, v142, v143
    v_mov_b32 v143, v142
    s_nop 1
    v_permlane32_swap_b32 v142, v143
    v_max_f32 v142, v142, v143
    v_mov_b32 v143, v142
    s_add_u32 m0, s45, 4096
    s_nop 0
    v_permlane16_swap_b32 v142, v143
    v_pk_add_f32 v[44:45], v[44:45], v[142:143] op_sel:[0,0] op_sel_hi:[1,0] neg_lo:[0,1] neg_hi:[0,1]
    v_pk_add_f32 v[46:47], v[46:47], v[142:143] op_sel:[0,0] op_sel_hi:[1,0] neg_lo:[0,1] neg_hi:[0,1]
    v_pk_add_f32 v[48:49], v[48:49], v[142:143] op_sel:[0,1] op_sel_hi:[1,1] neg_lo:[0,1] neg_hi:[0,1]
    v_pk_add_f32 v[50:51], v[50:51], v[142:143] op_sel:[0,1] op_sel_hi:[1,1] neg_lo:[0,1] neg_hi:[0,1]
    s_add_u32 s47, s44, 0x201000
    v_exp_f32 v44, v44
    v_exp_f32 v45, v45
    v_exp_f32 v46, v46
    v_exp_f32 v47, v47
    v_exp_f32 v48, v48
    buffer_load_dwordx4 v1, s[8:11], s47 offen offset:0 sc1 lds
    v_exp_f32 v49, v49
    v_exp_f32 v50, v50
    v_exp_f32 v51, v51
    v_cvt_pk_bf16_f32 v28, v44, v45
    v_cvt_pk_bf16_f32 v29, v46, v47
    buffer_load_dwordx4 v1, s[8:11], s47 offen offset:1024 sc1 lds
    v_perm_b32 v52, v28, v28, v16
    v_perm_b32 v53, v28, v28, v17
    v_perm_b32 v54, v29, v29, v16
    v_perm_b32 v55, v29, v29, v17
    v_add_f32 v144, v44, v45
    buffer_load_dwordx4 v1, s[8:11], s47 offen offset:2048 sc1 lds
    v_add_f32 v46, v46, v47
    v_mfma_f32_16x16x32_bf16 v[146:149], v[114:117], v[52:55], 0
    v_add_f32 v144, v144, v46
    v_cvt_pk_bf16_f32 v36, v48, v49
    v_cvt_pk_bf16_f32 v37, v50, v51
    v_perm_b32 v56, v36, v36, v16
    buffer_load_dwordx4 v1, s[8:11], s47 offen offset:3072 sc1 lds
    v_perm_b32 v57, v36, v36, v17
    v_perm_b32 v58, v37, v37, v16
    v_perm_b32 v59, v37, v37, v17
    v_add_f32 v145, v48, v49
    v_add_f32 v50, v50, v51
    s_add_u32 m0, s45, 32768
    v_mfma_f32_16x16x32_bf16 v[150:153], v[116:119], v[56:59], 0
    v_add_f32 v145, v145, v50
    s_nop 1
    v_permlane16_swap_b32 v144, v145
    v_add_f32 v144, v144, v145
    v_mov_b32 v145, v144
    s_add_u32 s47, s44, 0x208000
    s_nop 0
    v_permlane32_swap_b32 v144, v145
    v_add_f32 v144, v144, v145
    v_rcp_f32 v144, v144
    s_nop 0
    v_mov_b32 v145, v144
    s_nop 1
    v_permlane16_swap_b32 v144, v145
    buffer_load_dwordx4 v1, s[8:11], s47 offen offset:0 sc1 lds
    v_pk_mul_f32 v[146:147], v[146:147], v[144:145] op_sel:[0,0] op_sel_hi:[1,0]
    v_pk_mul_f32 v[148:149], v[148:149], v[144:145] op_sel:[0,0] op_sel_hi:[1,0]
    v_pk_mul_f32 v[150:151], v[150:151], v[144:145] op_sel:[0,1] op_sel_hi:[1,1]
    v_pk_mul_f32 v[152:153], v[152:153], v[144:145] op_sel:[0,1] op_sel_hi:[1,1]
    v_cvt_pk_bf16_f32 v154, v146, v147
    v_cvt_pk_bf16_f32 v155, v148, v149
    v_cvt_pk_bf16_f32 v156, v150, v151
    v_cvt_pk_bf16_f32 v157, v152, v153
    s_nop 0
    v_permlane16_swap_b32 v154, v156
    v_permlane16_swap_b32 v155, v157
    buffer_store_dwordx4 v[154:157], v1, s[8:11], s38 offen sc1
    v_add_u32 v8, 98304, v1
    s_lshr_b32 s30, s3, 1
    s_lshl_b32 s31, s18, 1
    s_add_u32 s30, s30, s31
    s_lshl_b32 s30, s30, 15
    s_and_b32 s31, s3, 1
    s_lshl_b32 s31, s31, 8
    s_add_u32 s30, s30, s31
    s_add_u32 s31, s30, 0x1000000
    s_lshl_b32 s32, s19, 12
    s_add_u32 s30, s30, s32
    s_add_u32 s32, s30, 0xe00000
    s_add_u32 s33, s30, 0x1200000
    s_lshl_b32 s34, s18, 8
    s_add_u32 s35, s34, 0x2306000
    s_add_u32 s34, s34, 0x2302000
    s_lshl_b32 s36, s18, 2
    s_add_u32 s36, s36, s3
    s_lshl_b32 s36, s36, 10
    s_lshl_b32 s37, s19, 7
    s_add_u32 s36, s36, s37
    s_add_u32 s36, s36, 0x22a0000
    v_bfe_u32 v9, v0, 4, 1
    v_lshlrev_b32 v9, 2, v9
    v_and_b32 v10, 15, v0
    v_lshl_add_u32 v9, v10, 3, v9
    buffer_load_dwordx4 v[92:95], v7, s[8:11], s32 offen sc1
    buffer_load_dwordx4 v[96:99], v7, s[8:11], s32 offen offset:2048 sc1
    s_cmp_lg_u32 s3, 0
    s_cbranch_scc1 L_ap23
    s_load_dword s64, s[4:5], s34 glc
L_ap23:
    buffer_load_dwordx4 v1, s[8:11], s47 offen offset:1024 sc1 lds
    buffer_load_dwordx4 v1, s[8:11], s47 offen offset:2048 sc1 lds
    buffer_load_dwordx4 v1, s[8:11], s47 offen offset:3072 sc1 lds
    s_add_u32 m0, s45, 36864
    s_add_u32 s47, s44, 0x209000
    buffer_load_dwordx4 v1, s[8:11], s47 offen offset:0 sc1 lds
    s_waitcnt lgkmcnt(0)
    s_cmp_lg_u32 s3, 0
    s_cbranch_scc1 L_pw_done24
    s_mov_b32 s57, 100000
    s_waitcnt lgkmcnt(0)
    s_cmp_eq_u32 s64, 32
    s_cbranch_scc1 L_pw_done24
L_pw24:
    s_load_dword s64, s[4:5], s34 glc
    s_sub_u32 s57, s57, 1
    s_cbranch_scc1 L_pw_done24
    s_waitcnt lgkmcnt(0)
    s_cmp_lg_u32 s64, 32
    s_cbranch_scc1 L_pw24
L_pw_done24:
    s_barrier
    s_mov_b32 s67, s31
    buffer_load_dwordx4 v[28:31], v7, s[8:11], s31 offen offset:0 sc1
    buffer_load_dwordx4 v[32:35], v7, s[8:11], s31 offen offset:2048 sc1
    s_add_u32 s31, s31, 4096
    buffer_load_dwordx4 v[36:39], v7, s[8:11], s31 offen offset:0 sc1
    buffer_load_dwordx4 v[40:43], v7, s[8:11], s31 offen offset:2048 sc1
    s_add_u32 s31, s31, 4096
    buffer_load_dwordx4 v[44:47], v7, s[8:11], s31 offen offset:0 sc1
    buffer_load_dwordx4 v[48:51], v7, s[8:11], s31 offen offset:2048 sc1
    s_add_u32 s31, s31, 4096
    buffer_load_dwordx4 v[52:55], v7, s[8:11], s31 offen offset:0 sc1
    buffer_load_dwordx4 v[56:59], v7, s[8:11], s31 offen offset:2048 sc1
    s_add_u32 s31, s31, 4096
    buffer_load_dwordx4 v[60:63], v7, s[8:11], s31 offen offset:0 sc1
    buffer_load_dwordx4 v[64:67], v7, s[8:11], s31 offen offset:2048 sc1
    s_waitcnt vmcnt(15)
    v_lshlrev_b32 v100, 16, v92
    v_and_b32 v101, 0xffff0000, v92
    v_lshlrev_b32 v102, 16, v93
    v_and_b32 v103, 0xffff0000, v93
    v_lshlrev_b32 v104, 16, v94
    v_and_b32 v105, 0xffff0000, v94
    v_lshlrev_b32 v106, 16, v95
    v_and_b32 v107, 0xffff0000, v95
    s_waitcnt vmcnt(14)
    v_lshlrev_b32 v108, 16, v96
    v_and_b32 v109, 0xffff0000, v96
    v_lshlrev_b32 v110, 16, v97
    v_and_b32 v111, 0xffff0000, v97
    v_lshlrev_b32 v112, 16, v98
    v_and_b32 v113, 0xffff0000, v98
    v_lshlrev_b32 v114, 16, v99
    v_and_b32 v115, 0xffff0000, v99
    ds_read_b128 v[116:119], v8 offset:0
    ds_read_b128 v[120:123], v8 offset:1024
    ds_read_b128 v[124:127], v8 offset:2048
    ds_read_b128 v[128:131], v8 offset:3072
    ds_read_b128 v[132:135], v8 offset:4096
    ds_read_b128 v[136:139], v8 offset:5120
    s_waitcnt lgkmcnt(4)
    s_waitcnt vmcnt(9)
    v_cmp_eq_u32 vcc, -1, v28
    s_cbranch_vccnz L_fix25
L_back25:
    v_mfma_f32_16x16x32_bf16 v[100:103], v[116:119], v[28:31], v[100:103]
    ds_read_b128 v[140:143], v8 offset:6144
    s_add_u32 s31, s31, 4096
    buffer_load_dwordx4 v[68:71], v7, s[8:11], s31 offen offset:0 sc1
    v_mfma_f32_16x16x32_bf16 v[104:107], v[120:123], v[28:31], v[104:107]
    ds_read_b128 v[144:147], v8 offset:7168
    s_waitcnt lgkmcnt(5)
    v_mfma_f32_16x16x32_bf16 v[108:111], v[124:127], v[28:31], v[108:111]
    ds_read_b128 v[116:119], v8 offset:8192
    s_waitcnt vmcnt(9)
    v_cmp_eq_u32 vcc, -1, v32
    s_waitcnt lgkmcnt(5)
    v_mfma_f32_16x16x32_bf16 v[112:115], v[128:131], v[28:31], v[112:115]
    s_cbranch_vccnz L_fix26
L_back26:
    ds_read_b128 v[120:123], v8 offset:9216
    s_waitcnt lgkmcnt(5)
    v_mfma_f32_16x16x32_bf16 v[100:103], v[132:135], v[32:35], v[100:103]
    ds_read_b128 v[124:127], v8 offset:10240
    buffer_load_dwordx4 v[72:75], v7, s[8:11], s31 offen offset:2048 sc1
    s_waitcnt lgkmcnt(5)
    v_mfma_f32_16x16x32_bf16 v[104:107], v[136:139], v[32:35], v[104:107]
    ds_read_b128 v[128:131], v8 offset:11264
    s_waitcnt lgkmcnt(5)
    v_mfma_f32_16x16x32_bf16 v[108:111], v[140:143], v[32:35], v[108:111]
    ds_read_b128 v[132:135], v8 offset:12288
    s_waitcnt vmcnt(9)
    v_cmp_eq_u32 vcc, -1, v36
    s_waitcnt lgkmcnt(5)
    v_mfma_f32_16x16x32_bf16 v[112:115], v[144:147], v[32:35], v[112:115]
    s_cbranch_vccnz L_fix27
L_back27:
    ds_read_b128 v[136:139], v8 offset:13312
    s_waitcnt lgkmcnt(5)
    v_mfma_f32_16x16x32_bf16 v[100:103], v[116:119], v[36:39], v[100:103]
    ds_read_b128 v[140:143], v8 offset:14336
    s_add_u32 s31, s31, 4096
    buffer_load_dwordx4 v[76:79], v7, s[8:11], s31 offen offset:0 sc1
    s_waitcnt lgkmcnt(5)
    v_mfma_f32_16x16x32_bf16 v[104:107], v[120:123], v[36:39], v[104:107]
    ds_read_b128 v[144:147], v8 offset:15360
    s_waitcnt lgkmcnt(5)
    v_mfma_f32_16x16x32_bf16 v[108:111], v[124:127], v[36:39], v[108:111]
    ds_read_b128 v[116:119], v8 offset:16384
    s_waitcnt vmcnt(9)
    v_cmp_eq_u32 vcc, -1, v40
    s_waitcnt lgkmcnt(5)
    v_mfma_f32_16x16x32_bf16 v[112:115], v[128:131], v[36:39], v[112:115]
    s_cbranch_vccnz L_fix28
L_back28:
    ds_read_b128 v[120:123], v8 offset:17408
    s_waitcnt lgkmcnt(5)
    v_mfma_f32_16x16x32_bf16 v[100:103], v[132:135], v[40:43], v[100:103]
    ds_read_b128 v[124:127], v8 offset:18432
    buffer_load_dwordx4 v[80:83], v7, s[8:11], s31 offen offset:2048 sc1
    s_waitcnt lgkmcnt(5)
    v_mfma_f32_16x16x32_bf16 v[104:107], v[136:139], v[40:43], v[104:107]
    ds_read_b128 v[128:131], v8 offset:19456
    s_waitcnt lgkmcnt(5)
    v_mfma_f32_16x16x32_bf16 v[108:111], v[140:143], v[40:43], v[108:111]
    ds_read_b128 v[132:135], v8 offset:20480
    s_waitcnt vmcnt(9)
    v_cmp_eq_u32 vcc, -1, v44
    s_waitcnt lgkmcnt(5)
    v_mfma_f32_16x16x32_bf16 v[112:115], v[144:147], v[40:43], v[112:115]
    s_cbranch_vccnz L_fix29
L_back29:
    ds_read_b128 v[136:139], v8 offset:21504
    s_waitcnt lgkmcnt(4)
    v_mfma_f32_16x16x32_bf16 v[100:103], v[116:119], v[44:47], v[100:103]
    ds_read_b128 v[140:143], v8 offset:22528
    s_add_u32 s31, s31, 4096
    buffer_load_dwordx4 v[84:87], v7, s[8:11], s31 offen offset:0 sc1
    v_mfma_f32_16x16x32_bf16 v[104:107], v[120:123], v[44:47], v[104:107]
    ds_read_b128 v[144:147], v8 offset:23552
    s_waitcnt lgkmcnt(4)
    v_mfma_f32_16x16x32_bf16 v[108:111], v[124:127], v[44:47], v[108:111]
    ds_read_b128 v[116:119], v8 offset:24576
    s_waitcnt vmcnt(9)
    v_cmp_eq_u32 vcc, -1, v48
    v_mfma_f32_16x16x32_bf16 v[112:115], v[128:131], v[44:47], v[112:115]
    s_cbranch_vccnz L_fix30
L_back30:
    ds_read_b128 v[120:123], v8 offset:25600
    s_waitcnt lgkmcnt(4)
    v_mfma_f32_16x16x32_bf16 v[100:103], v[132:135], v[48:51], v[100:103]
    v_mov_b32 v3, 1
    buffer_load_dwordx4 v[88:91], v7, s[8:11], s31 offen offset:2048 sc1
    s_mov_b64 exec, 1
    buffer_atomic_add v3, off, s[8:11], s35 sc1
    s_mov_b64 exec, -1
    ds_read_b128 v[124:127], v8 offset:26624
    v_mfma_f32_16x16x32_bf16 v[104:107], v[136:139], v[48:51], v[104:107]
    ds_read_b128 v[128:131], v8 offset:27648
    s_waitcnt lgkmcnt(4)
    v_mfma_f32_16x16x32_bf16 v[108:111], v[140:143], v[48:51], v[108:111]
    ds_read_b128 v[132:135], v8 offset:28672
    s_waitcnt vmcnt(10)
    v_cmp_eq_u32 vcc, -1, v52
    v_mfma_f32_16x16x32_bf16 v[112:115], v[144:147], v[48:51], v[112:115]
    s_cbranch_vccnz L_fix31
L_back31:
    ds_read_b128 v[136:139], v8 offset:29696
    s_waitcnt lgkmcnt(4)
    v_mfma_f32_16x16x32_bf16 v[100:103], v[116:119], v[52:55], v[100:103]
    ds_read_b128 v[140:143], v8 offset:30720
    v_mfma_f32_16x16x32_bf16 v[104:107], v[120:123], v[52:55], v[104:107]
    ds_read_b128 v[144:147], v8 offset:31744
    s_waitcnt lgkmcnt(4)
    v_mfma_f32_16x16x32_bf16 v[108:111], v[124:127], v[52:55], v[108:111]
    ds_read_b128 v[116:119], v8 offset:32768
    s_waitcnt vmcnt(9)
    v_cmp_eq_u32 vcc, -1, v56
    buffer_load_dwordx4 v1, s[8:11], s47 offen offset:1024 sc1 lds
    v_mfma_f32_16x16x32_bf16 v[112:115], v[128:131], v[52:55], v[112:115]
    s_cbranch_vccnz L_fix32
L_back32:
    ds_read_b128 v[120:123], v8 offset:33792
    s_waitcnt lgkmcnt(4)
    v_mfma_f32_16x16x32_bf16 v[100:103], v[132:135], v[56:59], v[100:103]
    ds_read_b128 v[124:127], v8 offset:34816
    v_mfma_f32_16x16x32_bf16 v[104:107], v[136:139], v[56:59], v[104:107]
    ds_read_b128 v[128:131], v8 offset:35840
    buffer_load_dwordx4 v1, s[8:11], s47 offen offset:2048 sc1 lds
    s_waitcnt lgkmcnt(4)
    v_mfma_f32_16x16x32_bf16 v[108:111], v[140:143], v[56:59], v[108:111]
    ds_read_b128 v[132:135], v8 offset:36864
    s_waitcnt vmcnt(10)
    v_cmp_eq_u32 vcc, -1, v60
    v_mfma_f32_16x16x32_bf16 v[112:115], v[144:147], v[56:59], v[112:115]
    s_cbranch_vccnz L_fix33
L_back33:
    ds_read_b128 v[136:139], v8 offset:37888
    s_waitcnt lgkmcnt(4)
    v_mfma_f32_16x16x32_bf16 v[100:103], v[116:119], v[60:63], v[100:103]
    ds_read_b128 v[140:143], v8 offset:38912
    v_mfma_f32_16x16x32_bf16 v[104:107], v[120:123], v[60:63], v[104:107]
    ds_read_b128 v[144:147], v8 offset:39936
    buffer_load_dwordx4 v1, s[8:11], s47 offen offset:3072 sc1 lds
    s_waitcnt lgkmcnt(4)
    v_mfma_f32_16x16x32_bf16 v[108:111], v[124:127], v[60:63], v[108:111]
    ds_read_b128 v[116:119], v8 offset:40960
    s_waitcnt vmcnt(10)
    v_cmp_eq_u32 vcc, -1, v64
    v_mfma_f32_16x16x32_bf16 v[112:115], v[128:131], v[60:63], v[112:115]
    s_cbranch_vccnz L_fix34
L_back34:
    ds_read_b128 v[120:123], v8 offset:41984
    s_waitcnt lgkmcnt(4)
    v_mfma_f32_16x16x32_bf16 v[100:103], v[132:135], v[64:67], v[100:103]
    ds_read_b128 v[124:127], v8 offset:43008
    s_add_u32 m0, s45, 65536
    s_add_u32 s47, s44, 0x210000
    buffer_load_dwordx4 v1, s[8:11], s47 offen offset:0 sc1 lds
    v_mfma_f32_16x16x32_bf16 v[104:107], v[136:139], v[64:67], v[104:107]
    ds_read_b128 v[128:131], v8 offset:44032
    s_waitcnt lgkmcnt(4)
    v_mfma_f32_16x16x32_bf16 v[108:111], v[140:143], v[64:67], v[108:111]
    ds_read_b128 v[132:135], v8 offset:45056
    s_waitcnt vmcnt(10)
    v_cmp_eq_u32 vcc, -1, v68
    v_mfma_f32_16x16x32_bf16 v[112:115], v[144:147], v[64:67], v[112:115]
    s_cbranch_vccnz L_fix35
L_back35:
    ds_read_b128 v[136:139], v8 offset:46080
    buffer_load_dwordx4 v1, s[8:11], s47 offen offset:1024 sc1 lds
    s_waitcnt lgkmcnt(4)
    v_mfma_f32_16x16x32_bf16 v[100:103], v[116:119], v[68:71], v[100:103]
    ds_read_b128 v[140:143], v8 offset:47104
    v_mfma_f32_16x16x32_bf16 v[104:107], v[120:123], v[68:71], v[104:107]
    ds_read_b128 v[144:147], v8 offset:48128
    s_waitcnt lgkmcnt(4)
    v_mfma_f32_16x16x32_bf16 v[108:111], v[124:127], v[68:71], v[108:111]
    ds_read_b128 v[116:119], v8 offset:49152
    s_waitcnt vmcnt(10)
    v_cmp_eq_u32 vcc, -1, v72
    buffer_load_dwordx4 v1, s[8:11], s47 offen offset:2048 sc1 lds
    v_mfma_f32_16x16x32_bf16 v[112:115], v[128:131], v[68:71], v[112:115]
    s_cbranch_vccnz L_fix36
L_back36:
    ds_read_b128 v[120:123], v8 offset:50176
    s_waitcnt lgkmcnt(4)
    v_mfma_f32_16x16x32_bf16 v[100:103], v[132:135], v[72:75], v[100:103]
    ds_read_b128 v[124:127], v8 offset:51200
    v_mfma_f32_16x16x32_bf16 v[104:107], v[136:139], v[72:75], v[104:107]
    ds_read_b128 v[128:131], v8 offset:52224
    s_waitcnt lgkmcnt(4)
    v_mfma_f32_16x16x32_bf16 v[108:111], v[140:143], v[72:75], v[108:111]
    ds_read_b128 v[132:135], v8 offset:53248
    s_waitcnt vmcnt(10)
    v_cmp_eq_u32 vcc, -1, v76
    buffer_load_dwordx4 v1, s[8:11], s47 offen offset:3072 sc1 lds
    v_mfma_f32_16x16x32_bf16 v[112:115], v[144:147], v[72:75], v[112:115]
    s_cbranch_vccnz L_fix37
L_back37:
    ds_read_b128 v[136:139], v8 offset:54272
    s_waitcnt lgkmcnt(4)
    v_mfma_f32_16x16x32_bf16 v[100:103], v[116:119], v[76:79], v[100:103]
    ds_read_b128 v[140:143], v8 offset:55296
    v_mfma_f32_16x16x32_bf16 v[104:107], v[120:123], v[76:79], v[104:107]
    ds_read_b128 v[144:147], v8 offset:56320
    s_add_u32 m0, s45, 69632
    s_add_u32 s47, s44, 0x211000
    buffer_load_dwordx4 v1, s[8:11], s47 offen offset:0 sc1 lds
    s_waitcnt lgkmcnt(4)
    v_mfma_f32_16x16x32_bf16 v[108:111], v[124:127], v[76:79], v[108:111]
    ds_read_b128 v[116:119], v8 offset:57344
    s_waitcnt vmcnt(11)
    v_cmp_eq_u32 vcc, -1, v80
    v_mfma_f32_16x16x32_bf16 v[112:115], v[128:131], v[76:79], v[112:115]
    s_cbranch_vccnz L_fix38
L_back38:
    ds_read_b128 v[120:123], v8 offset:58368
    s_waitcnt lgkmcnt(4)
    v_mfma_f32_16x16x32_bf16 v[100:103], v[132:135], v[80:83], v[100:103]
    ds_read_b128 v[124:127], v8 offset:59392
    buffer_load_dwordx4 v1, s[8:11], s47 offen offset:1024 sc1 lds
    v_mfma_f32_16x16x32_bf16 v[104:107], v[136:139], v[80:83], v[104:107]
    ds_read_b128 v[128:131], v8 offset:60416
    s_waitcnt lgkmcnt(4)
    v_mfma_f32_16x16x32_bf16 v[108:111], v[140:143], v[80:83], v[108:111]
    ds_read_b128 v[132:135], v8 offset:61440
    s_waitcnt vmcnt(11)
    v_cmp_eq_u32 vcc, -1, v84
    v_mfma_f32_16x16x32_bf16 v[112:115], v[144:147], v[80:83], v[112:115]
    s_cbranch_vccnz L_fix39
L_back39:
    ds_read_b128 v[136:139], v8 offset:62464
    buffer_load_dwordx4 v1, s[8:11], s47 offen offset:2048 sc1 lds
    s_waitcnt lgkmcnt(4)
    v_mfma_f32_16x16x32_bf16 v[100:103], v[116:119], v[84:87], v[100:103]
    ds_read_b128 v[140:143], v8 offset:63488
    v_mfma_f32_16x16x32_bf16 v[104:107], v[120:123], v[84:87], v[104:107]
    ds_read_b128 v[144:147], v8 offset:64512
    s_waitcnt lgkmcnt(4)
    v_mfma_f32_16x16x32_bf16 v[108:111], v[124:127], v[84:87], v[108:111]
    s_waitcnt vmcnt(11)
    v_cmp_eq_u32 vcc, -1, v88
    v_mfma_f32_16x16x32_bf16 v[112:115], v[128:131], v[84:87], v[112:115]
    s_cbranch_vccnz L_fix40
L_back40:
    buffer_load_dwordx4 v1, s[8:11], s47 offen offset:3072 sc1 lds
    s_waitcnt lgkmcnt(2)
    v_mfma_f32_16x16x32_bf16 v[100:103], v[132:135], v[88:91], v[100:103]
    v_mfma_f32_16x16x32_bf16 v[104:107], v[136:139], v[88:91], v[104:107]
    s_waitcnt lgkmcnt(0)
    v_mfma_f32_16x16x32_bf16 v[108:111], v[140:143], v[88:91], v[108:111]
    v_mfma_f32_16x16x32_bf16 v[112:115], v[144:147], v[88:91], v[112:115]
    s_nop 3
    v_cvt_pk_bf16_f32 v148, v100, v101
    v_cvt_pk_bf16_f32 v149, v102, v103
    v_cvt_pk_bf16_f32 v150, v104, v105
    v_cvt_pk_bf16_f32 v151, v106, v107
    buffer_store_dwordx4 v[148:151], v7, s[8:11], s33 offen offset:0 sc1
    v_cvt_pk_bf16_f32 v152, v108, v109
    v_cvt_pk_bf16_f32 v153, v110, v111
    v_cvt_pk_bf16_f32 v154, v112, v113
    v_cvt_pk_bf16_f32 v155, v114, v115
    buffer_store_dwordx4 v[152:155], v7, s[8:11], s33 offen offset:2048 sc1
    v_mov_b32 v156, 0
    v_mov_b32 v157, 0
    v_dot2_f32_bf16 v156, v148, s25, v156
    v_dot2_f32_bf16 v157, v148, v148, v157
    v_dot2_f32_bf16 v156, v149, s25, v156
    v_dot2_f32_bf16 v157, v149, v149, v157
    v_dot2_f32_bf16 v156, v150, s25, v156
    v_dot2_f32_bf16 v157, v150, v150, v157
    v_dot2_f32_bf16 v156, v151, s25, v156
    v_dot2_f32_bf16 v157, v151, v151, v157
    v_dot2_f32_bf16 v156, v152, s25, v156
    v_dot2_f32_bf16 v157, v152, v152, v157
    v_dot2_f32_bf16 v156, v153, s25, v156
    v_dot2_f32_bf16 v157, v153, v153, v157
    v_dot2_f32_bf16 v156, v154, s25, v156
    v_dot2_f32_bf16 v157, v154, v154, v157
    v_dot2_f32_bf16 v156, v155, s25, v156
    v_dot2_f32_bf16 v157, v155, v155, v157
    s_nop 2
    v_permlane16_swap_b32 v156, v157
    v_add_f32 v156, v156, v157
    v_mov_b32 v157, v156
    s_nop 1
    v_permlane32_swap_b32 v156, v157
    v_add_f32 v156, v156, v157
    v_mov_b32 v3, 1
    buffer_store_dword v156, v9, s[8:11], s36 offen sc1
    s_barrier
    s_lshl_b32 s34, s20, 9
    s_add_u32 s34, s34, 0x2306000
    s_lshl_b32 s48, s21, 11
    s_add_u32 s48, s48, 0x760000
    buffer_load_dwordx4 v[124:127], v1, s[8:11], s48 offen offset:0 sc1
    buffer_load_dwordx4 v[76:79], v1, s[8:11], s48 offen offset:1024 sc1
    s_mul_i32 s44, s21, 229376
    s_lshl_b32 s45, s3, 13
    s_add_u32 s44, s44, s45
    s_add_u32 m0, s45, 98304
    s_add_u32 s47, s44, 0x218000
    buffer_load_dwordx4 v1, s[8:11], s47 offen offset:0 sc1 lds
    buffer_load_dwordx4 v1, s[8:11], s47 offen offset:1024 sc1 lds
    s_cmp_lg_u32 s3, 0
    s_cbranch_scc1 L_ap42
    s_add_u32 s66, s34, 256
    s_load_dword s64, s[4:5], s34 glc
    s_load_dword s65, s[4:5], s66 glc
L_ap42:
    buffer_load_dwordx4 v1, s[8:11], s47 offen offset:2048 sc1 lds
    buffer_load_dwordx4 v1, s[8:11], s47 offen offset:3072 sc1 lds
    s_add_u32 m0, s45, 102400
    s_add_u32 s47, s44, 0x219000
    buffer_load_dwordx4 v1, s[8:11], s47 offen offset:0 sc1 lds
    buffer_load_dwordx4 v1, s[8:11], s47 offen offset:1024 sc1 lds
    buffer_load_dwordx4 v1, s[8:11], s47 offen offset:2048 sc1 lds
    buffer_load_dwordx4 v1, s[8:11], s47 offen offset:3072 sc1 lds
    v_and_b32 v4, 31, v0
    v_lshrrev_b32 v5, 5, v0
    v_lshrrev_b32 v6, 4, v4
    v_lshlrev_b32 v6, 10, v6
    v_lshl_add_u32 v6, v5, 9, v6
    v_and_b32 v7, 15, v4
    v_lshl_add_u32 v6, v7, 3, v6
    v_add_u32 v8, 65536, v1
    v_add_u32 v9, 0x20000, v1
    v_lshlrev_b32 v10, 8, v0
    s_lshl_b32 s30, s20, 2
    s_add_u32 s30, s30, s3
    s_lshl_b32 s31, s30, 15
    s_add_u32 s31, s31, 0x1200000
    s_lshl_b32 s32, s30, 11
    s_add_u32 s32, s32, 0x22a0000
    s_mul_i32 s33, s30, 114688
    s_mul_i32 s35, s21, 7168
    s_add_u32 s33, s33, s35
    s_add_u32 s33, s33, 0x1b00000
    s_lshl_b32 s35, s20, 3
    s_lshr_b32 s36, s3, 1
    s_lshl_b32 s36, s36, 2
    s_add_u32 s35, s35, s36
    s_lshr_b32 s36, s21, 2
    s_add_u32 s35, s35, s36
    s_lshl_b32 s35, s35, 8
    s_add_u32 s78, s78, 0x700000
    s_add_u32 s79, s79, 0x700000
    s_add_u32 s80, s78, 4096
    s_add_u32 s81, s79, 4096
    s_add_u32 s85, s84, 0x1200000
    v_add_u32 v15, 7168, v1
    v_add_u32 v7, 14336, v1
    v_add_u32 v10, 21504, v1
    s_lshl_b32 s36, s22, 2
    s_add_u32 s36, s36, s3
    s_lshl_b32 s36, s36, 8
    s_waitcnt vmcnt(13)
    s_cmp_lg_u32 s3, 0
    s_cbranch_scc1 L_pw_done43
    s_mov_b32 s57, 100000
    s_add_u32 s66, s34, 256
    s_waitcnt lgkmcnt(0)
    s_min_u32 s64, s64, s65
    s_cmp_eq_u32 s64, 32
    s_cbranch_scc1 L_pw_done43
L_pw43:
    s_load_dword s64, s[4:5], s34 glc
    s_load_dword s65, s[4:5], s66 glc
    s_sub_u32 s57, s57, 1
L_pad36096:
    s_cbranch_execz L_ret_p3s0
    s_cbranch_scc1 L_pw_done43
    s_waitcnt lgkmcnt(0)
    s_min_u32 s64, s64, s65
    s_cmp_lg_u32 s64, 32
    s_cbranch_scc1 L_pw43
L_pw_done43:
    s_barrier
    s_mov_b32 s67, s31
    buffer_load_dwordx4 v[128:131], v1, s[8:11], s31 offen offset:0 sc1
    buffer_load_dwordx4 v[132:135], v1, s[8:11], s31 offen offset:1024 sc1
    buffer_load_dwordx4 v[136:139], v1, s[8:11], s31 offen offset:2048 sc1
    buffer_load_dwordx4 v[140:143], v1, s[8:11], s31 offen offset:3072 sc1
    s_add_u32 s31, s31, 4096
    buffer_load_dwordx4 v[144:147], v1, s[8:11], s31 offen offset:0 sc1
    buffer_load_dwordx4 v[148:151], v1, s[8:11], s31 offen offset:1024 sc1
    buffer_load_dwordx4 v[152:155], v1, s[8:11], s31 offen offset:2048 sc1
    buffer_load_dwordx4 v[156:159], v1, s[8:11], s31 offen offset:3072 sc1
    s_add_u32 s31, s31, 4096
    buffer_load_dwordx4 v[160:163], v1, s[8:11], s31 offen offset:0 sc1
    buffer_load_dwordx4 v[164:167], v1, s[8:11], s31 offen offset:1024 sc1
    buffer_load_dwordx4 v[168:171], v1, s[8:11], s31 offen offset:2048 sc1
    buffer_load_dwordx4 v[172:175], v1, s[8:11], s31 offen offset:3072 sc1
    s_add_u32 s31, s31, 4096
    buffer_load_dwordx4 v[176:179], v1, s[8:11], s31 offen offset:0 sc1
    ds_read_b128 v[80:83], v1 offset:0
    ds_read_b128 v[84:87], v1 offset:32768
    ds_read_b128 v[88:91], v1 offset:1024
    ds_read_b128 v[92:95], v1 offset:33792
    ds_read_b128 v[96:99], v1 offset:2048
    ds_read_b128 v[100:103], v1 offset:34816
    ds_read_b128 v[104:107], v1 offset:3072
    s_waitcnt lgkmcnt(5)
    s_waitcnt vmcnt(12)
    v_cmp_eq_u32 vcc, -1, v128
    s_cbranch_vccnz L_fix44
L_back44:
    v_mfma_f32_32x32x16_bf16 v[16:31], v[80:83], v[128:131], 0
    ds_read_b128 v[108:111], v1 offset:35840
    s_waitcnt vmcnt(11)
    v_cmp_eq_u32 vcc, -1, v132
    buffer_load_dwordx4 v[180:183], v1, s[8:11], s31 offen offset:1024 sc1
    v_mfma_f32_32x32x16_bf16 v[32:47], v[84:87], v[128:131], 0
    s_cbranch_vccnz L_fix45
L_back45:
    ds_read_b128 v[80:83], v1 offset:4096
    s_waitcnt lgkmcnt(5)
    v_mfma_f32_32x32x16_bf16 v[16:31], v[88:91], v[132:135], v[16:31]
    ds_read_b128 v[84:87], v1 offset:36864
    s_waitcnt vmcnt(11)
    v_cmp_eq_u32 vcc, -1, v136
    buffer_load_dwordx4 v[184:187], v1, s[8:11], s31 offen offset:2048 sc1
    v_mfma_f32_32x32x16_bf16 v[32:47], v[92:95], v[132:135], v[32:47]
    s_cbranch_vccnz L_fix46
L_back46:
    ds_read_b128 v[88:91], v1 offset:5120
    s_waitcnt lgkmcnt(5)
    v_mfma_f32_32x32x16_bf16 v[16:31], v[96:99], v[136:139], v[16:31]
    ds_read_b128 v[92:95], v1 offset:37888
    s_waitcnt vmcnt(11)
    v_cmp_eq_u32 vcc, -1, v140
    buffer_load_dwordx4 v[188:191], v1, s[8:11], s31 offen offset:3072 sc1
    s_add_u32 s31, s31, 4096
    v_mfma_f32_32x32x16_bf16 v[32:47], v[100:103], v[136:139], v[32:47]
    s_cbranch_vccnz L_fix47
L_back47:
    ds_read_b128 v[96:99], v1 offset:6144
    buffer_load_dwordx4 v[192:195], v1, s[8:11], s31 offen offset:0 sc1
    s_waitcnt lgkmcnt(5)
    v_mfma_f32_32x32x16_bf16 v[16:31], v[104:107], v[140:143], v[16:31]
    ds_read_b128 v[100:103], v1 offset:38912
    s_waitcnt vmcnt(12)
    v_cmp_eq_u32 vcc, -1, v144
    v_mfma_f32_32x32x16_bf16 v[32:47], v[108:111], v[140:143], v[32:47]
    s_cbranch_vccnz L_fix48
L_back48:
    ds_read_b128 v[104:107], v1 offset:7168
    buffer_load_dwordx4 v[196:199], v1, s[8:11], s31 offen offset:1024 sc1
    s_waitcnt lgkmcnt(5)
    v_mfma_f32_32x32x16_bf16 v[16:31], v[80:83], v[144:147], v[16:31]
    ds_read_b128 v[108:111], v1 offset:39936
    s_waitcnt vmcnt(12)
    v_cmp_eq_u32 vcc, -1, v148
    v_mfma_f32_32x32x16_bf16 v[32:47], v[84:87], v[144:147], v[32:47]
    s_cbranch_vccnz L_fix49
L_back49:
    ds_read_b128 v[80:83], v1 offset:8192
    buffer_load_dwordx4 v[200:203], v1, s[8:11], s31 offen offset:2048 sc1
    s_waitcnt lgkmcnt(5)
    v_mfma_f32_32x32x16_bf16 v[16:31], v[88:91], v[148:151], v[16:31]
    ds_read_b128 v[84:87], v1 offset:40960
    s_waitcnt vmcnt(12)
    v_cmp_eq_u32 vcc, -1, v152
    buffer_load_dwordx4 v[204:207], v1, s[8:11], s31 offen offset:3072 sc1
    v_mfma_f32_32x32x16_bf16 v[32:47], v[92:95], v[148:151], v[32:47]
    s_cbranch_vccnz L_fix50
L_back50:
    ds_read_b128 v[88:91], v1 offset:9216
    s_add_u32 s31, s31, 4096
    s_waitcnt lgkmcnt(5)
    v_mfma_f32_32x32x16_bf16 v[16:31], v[96:99], v[152:155], v[16:31]
    ds_read_b128 v[92:95], v1 offset:41984
    s_waitcnt vmcnt(12)
    v_cmp_eq_u32 vcc, -1, v156
    buffer_load_dwordx2 v[112:113], v6, s[8:11], s32 offen offset:0 sc1
    v_mfma_f32_32x32x16_bf16 v[32:47], v[100:103], v[152:155], v[32:47]
    s_cbranch_vccnz L_fix51
L_back51:
    ds_read_b128 v[96:99], v1 offset:10240
    s_waitcnt lgkmcnt(5)
    v_mfma_f32_32x32x16_bf16 v[16:31], v[104:107], v[156:159], v[16:31]
    ds_read_b128 v[100:103], v1 offset:43008
    s_waitcnt vmcnt(12)
    v_cmp_eq_u32 vcc, -1, v160
    buffer_load_dwordx2 v[114:115], v6, s[8:11], s32 offen offset:128 sc1
    v_mfma_f32_32x32x16_bf16 v[32:47], v[108:111], v[156:159], v[32:47]
    s_cbranch_vccnz L_fix52
L_back52:
    ds_read_b128 v[104:107], v1 offset:11264
    buffer_load_dwordx2 v[116:117], v6, s[8:11], s32 offen offset:256 sc1
    s_waitcnt lgkmcnt(5)
    v_mfma_f32_32x32x16_bf16 v[16:31], v[80:83], v[160:163], v[16:31]
    ds_read_b128 v[108:111], v1 offset:44032
    s_waitcnt vmcnt(13)
    v_cmp_eq_u32 vcc, -1, v164
    v_mfma_f32_32x32x16_bf16 v[32:47], v[84:87], v[160:163], v[32:47]
    s_cbranch_vccnz L_fix53
L_back53:
    ds_read_b128 v[80:83], v1 offset:12288
    buffer_load_dwordx2 v[118:119], v6, s[8:11], s32 offen offset:384 sc1
    s_waitcnt lgkmcnt(5)
    v_mfma_f32_32x32x16_bf16 v[16:31], v[88:91], v[164:167], v[16:31]
    ds_read_b128 v[84:87], v1 offset:45056
    s_waitcnt vmcnt(13)
    v_cmp_eq_u32 vcc, -1, v168
    buffer_load_dwordx4 v[208:211], v1, s[8:11], s31 offen offset:0 sc1
    v_mfma_f32_32x32x16_bf16 v[32:47], v[92:95], v[164:167], v[32:47]
    s_cbranch_vccnz L_fix54
L_back54:
    ds_read_b128 v[88:91], v1 offset:13312
    s_waitcnt lgkmcnt(5)
    v_mfma_f32_32x32x16_bf16 v[16:31], v[96:99], v[168:171], v[16:31]
    ds_read_b128 v[92:95], v1 offset:46080
    s_waitcnt vmcnt(13)
    v_cmp_eq_u32 vcc, -1, v172
    buffer_load_dwordx4 v[212:215], v1, s[8:11], s31 offen offset:1024 sc1
    v_mfma_f32_32x32x16_bf16 v[32:47], v[100:103], v[168:171], v[32:47]
    s_cbranch_vccnz L_fix55
L_back55:
    ds_read_b128 v[96:99], v1 offset:14336
    s_waitcnt lgkmcnt(5)
    v_mfma_f32_32x32x16_bf16 v[16:31], v[104:107], v[172:175], v[16:31]
    ds_read_b128 v[100:103], v1 offset:47104
    s_waitcnt vmcnt(13)
    v_cmp_eq_u32 vcc, -1, v176
    buffer_load_dwordx4 v[216:219], v1, s[8:11], s31 offen offset:2048 sc1
    v_mfma_f32_32x32x16_bf16 v[32:47], v[108:111], v[172:175], v[32:47]
    s_cbranch_vccnz L_fix56
L_back56:
    ds_read_b128 v[104:107], v1 offset:15360
    buffer_load_dwordx4 v[220:223], v1, s[8:11], s31 offen offset:3072 sc1
    s_waitcnt lgkmcnt(5)
    v_mfma_f32_32x32x16_bf16 v[16:31], v[80:83], v[176:179], v[16:31]
    ds_read_b128 v[108:111], v1 offset:48128
    s_waitcnt vmcnt(14)
    v_cmp_eq_u32 vcc, -1, v180
    s_add_u32 s31, s31, 4096
    v_mfma_f32_32x32x16_bf16 v[32:47], v[84:87], v[176:179], v[32:47]
    s_cbranch_vccnz L_fix57
L_back57:
    ds_read_b128 v[80:83], v1 offset:16384
    buffer_load_dwordx4 v[224:227], v1, s[8:11], s31 offen offset:0 sc1
    s_waitcnt lgkmcnt(5)
    v_mfma_f32_32x32x16_bf16 v[16:31], v[88:91], v[180:183], v[16:31]
    ds_read_b128 v[84:87], v1 offset:49152
    s_waitcnt vmcnt(14)
    v_cmp_eq_u32 vcc, -1, v184
    v_mfma_f32_32x32x16_bf16 v[32:47], v[92:95], v[180:183], v[32:47]
    s_cbranch_vccnz L_fix58
L_back58:
    ds_read_b128 v[88:91], v1 offset:17408
    buffer_load_dwordx4 v[228:231], v1, s[8:11], s31 offen offset:1024 sc1
    s_waitcnt lgkmcnt(5)
    v_mfma_f32_32x32x16_bf16 v[16:31], v[96:99], v[184:187], v[16:31]
    ds_read_b128 v[92:95], v1 offset:50176
    s_waitcnt vmcnt(14)
    v_cmp_eq_u32 vcc, -1, v188
    buffer_load_dwordx4 v[232:235], v1, s[8:11], s31 offen offset:2048 sc1
    v_mfma_f32_32x32x16_bf16 v[32:47], v[100:103], v[184:187], v[32:47]
    s_cbranch_vccnz L_fix59
L_back59:
    ds_read_b128 v[96:99], v1 offset:18432
    s_waitcnt lgkmcnt(5)
    v_mfma_f32_32x32x16_bf16 v[16:31], v[104:107], v[188:191], v[16:31]
    ds_read_b128 v[100:103], v1 offset:51200
    s_waitcnt vmcnt(14)
    v_cmp_eq_u32 vcc, -1, v192
    buffer_load_dwordx4 v[236:239], v1, s[8:11], s31 offen offset:3072 sc1
    v_mfma_f32_32x32x16_bf16 v[32:47], v[108:111], v[188:191], v[32:47]
    s_cbranch_vccnz L_fix60
L_back60:
    ds_read_b128 v[104:107], v1 offset:19456
    s_add_u32 s31, s31, 4096
    s_waitcnt lgkmcnt(5)
    v_mfma_f32_32x32x16_bf16 v[16:31], v[80:83], v[192:195], v[16:31]
    ds_read_b128 v[108:111], v1 offset:52224
    s_waitcnt vmcnt(14)
    v_cmp_eq_u32 vcc, -1, v196
    buffer_load_dwordx4 v[240:243], v1, s[8:11], s31 offen offset:0 sc1
    v_mfma_f32_32x32x16_bf16 v[32:47], v[84:87], v[192:195], v[32:47]
    s_cbranch_vccnz L_fix61
L_back61:
    ds_read_b128 v[80:83], v1 offset:20480
    buffer_load_dwordx4 v[244:247], v1, s[8:11], s31 offen offset:1024 sc1
    s_waitcnt lgkmcnt(5)
    v_mfma_f32_32x32x16_bf16 v[16:31], v[88:91], v[196:199], v[16:31]
    ds_read_b128 v[84:87], v1 offset:53248
    s_waitcnt vmcnt(15)
    v_cmp_eq_u32 vcc, -1, v200
    v_mfma_f32_32x32x16_bf16 v[32:47], v[92:95], v[196:199], v[32:47]
    s_cbranch_vccnz L_fix62
L_back62:
    ds_read_b128 v[88:91], v1 offset:21504
    buffer_load_dwordx4 v[248:251], v1, s[8:11], s31 offen offset:2048 sc1
    s_waitcnt lgkmcnt(5)
    v_mfma_f32_32x32x16_bf16 v[16:31], v[96:99], v[200:203], v[16:31]
    ds_read_b128 v[92:95], v1 offset:54272
    s_waitcnt vmcnt(15)
    v_cmp_eq_u32 vcc, -1, v204
    buffer_load_dwordx4 v[252:255], v1, s[8:11], s31 offen offset:3072 sc1
    v_mfma_f32_32x32x16_bf16 v[32:47], v[100:103], v[200:203], v[32:47]
    s_cbranch_vccnz L_fix63
L_back63:
    ds_read_b128 v[96:99], v1 offset:22528
    s_waitcnt lgkmcnt(5)
    v_mfma_f32_32x32x16_bf16 v[16:31], v[104:107], v[204:207], v[16:31]
    ds_read_b128 v[100:103], v1 offset:55296
    s_waitcnt vmcnt(11)
    v_cmp_eq_u32 vcc, -1, v208
    v_mfma_f32_32x32x16_bf16 v[32:47], v[108:111], v[204:207], v[32:47]
    s_cbranch_vccnz L_fix64
L_back64:
    ds_read_b128 v[104:107], v1 offset:23552
    v_max_u32 v11, v112, v113
    v_max3_u32 v11, v11, v114, v115
    v_max3_u32 v11, v11, v116, v117
    v_max3_u32 v11, v11, v118, v119
    v_cmp_eq_u32 s[6:7], -1, v11
    s_nop 0
    s_cmp_lg_u64 s[6:7], 0
    s_cbranch_scc1 L_fix76
L_back76:
    s_waitcnt lgkmcnt(5)
    v_mfma_f32_32x32x16_bf16 v[16:31], v[80:83], v[208:211], v[16:31]
    ds_read_b128 v[108:111], v1 offset:56320
    s_waitcnt vmcnt(10)
    v_cmp_eq_u32 vcc, -1, v212
    s_add_u32 m0, s45, 131072
    v_add_f32 v112, v112, v114
    v_mfma_f32_32x32x16_bf16 v[32:47], v[84:87], v[208:211], v[32:47]
    s_cbranch_vccnz L_fix65
L_back65:
    ds_read_b128 v[80:83], v1 offset:24576
    v_add_f32 v113, v113, v115
    v_add_f32 v112, v112, v116
    v_add_f32 v113, v113, v117
    s_waitcnt lgkmcnt(5)
    v_mfma_f32_32x32x16_bf16 v[16:31], v[88:91], v[212:215], v[16:31]
    ds_read_b128 v[84:87], v1 offset:57344
    s_waitcnt vmcnt(9)
    v_cmp_eq_u32 vcc, -1, v216
    v_add_f32 v112, v112, v118
    v_add_f32 v113, v113, v119
    v_mfma_f32_32x32x16_bf16 v[32:47], v[92:95], v[212:215], v[32:47]
    s_cbranch_vccnz L_fix66
L_back66:
    ds_read_b128 v[88:91], v1 offset:25600
    v_permlane32_swap_b32 v112, v113
    s_add_u32 s47, s44, 0x220000
    v_add_f32 v112, v112, v113
    s_waitcnt lgkmcnt(5)
    v_mfma_f32_32x32x16_bf16 v[16:31], v[96:99], v[216:219], v[16:31]
    ds_read_b128 v[92:95], v1 offset:58368
    s_waitcnt vmcnt(8)
    v_cmp_eq_u32 vcc, -1, v220
    v_mov_b32 v113, v112
    s_nop 1
    v_permlane32_swap_b32 v112, v113
    v_mul_f32 v112, 0xbb000000, v112
    v_mfma_f32_32x32x16_bf16 v[32:47], v[100:103], v[216:219], v[32:47]
    s_cbranch_vccnz L_fix67
L_back67:
    ds_read_b128 v[96:99], v1 offset:26624
    v_mul_f32 v114, v112, v112
    v_mov_b32 v115, 0x3b000000
    s_waitcnt lgkmcnt(5)
    v_mfma_f32_32x32x16_bf16 v[16:31], v[104:107], v[220:223], v[16:31]
    ds_read_b128 v[100:103], v1 offset:59392
    s_waitcnt vmcnt(7)
    v_cmp_eq_u32 vcc, -1, v224
    v_fma_f32 v114, v113, v115, -v114
    v_mfma_f32_32x32x16_bf16 v[32:47], v[108:111], v[220:223], v[32:47]
    s_cbranch_vccnz L_fix68
L_back68:
    ds_read_b128 v[104:107], v1 offset:27648
    buffer_load_dwordx4 v1, s[8:11], s47 offen offset:0 sc1 lds
    s_waitcnt lgkmcnt(5)
    v_mfma_f32_32x32x16_bf16 v[16:31], v[80:83], v[224:227], v[16:31]
    ds_read_b128 v[108:111], v1 offset:60416
    s_waitcnt vmcnt(7)
    v_cmp_eq_u32 vcc, -1, v228
    v_max_f32 v114, 0, v114
    v_add_f32 v114, s24, v114
    v_mov_b32 v113, v112
    v_mfma_f32_32x32x16_bf16 v[32:47], v[84:87], v[224:227], v[32:47]
    s_cbranch_vccnz L_fix69
L_back69:
    ds_read_b128 v[80:83], v1 offset:28672
    v_rsq_f32 v112, v114
    s_waitcnt lgkmcnt(5)
    v_mfma_f32_32x32x16_bf16 v[16:31], v[88:91], v[228:231], v[16:31]
    ds_read_b128 v[84:87], v1 offset:61440
    s_waitcnt vmcnt(6)
    v_cmp_eq_u32 vcc, -1, v232
    v_cvt_pk_bf16_f32 v116, v113, v113
    v_mul_f32 v114, v112, v112
    v_and_b32 v117, 0xffff0000, v116
    v_mfma_f32_32x32x16_bf16 v[32:47], v[92:95], v[228:231], v[32:47]
    s_cbranch_vccnz L_fix70
L_back70:
    ds_read_b128 v[88:91], v1 offset:29696
    buffer_load_dwordx4 v1, s[8:11], s47 offen offset:1024 sc1 lds
    s_waitcnt lgkmcnt(5)
    v_mfma_f32_32x32x16_bf16 v[16:31], v[96:99], v[232:235], v[16:31]
    ds_read_b128 v[92:95], v1 offset:62464
    s_waitcnt vmcnt(6)
    v_cmp_eq_u32 vcc, -1, v236
    v_mul_f32 v12, 0xc0135761, v112
    v_mfma_f32_32x32x16_bf16 v[32:47], v[100:103], v[232:235], v[32:47]
    s_cbranch_vccnz L_fix71
L_back71:
    ds_read_b128 v[96:99], v1 offset:30720
    v_sub_f32 v113, v113, v117
    v_mul_f32 v115, v114, v112
    s_waitcnt lgkmcnt(5)
    v_mfma_f32_32x32x16_bf16 v[16:31], v[104:107], v[236:239], v[16:31]
    ds_read_b128 v[100:103], v1 offset:63488
    s_waitcnt vmcnt(5)
    v_cmp_eq_u32 vcc, -1, v240
    v_mov_b32 v64, 0
    v_cvt_pk_bf16_f32 v117, v113, v64
    v_mul_f32 v13, 0xbdd2d3e8, v115
    v_mfma_f32_32x32x16_bf16 v[32:47], v[108:111], v[236:239], v[32:47]
    s_cbranch_vccnz L_fix72
L_back72:
    ds_read_b128 v[104:107], v1 offset:31744
    v_rcp_f32 v14, v114
    s_waitcnt lgkmcnt(5)
    v_mfma_f32_32x32x16_bf16 v[16:31], v[80:83], v[240:243], v[16:31]
    ds_read_b128 v[108:111], v1 offset:64512
    s_waitcnt vmcnt(4)
    v_cmp_eq_u32 vcc, -1, v244
    buffer_load_dwordx4 v1, s[8:11], s47 offen offset:2048 sc1 lds
    v_mfma_f32_32x32x16_bf16 v[32:47], v[84:87], v[240:243], v[32:47]
    s_cbranch_vccnz L_fix73
L_back73:
    ds_read_b128 v[80:83], v8 offset:0
    v_mov_b32 v65, 0
    s_waitcnt lgkmcnt(5)
    v_mfma_f32_32x32x16_bf16 v[16:31], v[88:91], v[244:247], v[16:31]
    ds_read_b128 v[84:87], v8 offset:1024
    s_waitcnt vmcnt(4)
    v_cmp_eq_u32 vcc, -1, v248
    v_mov_b32 v68, 0
    v_mov_b32 v69, 0
    v_mov_b32 v72, 0
    v_mfma_f32_32x32x16_bf16 v[32:47], v[92:95], v[244:247], v[32:47]
    s_cbranch_vccnz L_fix74
L_back74:
    ds_read_b128 v[88:91], v8 offset:2048
    v_mov_b32 v73, 0
    s_mov_b32 s6, -1
    s_mov_b32 s7, 0
    s_waitcnt lgkmcnt(5)
    v_mfma_f32_32x32x16_bf16 v[16:31], v[96:99], v[248:251], v[16:31]
    ds_read_b128 v[92:95], v8 offset:3072
    s_waitcnt vmcnt(3)
    v_cmp_eq_u32 vcc, -1, v252
    buffer_load_dwordx4 v1, s[8:11], s47 offen offset:3072 sc1 lds
    v_mfma_f32_32x32x16_bf16 v[32:47], v[100:103], v[248:251], v[32:47]
    s_cbranch_vccnz L_fix75
L_back75:
    ds_read_b128 v[96:99], v8 offset:4096
    v_cndmask_b32 v66, v64, v116, s[6:7]
    s_waitcnt lgkmcnt(5)
    v_mfma_f32_32x32x16_bf16 v[16:31], v[104:107], v[252:255], v[16:31]
    ds_read_b128 v[100:103], v8 offset:5120
    v_cndmask_b32 v70, v116, v64, s[6:7]
    v_cndmask_b32 v78, v64, v78, s[6:7]
    v_cndmask_b32 v67, v64, v117, s[6:7]
    v_mfma_f32_32x32x16_bf16 v[32:47], v[108:111], v[252:255], v[32:47]
    ds_read_b128 v[104:107], v8 offset:6144
    v_cndmask_b32 v71, v117, v64, s[6:7]
    v_cndmask_b32 v79, v64, v79, s[6:7]
    v_mfma_f32_32x32x16_bf16 v[16:31], v[124:127], v[66:69], v[16:31]
    v_mfma_f32_32x32x16_bf16 v[32:47], v[124:127], v[64:67], v[32:47]
    s_barrier
    s_waitcnt lgkmcnt(3)
    v_mfma_f32_32x32x16_bf16 v[48:63], v[80:83], v[128:131], 0
    ds_read_b128 v[108:111], v8 offset:7168
    v_mfma_f32_32x32x16_bf16 v[48:63], v[84:87], v[132:135], v[48:63]
    ds_read_b128 v[80:83], v8 offset:8192
    s_nop 4
    v_mul_f32 v112, v16, v16
    s_add_u32 m0, s45, 135168
    v_fma_f32 v112, v112, v13, v12
    v_mul_f32 v112, v112, v16
    v_mfma_f32_32x32x16_bf16 v[48:63], v[88:91], v[136:139], v[48:63]
    ds_read_b128 v[84:87], v8 offset:9216
    v_exp_f32 v112, v112
    s_add_u32 s47, s44, 0x221000
    v_mul_f32 v16, v16, v24
    v_mul_f32 v113, v17, v17
    v_mfma_f32_32x32x16_bf16 v[48:63], v[92:95], v[140:143], v[48:63]
    ds_read_b128 v[88:91], v8 offset:10240
    v_fma_f32 v113, v113, v13, v12
    s_waitcnt lgkmcnt(3)
    v_mfma_f32_32x32x16_bf16 v[48:63], v[96:99], v[144:147], v[48:63]
    ds_read_b128 v[92:95], v8 offset:11264
    buffer_load_dwordx4 v1, s[8:11], s47 offen offset:0 sc1 lds
    v_mul_f32 v113, v113, v17
    v_exp_f32 v113, v113
    v_mul_f32 v17, v17, v25
    v_mfma_f32_32x32x16_bf16 v[48:63], v[100:103], v[148:151], v[48:63]
    ds_read_b128 v[96:99], v8 offset:12288
    buffer_load_dwordx4 v1, s[8:11], s47 offen offset:1024 sc1 lds
    v_fma_f32 v112, v112, v14, v14
    v_mfma_f32_32x32x16_bf16 v[48:63], v[104:107], v[152:155], v[48:63]
    ds_read_b128 v[100:103], v8 offset:13312
    v_rcp_f32 v112, v112
    v_mul_f32 v114, v18, v18
    v_fma_f32 v114, v114, v13, v12
    v_mfma_f32_32x32x16_bf16 v[48:63], v[108:111], v[156:159], v[48:63]
    ds_read_b128 v[104:107], v8 offset:14336
    buffer_load_dwordx4 v1, s[8:11], s47 offen offset:2048 sc1 lds
    v_mul_f32 v114, v114, v18
    v_exp_f32 v114, v114
    s_waitcnt lgkmcnt(3)
    v_mfma_f32_32x32x16_bf16 v[48:63], v[80:83], v[160:163], v[48:63]
    ds_read_b128 v[108:111], v8 offset:15360
    v_mul_f32 v18, v18, v26
    buffer_load_dwordx4 v1, s[8:11], s47 offen offset:3072 sc1 lds
    v_fma_f32 v113, v113, v14, v14
    v_mfma_f32_32x32x16_bf16 v[48:63], v[84:87], v[164:167], v[48:63]
    ds_read_b128 v[80:83], v8 offset:16384
    v_rcp_f32 v113, v113
    v_mul_f32 v115, v19, v19
    s_mul_i32 s44, s21, 229376
    v_mul_f32 v16, v16, v112
    v_mfma_f32_32x32x16_bf16 v[48:63], v[88:91], v[168:171], v[48:63]
    ds_read_b128 v[84:87], v8 offset:17408
    v_fma_f32 v115, v115, v13, v12
    v_mul_f32 v115, v115, v19
    v_exp_f32 v115, v115
    s_lshl_b32 s45, s3, 13
    v_mfma_f32_32x32x16_bf16 v[48:63], v[92:95], v[172:175], v[48:63]
    ds_read_b128 v[88:91], v8 offset:18432
    v_mul_f32 v19, v19, v27
    v_fma_f32 v114, v114, v14, v14
    v_rcp_f32 v114, v114
    s_add_u32 s44, s44, s45
    v_mul_f32 v116, v20, v20
    s_waitcnt lgkmcnt(3)
    v_mfma_f32_32x32x16_bf16 v[48:63], v[96:99], v[176:179], v[48:63]
    ds_read_b128 v[92:95], v8 offset:19456
    v_mul_f32 v17, v17, v113
    v_cvt_pk_bf16_f32 v120, v16, v17
    s_add_u32 m0, s45, 0
    v_fma_f32 v116, v116, v13, v12
    v_mul_f32 v116, v116, v20
    v_mfma_f32_32x32x16_bf16 v[48:63], v[100:103], v[180:183], v[48:63]
    ds_read_b128 v[96:99], v8 offset:20480
    v_exp_f32 v116, v116
    v_mul_f32 v20, v20, v28
    s_add_u32 s47, s44, 0x228000
    v_fma_f32 v115, v115, v14, v14
    v_mfma_f32_32x32x16_bf16 v[48:63], v[104:107], v[184:187], v[48:63]
    ds_read_b128 v[100:103], v8 offset:21504
    v_rcp_f32 v115, v115
    v_mul_f32 v117, v21, v21
    v_mfma_f32_32x32x16_bf16 v[48:63], v[108:111], v[188:191], v[48:63]
    ds_read_b128 v[104:107], v8 offset:22528
    buffer_load_dwordx4 v1, s[8:11], s47 offen offset:0 sc1 lds
    v_mul_f32 v18, v18, v114
    v_fma_f32 v117, v117, v13, v12
    v_mul_f32 v117, v117, v21
    s_waitcnt lgkmcnt(3)
    v_mfma_f32_32x32x16_bf16 v[48:63], v[80:83], v[192:195], v[48:63]
    ds_read_b128 v[108:111], v8 offset:23552
    buffer_load_dwordx4 v1, s[8:11], s47 offen offset:1024 sc1 lds
    v_exp_f32 v117, v117
    v_mul_f32 v21, v21, v29
    v_mfma_f32_32x32x16_bf16 v[48:63], v[84:87], v[196:199], v[48:63]
    ds_read_b128 v[80:83], v8 offset:24576
    v_fma_f32 v116, v116, v14, v14
    v_rcp_f32 v116, v116
    v_mfma_f32_32x32x16_bf16 v[48:63], v[88:91], v[200:203], v[48:63]
    ds_read_b128 v[84:87], v8 offset:25600
    buffer_load_dwordx4 v1, s[8:11], s47 offen offset:2048 sc1 lds
    v_mul_f32 v118, v22, v22
    v_mul_f32 v19, v19, v115
    v_cvt_pk_bf16_f32 v121, v18, v19
    v_mfma_f32_32x32x16_bf16 v[48:63], v[92:95], v[204:207], v[48:63]
    ds_read_b128 v[88:91], v8 offset:26624
    buffer_load_dwordx4 v1, s[8:11], s47 offen offset:3072 sc1 lds
    v_fma_f32 v118, v118, v13, v12
    v_mul_f32 v118, v118, v22
    s_waitcnt lgkmcnt(3)
    v_mfma_f32_32x32x16_bf16 v[48:63], v[96:99], v[208:211], v[48:63]
    ds_read_b128 v[92:95], v8 offset:27648
    v_exp_f32 v118, v118
    s_add_u32 m0, s45, 4096
    v_mul_f32 v22, v22, v30
    v_fma_f32 v117, v117, v14, v14
    v_mfma_f32_32x32x16_bf16 v[48:63], v[100:103], v[212:215], v[48:63]
    ds_read_b128 v[96:99], v8 offset:28672
    v_rcp_f32 v117, v117
    v_mul_f32 v119, v23, v23
    s_add_u32 s47, s44, 0x229000
    v_mul_f32 v20, v20, v116
    v_mfma_f32_32x32x16_bf16 v[48:63], v[104:107], v[216:219], v[48:63]
    ds_read_b128 v[100:103], v8 offset:29696
    v_fma_f32 v119, v119, v13, v12
    v_mul_f32 v119, v119, v23
    buffer_load_dwordx4 v1, s[8:11], s47 offen offset:0 sc1 lds
    v_mfma_f32_32x32x16_bf16 v[48:63], v[108:111], v[220:223], v[48:63]
    ds_read_b128 v[104:107], v8 offset:30720
    v_exp_f32 v119, v119
    v_mul_f32 v23, v23, v31
    v_fma_f32 v118, v118, v14, v14
    s_waitcnt lgkmcnt(3)
    v_mfma_f32_32x32x16_bf16 v[48:63], v[80:83], v[224:227], v[48:63]
    ds_read_b128 v[108:111], v8 offset:31744
    buffer_load_dwordx4 v1, s[8:11], s47 offen offset:1024 sc1 lds
    v_rcp_f32 v118, v118
    v_mul_f32 v21, v21, v117
    v_mfma_f32_32x32x16_bf16 v[48:63], v[84:87], v[228:231], v[48:63]
    v_cvt_pk_bf16_f32 v122, v20, v21
    v_fma_f32 v119, v119, v14, v14
    s_barrier
    ds_read_b128 v[80:83], v8 offset:32768
    v_mfma_f32_32x32x16_bf16 v[48:63], v[88:91], v[232:235], v[48:63]
    ds_read_b128 v[84:87], v8 offset:33792
    buffer_load_dwordx4 v1, s[8:11], s47 offen offset:2048 sc1 lds
    v_rcp_f32 v119, v119
    v_mul_f32 v22, v22, v118
    v_mul_f32 v23, v23, v119
    v_mfma_f32_32x32x16_bf16 v[48:63], v[92:95], v[236:239], v[48:63]
    ds_read_b128 v[88:91], v8 offset:34816
    buffer_load_dwordx4 v1, s[8:11], s47 offen offset:3072 sc1 lds
    v_cvt_pk_bf16_f32 v123, v22, v23
    s_waitcnt lgkmcnt(3)
    v_mfma_f32_32x32x16_bf16 v[48:63], v[96:99], v[240:243], v[48:63]
    ds_read_b128 v[92:95], v8 offset:35840
    buffer_store_dwordx4 v[120:123], v1, s[8:11], s33 offen offset:0 sc1
    v_mul_f32 v112, v32, v32
    s_add_u32 m0, s45, 32768
    v_mfma_f32_32x32x16_bf16 v[48:63], v[100:103], v[244:247], v[48:63]
    ds_read_b128 v[96:99], v8 offset:36864
    v_fma_f32 v112, v112, v13, v12
    v_mul_f32 v112, v112, v32
    v_exp_f32 v112, v112
    v_mul_f32 v32, v32, v40
    v_mfma_f32_32x32x16_bf16 v[48:63], v[104:107], v[248:251], v[48:63]
    ds_read_b128 v[100:103], v8 offset:37888
    s_add_u32 s47, s44, 0x230000
    v_mul_f32 v113, v33, v33
    v_fma_f32 v113, v113, v13, v12
    v_mul_f32 v113, v113, v33
    v_mfma_f32_32x32x16_bf16 v[48:63], v[108:111], v[252:255], v[48:63]
    ds_read_b128 v[104:107], v8 offset:38912
    buffer_load_dwordx4 v1, s[8:11], s47 offen offset:0 sc1 lds
    v_exp_f32 v113, v113
    v_mul_f32 v33, v33, v41
    v_mfma_f32_32x32x16_bf16 v[48:63], v[124:127], v[70:73], v[48:63]
    v_fma_f32 v112, v112, v14, v14
    buffer_load_dwordx4 v1, s[8:11], s47 offen offset:1024 sc1 lds
    v_rcp_f32 v112, v112
    v_mul_f32 v114, v34, v34
    v_fma_f32 v114, v114, v13, v12
    s_waitcnt lgkmcnt(3)
    v_mfma_f32_32x32x16_bf16 v[16:31], v[80:83], v[128:131], 0
    ds_read_b128 v[108:111], v8 offset:39936
    v_mul_f32 v114, v114, v34
    buffer_load_dwordx4 v1, s[8:11], s47 offen offset:2048 sc1 lds
    v_mfma_f32_32x32x16_bf16 v[16:31], v[84:87], v[132:135], v[16:31]
    ds_read_b128 v[80:83], v8 offset:40960
    v_exp_f32 v114, v114
    v_mul_f32 v34, v34, v42
    v_fma_f32 v113, v113, v14, v14
    v_mfma_f32_32x32x16_bf16 v[16:31], v[88:91], v[136:139], v[16:31]
    ds_read_b128 v[84:87], v8 offset:41984
    v_rcp_f32 v113, v113
    v_mul_f32 v115, v35, v35
    v_mfma_f32_32x32x16_bf16 v[16:31], v[92:95], v[140:143], v[16:31]
    ds_read_b128 v[88:91], v8 offset:43008
    buffer_load_dwordx4 v1, s[8:11], s47 offen offset:3072 sc1 lds
    s_waitcnt lgkmcnt(3)
    v_mfma_f32_32x32x16_bf16 v[16:31], v[96:99], v[144:147], v[16:31]
    ds_read_b128 v[92:95], v8 offset:44032
    v_mul_f32 v32, v32, v112
    v_fma_f32 v115, v115, v13, v12
    v_mul_f32 v115, v115, v35
    v_exp_f32 v115, v115
    v_mfma_f32_32x32x16_bf16 v[16:31], v[100:103], v[148:151], v[16:31]
    ds_read_b128 v[96:99], v8 offset:45056
    v_mul_f32 v35, v35, v43
    v_fma_f32 v114, v114, v14, v14
    s_add_u32 m0, s45, 36864
    v_rcp_f32 v114, v114
    v_mfma_f32_32x32x16_bf16 v[16:31], v[104:107], v[152:155], v[16:31]
    ds_read_b128 v[100:103], v8 offset:46080
    v_mul_f32 v116, v36, v36
    v_mul_f32 v33, v33, v113
    v_cvt_pk_bf16_f32 v120, v32, v33
    v_fma_f32 v116, v116, v13, v12
    v_mul_f32 v116, v116, v36
    v_mfma_f32_32x32x16_bf16 v[16:31], v[108:111], v[156:159], v[16:31]
    ds_read_b128 v[104:107], v8 offset:47104
    s_add_u32 s47, s44, 0x231000
    v_exp_f32 v116, v116
    v_mul_f32 v36, v36, v44
    s_waitcnt lgkmcnt(3)
    v_mfma_f32_32x32x16_bf16 v[16:31], v[80:83], v[160:163], v[16:31]
    ds_read_b128 v[108:111], v8 offset:48128
    v_fma_f32 v115, v115, v14, v14
    v_rcp_f32 v115, v115
    v_mul_f32 v117, v37, v37
    v_mul_f32 v34, v34, v114
    v_mfma_f32_32x32x16_bf16 v[16:31], v[84:87], v[164:167], v[16:31]
    ds_read_b128 v[80:83], v8 offset:49152
    buffer_load_dwordx4 v1, s[8:11], s47 offen offset:0 sc1 lds
    v_fma_f32 v117, v117, v13, v12
    v_mfma_f32_32x32x16_bf16 v[16:31], v[88:91], v[168:171], v[16:31]
    ds_read_b128 v[84:87], v8 offset:50176
    v_mul_f32 v117, v117, v37
    v_exp_f32 v117, v117
    v_mul_f32 v37, v37, v45
    v_fma_f32 v116, v116, v14, v14
    v_mfma_f32_32x32x16_bf16 v[16:31], v[92:95], v[172:175], v[16:31]
    ds_read_b128 v[88:91], v8 offset:51200
    v_rcp_f32 v116, v116
    s_waitcnt lgkmcnt(3)
    v_mfma_f32_32x32x16_bf16 v[16:31], v[96:99], v[176:179], v[16:31]
    ds_read_b128 v[92:95], v8 offset:52224
    buffer_load_dwordx4 v1, s[8:11], s47 offen offset:1024 sc1 lds
    v_mul_f32 v118, v38, v38
    v_mul_f32 v35, v35, v115
    v_mfma_f32_32x32x16_bf16 v[16:31], v[100:103], v[180:183], v[16:31]
    ds_read_b128 v[96:99], v8 offset:53248
    v_cvt_pk_bf16_f32 v121, v34, v35
    v_fma_f32 v118, v118, v13, v12
    v_mul_f32 v118, v118, v38
    v_exp_f32 v118, v118
    v_mfma_f32_32x32x16_bf16 v[16:31], v[104:107], v[184:187], v[16:31]
    ds_read_b128 v[100:103], v8 offset:54272
    buffer_load_dwordx4 v1, s[8:11], s47 offen offset:2048 sc1 lds
    v_mul_f32 v38, v38, v46
    v_mfma_f32_32x32x16_bf16 v[16:31], v[108:111], v[188:191], v[16:31]
    ds_read_b128 v[104:107], v8 offset:55296
    v_fma_f32 v117, v117, v14, v14
    v_rcp_f32 v117, v117
    v_mul_f32 v119, v39, v39
    s_waitcnt lgkmcnt(3)
    v_mfma_f32_32x32x16_bf16 v[16:31], v[80:83], v[192:195], v[16:31]
    ds_read_b128 v[108:111], v8 offset:56320
    v_mul_f32 v36, v36, v116
    v_fma_f32 v119, v119, v13, v12
    v_mfma_f32_32x32x16_bf16 v[16:31], v[84:87], v[196:199], v[16:31]
    ds_read_b128 v[80:83], v8 offset:57344
    buffer_load_dwordx4 v1, s[8:11], s47 offen offset:3072 sc1 lds
    v_mul_f32 v119, v119, v39
    v_exp_f32 v119, v119
    v_mul_f32 v39, v39, v47
    v_mfma_f32_32x32x16_bf16 v[16:31], v[88:91], v[200:203], v[16:31]
L_pad40192:
    s_cbranch_execz L_ret_p3s0
    ds_read_b128 v[84:87], v8 offset:58368
    v_fma_f32 v118, v118, v14, v14
    v_rcp_f32 v118, v118
    v_mul_f32 v37, v37, v117
    v_mfma_f32_32x32x16_bf16 v[16:31], v[92:95], v[204:207], v[16:31]
    ds_read_b128 v[88:91], v8 offset:59392
    buffer_load_dwordx4 a[160:163], v1, s[8:11], s74 offen offset:0 sc1
    v_cvt_pk_bf16_f32 v122, v36, v37
    s_waitcnt lgkmcnt(3)
    v_mfma_f32_32x32x16_bf16 v[16:31], v[96:99], v[208:211], v[16:31]
    ds_read_b128 v[92:95], v8 offset:60416
    v_fma_f32 v119, v119, v14, v14
    v_rcp_f32 v119, v119
    v_mul_f32 v38, v38, v118
    v_mul_f32 v39, v39, v119
    v_mfma_f32_32x32x16_bf16 v[16:31], v[100:103], v[212:215], v[16:31]
    ds_read_b128 v[96:99], v8 offset:61440
    v_cvt_pk_bf16_f32 v123, v38, v39
    buffer_load_dwordx4 a[164:167], v1, s[8:11], s75 offen offset:0 sc1
    v_mfma_f32_32x32x16_bf16 v[16:31], v[104:107], v[216:219], v[16:31]
    ds_read_b128 v[100:103], v8 offset:62464
    buffer_store_dwordx4 v[120:123], v1, s[8:11], s33 offen offset:1024 sc1
    v_mul_f32 v112, v48, v48
    v_mfma_f32_32x32x16_bf16 v[16:31], v[108:111], v[220:223], v[16:31]
    ds_read_b128 v[104:107], v8 offset:63488
    v_fma_f32 v112, v112, v13, v12
    v_mul_f32 v112, v112, v48
    v_exp_f32 v112, v112
    s_waitcnt lgkmcnt(3)
    v_mfma_f32_32x32x16_bf16 v[16:31], v[80:83], v[224:227], v[16:31]
    ds_read_b128 v[108:111], v8 offset:64512
    v_mul_f32 v48, v48, v56
    buffer_load_dwordx4 a[168:171], v15, s[8:11], s74 offen offset:0 sc1
    v_mfma_f32_32x32x16_bf16 v[16:31], v[84:87], v[228:231], v[16:31]
    v_mul_f32 v113, v49, v49
    v_fma_f32 v113, v113, v13, v12
    v_mul_f32 v113, v113, v49
    s_waitcnt vmcnt(21)
    s_barrier
    ds_read_b128 v[80:83], v9 offset:0
    v_mfma_f32_32x32x16_bf16 v[16:31], v[88:91], v[232:235], v[16:31]
    ds_read_b128 v[84:87], v9 offset:1024
    v_exp_f32 v113, v113
    v_mul_f32 v49, v49, v57
    v_fma_f32 v112, v112, v14, v14
    v_mfma_f32_32x32x16_bf16 v[16:31], v[92:95], v[236:239], v[16:31]
    ds_read_b128 v[88:91], v9 offset:2048
    buffer_load_dwordx4 a[172:175], v15, s[8:11], s75 offen offset:0 sc1
    v_rcp_f32 v112, v112
    v_mul_f32 v114, v50, v50
    s_waitcnt lgkmcnt(3)
    v_mfma_f32_32x32x16_bf16 v[16:31], v[96:99], v[240:243], v[16:31]
    ds_read_b128 v[92:95], v9 offset:3072
    v_fma_f32 v114, v114, v13, v12
    v_mul_f32 v114, v114, v50
    v_exp_f32 v114, v114
    v_mul_f32 v50, v50, v58
    v_mfma_f32_32x32x16_bf16 v[16:31], v[100:103], v[244:247], v[16:31]
    ds_read_b128 v[96:99], v9 offset:4096
    buffer_load_dwordx4 a[176:179], v7, s[8:11], s74 offen offset:0 sc1
    v_fma_f32 v113, v113, v14, v14
    v_mfma_f32_32x32x16_bf16 v[16:31], v[104:107], v[248:251], v[16:31]
    ds_read_b128 v[100:103], v9 offset:5120
    v_rcp_f32 v113, v113
    v_mul_f32 v115, v51, v51
    v_mul_f32 v48, v48, v112
    v_fma_f32 v115, v115, v13, v12
    v_mfma_f32_32x32x16_bf16 v[16:31], v[108:111], v[252:255], v[16:31]
    ds_read_b128 v[104:107], v9 offset:6144
    v_mul_f32 v115, v115, v51
    buffer_load_dwordx4 a[180:183], v7, s[8:11], s75 offen offset:0 sc1
    v_mfma_f32_32x32x16_bf16 v[16:31], v[124:127], v[68:71], v[16:31]
    v_exp_f32 v115, v115
    v_mul_f32 v51, v51, v59
    v_fma_f32 v114, v114, v14, v14
    v_rcp_f32 v114, v114
    v_mul_f32 v116, v52, v52
    s_waitcnt lgkmcnt(3)
    v_mfma_f32_32x32x16_bf16 v[32:47], v[80:83], v[128:131], 0
    ds_read_b128 v[108:111], v9 offset:7168
    v_mul_f32 v49, v49, v113
    buffer_load_dwordx4 a[184:187], v10, s[8:11], s74 offen offset:0 sc1
    v_mfma_f32_32x32x16_bf16 v[32:47], v[84:87], v[132:135], v[32:47]
    ds_read_b128 v[80:83], v9 offset:8192
    v_cvt_pk_bf16_f32 v120, v48, v49
    v_fma_f32 v116, v116, v13, v12
    v_mul_f32 v116, v116, v52
    v_exp_f32 v116, v116
    v_mfma_f32_32x32x16_bf16 v[32:47], v[88:91], v[136:139], v[32:47]
    ds_read_b128 v[84:87], v9 offset:9216
    v_mul_f32 v52, v52, v60
    v_fma_f32 v115, v115, v14, v14
    v_rcp_f32 v115, v115
    v_mul_f32 v117, v53, v53
    v_mfma_f32_32x32x16_bf16 v[32:47], v[92:95], v[140:143], v[32:47]
    ds_read_b128 v[88:91], v9 offset:10240
    buffer_load_dwordx4 a[188:191], v10, s[8:11], s75 offen offset:0 sc1
    s_waitcnt lgkmcnt(3)
    v_mfma_f32_32x32x16_bf16 v[32:47], v[96:99], v[144:147], v[32:47]
    v_lshlrev_b32 v6, 10, v5
    v_lshl_add_u32 v6, v4, 4, v6
    ds_read_b128 v[92:95], v9 offset:11264
    v_mul_f32 v50, v50, v114
    v_fma_f32 v117, v117, v13, v12
    v_mul_f32 v117, v117, v53
    v_mfma_f32_32x32x16_bf16 v[32:47], v[100:103], v[148:151], v[32:47]
    ds_read_b128 v[96:99], v9 offset:12288
    v_exp_f32 v117, v117
    v_mul_f32 v53, v53, v61
    v_fma_f32 v116, v116, v14, v14
    v_mfma_f32_32x32x16_bf16 v[32:47], v[104:107], v[152:155], v[32:47]
    ds_read_b128 v[100:103], v9 offset:13312
    v_rcp_f32 v116, v116
    v_mul_f32 v118, v54, v54
    v_mfma_f32_32x32x16_bf16 v[32:47], v[108:111], v[156:159], v[32:47]
    ds_read_b128 v[104:107], v9 offset:14336
    buffer_load_dwordx4 a[192:195], v1, s[8:11], s74 offen offset:1024 sc1
    s_waitcnt lgkmcnt(3)
    v_mfma_f32_32x32x16_bf16 v[32:47], v[80:83], v[160:163], v[32:47]
    ds_read_b128 v[108:111], v9 offset:15360
    v_mul_f32 v51, v51, v115
    v_cvt_pk_bf16_f32 v121, v50, v51
    v_fma_f32 v118, v118, v13, v12
    v_mul_f32 v118, v118, v54
    v_mfma_f32_32x32x16_bf16 v[32:47], v[84:87], v[164:167], v[32:47]
    s_add_u32 s38, s35, 0x2342000
    v_mov_b32 v3, 1
    v_exp_f32 v118, v118
    v_mul_f32 v54, v54, v62
    s_waitcnt vmcnt(7)
    s_mov_b64 exec, 1
    buffer_atomic_add v3, off, s[8:11], s38 sc1
    s_mov_b64 exec, -1
    ds_read_b128 v[80:83], v9 offset:16384
    v_mfma_f32_32x32x16_bf16 v[32:47], v[88:91], v[168:171], v[32:47]
    ds_read_b128 v[84:87], v9 offset:17408
    v_fma_f32 v117, v117, v14, v14
    v_rcp_f32 v117, v117
    v_mfma_f32_32x32x16_bf16 v[32:47], v[92:95], v[172:175], v[32:47]
    ds_read_b128 v[88:91], v9 offset:18432
    buffer_load_dwordx4 a[196:199], v1, s[8:11], s75 offen offset:1024 sc1
    v_mul_f32 v119, v55, v55
    v_mul_f32 v52, v52, v116
    s_waitcnt lgkmcnt(3)
    v_mfma_f32_32x32x16_bf16 v[32:47], v[96:99], v[176:179], v[32:47]
    ds_read_b128 v[92:95], v9 offset:19456
    v_fma_f32 v119, v119, v13, v12
    v_mul_f32 v119, v119, v55
    v_exp_f32 v119, v119
    v_mul_f32 v55, v55, v63
    v_mfma_f32_32x32x16_bf16 v[32:47], v[100:103], v[180:183], v[32:47]
    ds_read_b128 v[96:99], v9 offset:20480
    v_fma_f32 v118, v118, v14, v14
    v_rcp_f32 v118, v118
    v_mul_f32 v53, v53, v117
    v_mfma_f32_32x32x16_bf16 v[32:47], v[104:107], v[184:187], v[32:47]
    ds_read_b128 v[100:103], v9 offset:21504
    buffer_load_dwordx4 a[200:203], v15, s[8:11], s74 offen offset:1024 sc1
    v_cvt_pk_bf16_f32 v122, v52, v53
    v_mfma_f32_32x32x16_bf16 v[32:47], v[108:111], v[188:191], v[32:47]
    ds_read_b128 v[104:107], v9 offset:22528
    v_fma_f32 v119, v119, v14, v14
    v_rcp_f32 v119, v119
    v_mul_f32 v54, v54, v118
    s_waitcnt lgkmcnt(3)
    v_mfma_f32_32x32x16_bf16 v[32:47], v[80:83], v[192:195], v[32:47]
    ds_read_b128 v[108:111], v9 offset:23552
    v_mul_f32 v55, v55, v119
    v_cvt_pk_bf16_f32 v123, v54, v55
    v_mfma_f32_32x32x16_bf16 v[32:47], v[84:87], v[196:199], v[32:47]
    ds_read_b128 v[80:83], v9 offset:24576
    buffer_store_dwordx4 v[120:123], v1, s[8:11], s33 offen offset:2048 sc1
    v_mul_f32 v112, v16, v16
    v_mfma_f32_32x32x16_bf16 v[32:47], v[88:91], v[200:203], v[32:47]
    ds_read_b128 v[84:87], v9 offset:25600
    buffer_load_dwordx4 a[204:207], v15, s[8:11], s75 offen offset:1024 sc1
    v_fma_f32 v112, v112, v13, v12
    v_mul_f32 v112, v112, v16
    v_mfma_f32_32x32x16_bf16 v[32:47], v[92:95], v[204:207], v[32:47]
    ds_read_b128 v[88:91], v9 offset:26624
    v_exp_f32 v112, v112
    v_mul_f32 v16, v16, v24
    v_mul_f32 v113, v17, v17
    s_waitcnt lgkmcnt(3)
    v_mfma_f32_32x32x16_bf16 v[32:47], v[96:99], v[208:211], v[32:47]
    ds_read_b128 v[92:95], v9 offset:27648
    v_fma_f32 v113, v113, v13, v12
    v_mul_f32 v113, v113, v17
    v_exp_f32 v113, v113
    v_mfma_f32_32x32x16_bf16 v[32:47], v[100:103], v[212:215], v[32:47]
    ds_read_b128 v[96:99], v9 offset:28672
    buffer_load_dwordx4 a[208:211], v7, s[8:11], s74 offen offset:1024 sc1
    v_mul_f32 v17, v17, v25
    v_mfma_f32_32x32x16_bf16 v[32:47], v[104:107], v[216:219], v[32:47]
    ds_read_b128 v[100:103], v9 offset:29696
    v_fma_f32 v112, v112, v14, v14
    v_rcp_f32 v112, v112
    v_mul_f32 v114, v18, v18
    v_fma_f32 v114, v114, v13, v12
    v_mfma_f32_32x32x16_bf16 v[32:47], v[108:111], v[220:223], v[32:47]
    ds_read_b128 v[104:107], v9 offset:30720
    v_mul_f32 v114, v114, v18
    v_exp_f32 v114, v114
    v_mul_f32 v18, v18, v26
    s_waitcnt lgkmcnt(3)
    v_mfma_f32_32x32x16_bf16 v[32:47], v[80:83], v[224:227], v[32:47]
    ds_read_b128 v[108:111], v9 offset:31744
    v_fma_f32 v113, v113, v14, v14
    buffer_load_dwordx4 a[212:215], v7, s[8:11], s75 offen offset:1024 sc1
    v_mfma_f32_32x32x16_bf16 v[32:47], v[84:87], v[228:231], v[32:47]
    v_rcp_f32 v113, v113
    v_mul_f32 v115, v19, v19
    v_mul_f32 v16, v16, v112
    s_barrier
    ds_read_b128 v[80:83], v1 offset:0
    v_mfma_f32_32x32x16_bf16 v[32:47], v[88:91], v[232:235], v[32:47]
    ds_read_b128 v[84:87], v1 offset:1024
    v_fma_f32 v115, v115, v13, v12
    v_mul_f32 v115, v115, v19
    v_exp_f32 v115, v115
    v_mul_f32 v19, v19, v27
    v_mfma_f32_32x32x16_bf16 v[32:47], v[92:95], v[236:239], v[32:47]
    ds_read_b128 v[88:91], v1 offset:2048
    v_fma_f32 v114, v114, v14, v14
    s_waitcnt lgkmcnt(3)
    v_mfma_f32_32x32x16_bf16 v[32:47], v[96:99], v[240:243], v[32:47]
    ds_read_b128 v[92:95], v1 offset:3072
    buffer_load_dwordx4 a[216:219], v10, s[8:11], s74 offen offset:1024 sc1
    v_rcp_f32 v114, v114
    v_mul_f32 v116, v20, v20
    v_mfma_f32_32x32x16_bf16 v[32:47], v[100:103], v[244:247], v[32:47]
    ds_read_b128 v[96:99], v1 offset:4096
    v_mul_f32 v17, v17, v113
    v_cvt_pk_bf16_f32 v120, v16, v17
    v_fma_f32 v116, v116, v13, v12
    v_mul_f32 v116, v116, v20
    v_mfma_f32_32x32x16_bf16 v[32:47], v[104:107], v[248:251], v[32:47]
    ds_read_b128 v[100:103], v1 offset:5120
    v_exp_f32 v116, v116
    v_mul_f32 v20, v20, v28
    v_mfma_f32_32x32x16_bf16 v[32:47], v[108:111], v[252:255], v[32:47]
    ds_read_b128 v[104:107], v1 offset:6144
    buffer_load_dwordx4 a[220:223], v10, s[8:11], s75 offen offset:1024 sc1
    v_fma_f32 v115, v115, v14, v14
    v_mfma_f32_32x32x16_bf16 v[32:47], v[76:79], v[66:69], v[32:47]
    v_rcp_f32 v115, v115
    v_mul_f32 v117, v21, v21
    v_mul_f32 v18, v18, v114
    v_fma_f32 v117, v117, v13, v12
    v_mul_f32 v117, v117, v21
    v_exp_f32 v117, v117
    v_mul_f32 v21, v21, v29
    s_waitcnt lgkmcnt(3)
    v_mfma_f32_32x32x16_bf16 v[48:63], v[80:83], v[128:131], 0
    ds_read_b128 v[108:111], v1 offset:7168
    v_fma_f32 v116, v116, v14, v14
    v_rcp_f32 v116, v116
    v_mul_f32 v118, v22, v22
    v_mul_f32 v19, v19, v115
    v_mfma_f32_32x32x16_bf16 v[48:63], v[84:87], v[132:135], v[48:63]
    ds_read_b128 v[80:83], v1 offset:8192
    v_cvt_pk_bf16_f32 v121, v18, v19
    v_fma_f32 v118, v118, v13, v12
    v_mul_f32 v118, v118, v22
    v_exp_f32 v118, v118
    v_mfma_f32_32x32x16_bf16 v[48:63], v[88:91], v[136:139], v[48:63]
    ds_read_b128 v[84:87], v1 offset:9216
    v_mul_f32 v22, v22, v30
    v_fma_f32 v117, v117, v14, v14
    v_rcp_f32 v117, v117
    v_mfma_f32_32x32x16_bf16 v[48:63], v[92:95], v[140:143], v[48:63]
    s_add_u32 s38, s35, 0x234a000
    v_mov_b32 v3, 1
    s_waitcnt vmcnt(5)
    s_mov_b64 exec, 1
    buffer_atomic_add v3, off, s[8:11], s38 sc1
    s_mov_b64 exec, -1
    ds_read_b128 v[88:91], v1 offset:10240
    s_waitcnt lgkmcnt(3)
    v_mfma_f32_32x32x16_bf16 v[48:63], v[96:99], v[144:147], v[48:63]
    ds_read_b128 v[92:95], v1 offset:11264
    v_mul_f32 v119, v23, v23
    v_mul_f32 v20, v20, v116
    v_fma_f32 v119, v119, v13, v12
    v_mul_f32 v119, v119, v23
    v_mfma_f32_32x32x16_bf16 v[48:63], v[100:103], v[148:151], v[48:63]
    ds_read_b128 v[96:99], v1 offset:12288
    v_exp_f32 v119, v119
    v_mul_f32 v23, v23, v31
    v_fma_f32 v118, v118, v14, v14
    v_mfma_f32_32x32x16_bf16 v[48:63], v[104:107], v[152:155], v[48:63]
    ds_read_b128 v[100:103], v1 offset:13312
    v_rcp_f32 v118, v118
    v_mul_f32 v21, v21, v117
    v_cvt_pk_bf16_f32 v122, v20, v21
    v_mfma_f32_32x32x16_bf16 v[48:63], v[108:111], v[156:159], v[48:63]
    ds_read_b128 v[104:107], v1 offset:14336
    v_fma_f32 v119, v119, v14, v14
    v_rcp_f32 v119, v119
    s_waitcnt lgkmcnt(3)
    v_mfma_f32_32x32x16_bf16 v[48:63], v[80:83], v[160:163], v[48:63]
    s_add_u32 s56, s36, 0x2342000
    s_load_dword s92, s[4:5], s56 glc
    ds_read_b128 v[108:111], v1 offset:15360
    v_mul_f32 v22, v22, v118
    v_mul_f32 v23, v23, v119
    v_cvt_pk_bf16_f32 v123, v22, v23
    v_mfma_f32_32x32x16_bf16 v[48:63], v[84:87], v[164:167], v[48:63]
    ds_read_b128 v[80:83], v1 offset:16384
    buffer_store_dwordx4 v[120:123], v1, s[8:11], s33 offen offset:3072 sc1
    v_mfma_f32_32x32x16_bf16 v[48:63], v[88:91], v[168:171], v[48:63]
    ds_read_b128 v[84:87], v1 offset:17408
    v_mul_f32 v112, v32, v32
    v_fma_f32 v112, v112, v13, v12
    v_mfma_f32_32x32x16_bf16 v[48:63], v[92:95], v[172:175], v[48:63]
    ds_read_b128 v[88:91], v1 offset:18432
    v_mul_f32 v112, v112, v32
    v_exp_f32 v112, v112
    v_mul_f32 v32, v32, v40
    s_waitcnt lgkmcnt(3)
    v_mfma_f32_32x32x16_bf16 v[48:63], v[96:99], v[176:179], v[48:63]
    ds_read_b128 v[92:95], v1 offset:19456
    v_mul_f32 v113, v33, v33
    v_fma_f32 v113, v113, v13, v12
    v_mul_f32 v113, v113, v33
    v_mfma_f32_32x32x16_bf16 v[48:63], v[100:103], v[180:183], v[48:63]
    ds_read_b128 v[96:99], v1 offset:20480
    v_exp_f32 v113, v113
    v_mul_f32 v33, v33, v41
    v_mfma_f32_32x32x16_bf16 v[48:63], v[104:107], v[184:187], v[48:63]
    ds_read_b128 v[100:103], v1 offset:21504
    v_fma_f32 v112, v112, v14, v14
    v_rcp_f32 v112, v112
    v_mfma_f32_32x32x16_bf16 v[48:63], v[108:111], v[188:191], v[48:63]
    ds_read_b128 v[104:107], v1 offset:22528
    v_mul_f32 v114, v34, v34
    v_fma_f32 v114, v114, v13, v12
    v_mul_f32 v114, v114, v34
    s_waitcnt lgkmcnt(3)
    v_mfma_f32_32x32x16_bf16 v[48:63], v[80:83], v[192:195], v[48:63]
    ds_read_b128 v[108:111], v1 offset:23552
    v_exp_f32 v114, v114
    v_mul_f32 v34, v34, v42
    v_fma_f32 v113, v113, v14, v14
    v_mfma_f32_32x32x16_bf16 v[48:63], v[84:87], v[196:199], v[48:63]
    ds_read_b128 v[80:83], v1 offset:24576
    v_rcp_f32 v113, v113
    v_mul_f32 v115, v35, v35
    v_mfma_f32_32x32x16_bf16 v[48:63], v[88:91], v[200:203], v[48:63]
    ds_read_b128 v[84:87], v1 offset:25600
    v_mul_f32 v32, v32, v112
    v_fma_f32 v115, v115, v13, v12
    v_mul_f32 v115, v115, v35
    v_mfma_f32_32x32x16_bf16 v[48:63], v[92:95], v[204:207], v[48:63]
    ds_read_b128 v[88:91], v1 offset:26624
    v_exp_f32 v115, v115
    v_mul_f32 v35, v35, v43
    s_waitcnt lgkmcnt(3)
    v_mfma_f32_32x32x16_bf16 v[48:63], v[96:99], v[208:211], v[48:63]
    ds_read_b128 v[92:95], v1 offset:27648
    v_fma_f32 v114, v114, v14, v14
    v_rcp_f32 v114, v114
    v_mfma_f32_32x32x16_bf16 v[48:63], v[100:103], v[212:215], v[48:63]
    ds_read_b128 v[96:99], v1 offset:28672
    v_mul_f32 v116, v36, v36
    v_mul_f32 v33, v33, v113
    v_cvt_pk_bf16_f32 v120, v32, v33
    v_mfma_f32_32x32x16_bf16 v[48:63], v[104:107], v[216:219], v[48:63]
    ds_read_b128 v[100:103], v1 offset:29696
    v_fma_f32 v116, v116, v13, v12
    v_mul_f32 v116, v116, v36
    v_exp_f32 v116, v116
    v_mfma_f32_32x32x16_bf16 v[48:63], v[108:111], v[220:223], v[48:63]
    ds_read_b128 v[104:107], v1 offset:30720
    v_mul_f32 v36, v36, v44
    v_fma_f32 v115, v115, v14, v14
    v_rcp_f32 v115, v115
    s_waitcnt lgkmcnt(3)
    v_mfma_f32_32x32x16_bf16 v[48:63], v[80:83], v[224:227], v[48:63]
    s_add_u32 s56, s36, 0x2342000
    s_waitcnt lgkmcnt(0)
    s_mov_b32 s57, 100000
    s_cmp_eq_u32 s92, 8
    s_cbranch_scc1 L_pc_ok77
L_pc77:
    s_load_dword s92, s[4:5], s56 glc
    s_sub_u32 s57, s57, 1
    s_cbranch_scc1 L_pc_ok77
    s_waitcnt lgkmcnt(0)
    s_cmp_lg_u32 s92, 8
    s_cbranch_scc1 L_pc77
L_pc_ok77:
    buffer_load_dwordx4 a[224:227], v1, s[8:11], s79 offen offset:0 sc1
    ds_read_b128 v[108:111], v1 offset:31744
    v_mfma_f32_32x32x16_bf16 v[48:63], v[84:87], v[228:231], v[48:63]
    v_mul_f32 v117, v37, v37
    v_mul_f32 v34, v34, v114
    v_fma_f32 v117, v117, v13, v12
    s_barrier
    ds_read_b128 v[80:83], v1 offset:32768
    v_mfma_f32_32x32x16_bf16 v[48:63], v[88:91], v[232:235], v[48:63]
    buffer_load_dwordx4 a[228:231], v15, s[8:11], s79 offen offset:0 sc1
    ds_read_b128 v[84:87], v1 offset:33792
    v_mul_f32 v117, v117, v37
    v_mfma_f32_32x32x16_bf16 v[48:63], v[92:95], v[236:239], v[48:63]
    ds_read_b128 v[88:91], v1 offset:34816
    v_exp_f32 v117, v117
    v_mul_f32 v37, v37, v45
    v_fma_f32 v116, v116, v14, v14
    s_waitcnt lgkmcnt(3)
    v_mfma_f32_32x32x16_bf16 v[48:63], v[96:99], v[240:243], v[48:63]
    buffer_load_dwordx4 a[232:235], v7, s[8:11], s79 offen offset:0 sc1
    ds_read_b128 v[92:95], v1 offset:35840
    v_mfma_f32_32x32x16_bf16 v[48:63], v[100:103], v[244:247], v[48:63]
    ds_read_b128 v[96:99], v1 offset:36864
    v_rcp_f32 v116, v116
    v_mul_f32 v118, v38, v38
    v_mul_f32 v35, v35, v115
    v_cvt_pk_bf16_f32 v121, v34, v35
    v_mfma_f32_32x32x16_bf16 v[48:63], v[104:107], v[248:251], v[48:63]
    ds_read_b128 v[100:103], v1 offset:37888
    v_fma_f32 v118, v118, v13, v12
    v_mul_f32 v118, v118, v38
    v_exp_f32 v118, v118
    v_mul_f32 v38, v38, v46
    v_mfma_f32_32x32x16_bf16 v[48:63], v[108:111], v[252:255], v[48:63]
    buffer_load_dwordx4 a[236:239], v10, s[8:11], s79 offen offset:0 sc1
    s_add_u32 s38, s35, 0x2352000
    v_mov_b32 v3, 1
    s_waitcnt vmcnt(4)
    s_mov_b64 exec, 1
    buffer_atomic_add v3, off, s[8:11], s38 sc1
    s_mov_b64 exec, -1
    ds_read_b128 v[104:107], v1 offset:38912
    v_mfma_f32_32x32x16_bf16 v[48:63], v[76:79], v[64:67], v[48:63]
    v_fma_f32 v117, v117, v14, v14
    v_rcp_f32 v117, v117
    v_mul_f32 v119, v39, v39
    v_mul_f32 v36, v36, v116
    v_fma_f32 v119, v119, v13, v12
    s_waitcnt lgkmcnt(3)
    v_mfma_f32_32x32x16_bf16 v[16:31], v[80:83], v[128:131], 0
    buffer_load_dwordx4 a[240:243], v1, s[8:11], s79 offen offset:1024 sc1
    ds_read_b128 v[108:111], v1 offset:39936
    v_mul_f32 v119, v119, v39
    v_mfma_f32_32x32x16_bf16 v[16:31], v[84:87], v[132:135], v[16:31]
    ds_read_b128 v[80:83], v1 offset:40960
    v_exp_f32 v119, v119
    v_mul_f32 v39, v39, v47
    v_fma_f32 v118, v118, v14, v14
    v_mfma_f32_32x32x16_bf16 v[16:31], v[88:91], v[136:139], v[16:31]
    ds_read_b128 v[84:87], v1 offset:41984
    v_rcp_f32 v118, v118
    v_mul_f32 v37, v37, v117
    v_cvt_pk_bf16_f32 v122, v36, v37
    v_fma_f32 v119, v119, v14, v14
    v_mfma_f32_32x32x16_bf16 v[16:31], v[92:95], v[140:143], v[16:31]
    buffer_load_dwordx4 a[244:247], v15, s[8:11], s79 offen offset:1024 sc1
    ds_read_b128 v[88:91], v1 offset:43008
    s_waitcnt lgkmcnt(3)
    v_mfma_f32_32x32x16_bf16 v[16:31], v[96:99], v[144:147], v[16:31]
    ds_read_b128 v[92:95], v1 offset:44032
    v_rcp_f32 v119, v119
    v_mul_f32 v38, v38, v118
    v_mul_f32 v39, v39, v119
    v_cvt_pk_bf16_f32 v123, v38, v39
    v_mfma_f32_32x32x16_bf16 v[16:31], v[100:103], v[148:151], v[16:31]
    buffer_load_dwordx4 a[248:251], v7, s[8:11], s79 offen offset:1024 sc1
    ds_read_b128 v[96:99], v1 offset:45056
    s_add_u32 s33, s33, 4096
    v_mfma_f32_32x32x16_bf16 v[16:31], v[104:107], v[152:155], v[16:31]
    ds_read_b128 v[100:103], v1 offset:46080
    buffer_store_dwordx4 v[120:123], v1, s[8:11], s33 offen offset:0 sc1
    v_mul_f32 v112, v48, v48
    v_mfma_f32_32x32x16_bf16 v[16:31], v[108:111], v[156:159], v[16:31]
    buffer_load_dwordx4 a[252:255], v10, s[8:11], s79 offen offset:1024 sc1
    ds_read_b128 v[104:107], v1 offset:47104
    v_fma_f32 v112, v112, v13, v12
    v_mul_f32 v112, v112, v48
    s_waitcnt lgkmcnt(3)
    v_mfma_f32_32x32x16_bf16 v[16:31], v[80:83], v[160:163], v[16:31]
    ds_read_b128 v[108:111], v1 offset:48128
    v_exp_f32 v112, v112
    v_mul_f32 v48, v48, v56
    v_mul_f32 v113, v49, v49
    v_fma_f32 v113, v113, v13, v12
    v_mfma_f32_32x32x16_bf16 v[16:31], v[84:87], v[164:167], v[16:31]
    ds_read_b128 v[80:83], v1 offset:49152
    v_mul_f32 v113, v113, v49
    v_exp_f32 v113, v113
    v_mul_f32 v49, v49, v57
    v_fma_f32 v112, v112, v14, v14
    v_mfma_f32_32x32x16_bf16 v[16:31], v[88:91], v[168:171], v[16:31]
    buffer_load_dwordx4 v[128:131], v1, s[8:11], s78 offen offset:0 sc1
    ds_read_b128 v[84:87], v1 offset:50176
    v_mfma_f32_32x32x16_bf16 v[16:31], v[92:95], v[172:175], v[16:31]
    ds_read_b128 v[88:91], v1 offset:51200
    v_rcp_f32 v112, v112
    v_mul_f32 v114, v50, v50
    v_fma_f32 v114, v114, v13, v12
    s_waitcnt lgkmcnt(3)
    v_mfma_f32_32x32x16_bf16 v[16:31], v[96:99], v[176:179], v[16:31]
    buffer_load_dwordx4 v[132:135], v15, s[8:11], s78 offen offset:0 sc1
    ds_read_b128 v[92:95], v1 offset:52224
    v_mul_f32 v114, v114, v50
    v_mfma_f32_32x32x16_bf16 v[16:31], v[100:103], v[180:183], v[16:31]
    s_add_u32 s56, s36, 0x234a000
    s_load_dword s93, s[4:5], s56 glc
    ds_read_b128 v[96:99], v1 offset:53248
    v_exp_f32 v114, v114
    v_mul_f32 v50, v50, v58
    v_fma_f32 v113, v113, v14, v14
    v_mfma_f32_32x32x16_bf16 v[16:31], v[104:107], v[184:187], v[16:31]
    ds_read_b128 v[100:103], v1 offset:54272
    v_rcp_f32 v113, v113
    v_mul_f32 v115, v51, v51
    v_mul_f32 v48, v48, v112
    v_fma_f32 v115, v115, v13, v12
    v_mfma_f32_32x32x16_bf16 v[16:31], v[108:111], v[188:191], v[16:31]
    buffer_load_dwordx4 v[136:139], v7, s[8:11], s78 offen offset:0 sc1
    ds_read_b128 v[104:107], v1 offset:55296
    v_mul_f32 v115, v115, v51
    s_waitcnt lgkmcnt(3)
    v_mfma_f32_32x32x16_bf16 v[16:31], v[80:83], v[192:195], v[16:31]
    ds_read_b128 v[108:111], v1 offset:56320
    v_exp_f32 v115, v115
    v_mul_f32 v51, v51, v59
    v_fma_f32 v114, v114, v14, v14
    v_mfma_f32_32x32x16_bf16 v[16:31], v[84:87], v[196:199], v[16:31]
    buffer_load_dwordx4 v[140:143], v10, s[8:11], s78 offen offset:0 sc1
    ds_read_b128 v[80:83], v1 offset:57344
    v_rcp_f32 v114, v114
    v_mul_f32 v116, v52, v52
    v_mfma_f32_32x32x16_bf16 v[16:31], v[88:91], v[200:203], v[16:31]
    ds_read_b128 v[84:87], v1 offset:58368
    v_mul_f32 v49, v49, v113
    v_cvt_pk_bf16_f32 v120, v48, v49
    v_fma_f32 v116, v116, v13, v12
    v_mul_f32 v116, v116, v52
    v_mfma_f32_32x32x16_bf16 v[16:31], v[92:95], v[204:207], v[16:31]
    buffer_load_dwordx4 v[144:147], v1, s[8:11], s78 offen offset:1024 sc1
    ds_read_b128 v[88:91], v1 offset:59392
    v_exp_f32 v116, v116
    v_mul_f32 v52, v52, v60
    s_waitcnt lgkmcnt(3)
    v_mfma_f32_32x32x16_bf16 v[16:31], v[96:99], v[208:211], v[16:31]
    ds_read_b128 v[92:95], v1 offset:60416
    v_fma_f32 v115, v115, v14, v14
    v_rcp_f32 v115, v115
    v_mul_f32 v117, v53, v53
    v_mul_f32 v50, v50, v114
    v_mfma_f32_32x32x16_bf16 v[16:31], v[100:103], v[212:215], v[16:31]
    ds_read_b128 v[96:99], v1 offset:61440
    v_fma_f32 v117, v117, v13, v12
    v_mul_f32 v117, v117, v53
    v_exp_f32 v117, v117
    v_mul_f32 v53, v53, v61
    v_mfma_f32_32x32x16_bf16 v[16:31], v[104:107], v[216:219], v[16:31]
    buffer_load_dwordx4 v[148:151], v15, s[8:11], s78 offen offset:1024 sc1
    ds_read_b128 v[100:103], v1 offset:62464
    v_fma_f32 v116, v116, v14, v14
    v_mfma_f32_32x32x16_bf16 v[16:31], v[108:111], v[220:223], v[16:31]
    ds_read_b128 v[104:107], v1 offset:63488
    v_rcp_f32 v116, v116
    v_mul_f32 v118, v54, v54
    v_mul_f32 v51, v51, v115
    s_waitcnt lgkmcnt(3)
    v_mfma_f32_32x32x16_bf16 v[16:31], v[80:83], v[224:227], v[16:31]
    buffer_load_dwordx4 v[152:155], v7, s[8:11], s78 offen offset:1024 sc1
    ds_read_b128 v[108:111], v1 offset:64512
    v_cvt_pk_bf16_f32 v121, v50, v51
    v_mfma_f32_32x32x16_bf16 v[16:31], v[84:87], v[228:231], v[16:31]
    s_add_u32 s38, s35, 0x235a000
    v_mov_b32 v3, 1
    v_fma_f32 v118, v118, v13, v12
    v_mul_f32 v118, v118, v54
    v_exp_f32 v118, v118
    s_waitcnt vmcnt(8)
    s_mov_b64 exec, 1
    buffer_atomic_add v3, off, s[8:11], s38 sc1
    s_mov_b64 exec, -1
    v_mfma_f32_32x32x16_bf16 v[16:31], v[88:91], v[232:235], v[16:31]
    v_mul_f32 v54, v54, v62
    v_fma_f32 v117, v117, v14, v14
    v_rcp_f32 v117, v117
    v_mul_f32 v119, v55, v55
    v_mul_f32 v52, v52, v116
    v_mfma_f32_32x32x16_bf16 v[16:31], v[92:95], v[236:239], v[16:31]
    buffer_load_dwordx4 v[156:159], v10, s[8:11], s78 offen offset:1024 sc1
    v_fma_f32 v119, v119, v13, v12
    s_waitcnt lgkmcnt(0)
    v_mfma_f32_32x32x16_bf16 v[16:31], v[96:99], v[240:243], v[16:31]
    v_mul_f32 v119, v119, v55
    v_exp_f32 v119, v119
    v_mul_f32 v55, v55, v63
    v_fma_f32 v118, v118, v14, v14
    v_mfma_f32_32x32x16_bf16 v[16:31], v[100:103], v[244:247], v[16:31]
    s_add_u32 s56, s36, 0x234a000
    s_waitcnt lgkmcnt(0)
    s_mov_b32 s57, 100000
    s_cmp_eq_u32 s93, 8
    s_cbranch_scc1 L_pc_ok78
L_pc78:
    s_load_dword s93, s[4:5], s56 glc
    s_sub_u32 s57, s57, 1
    s_cbranch_scc1 L_pc_ok78
    s_waitcnt lgkmcnt(0)
    s_cmp_lg_u32 s93, 8
    s_cbranch_scc1 L_pc78
L_pc_ok78:
    buffer_load_dwordx4 v[160:163], v1, s[8:11], s79 offen offset:2048 sc1
    v_mfma_f32_32x32x16_bf16 v[16:31], v[104:107], v[248:251], v[16:31]
    v_rcp_f32 v118, v118
    v_mul_f32 v53, v53, v117
    v_cvt_pk_bf16_f32 v122, v52, v53
    v_fma_f32 v119, v119, v14, v14
    v_mfma_f32_32x32x16_bf16 v[16:31], v[108:111], v[252:255], v[16:31]
    buffer_load_dwordx4 v[164:167], v15, s[8:11], s79 offen offset:2048 sc1
    v_rcp_f32 v119, v119
    v_mfma_f32_32x32x16_bf16 v[16:31], v[76:79], v[70:73], v[16:31]
    v_mul_f32 v54, v54, v118
    v_mul_f32 v55, v55, v119
    v_cvt_pk_bf16_f32 v123, v54, v55
    buffer_store_dwordx4 v[120:123], v1, s[8:11], s33 offen offset:1024 sc1
    s_nop 7
    v_mul_f32 v112, v16, v16
    v_fma_f32 v112, v112, v13, v12
    v_mul_f32 v112, v112, v16
    v_exp_f32 v112, v112
    v_mul_f32 v16, v16, v24
    v_mul_f32 v113, v17, v17
    v_fma_f32 v113, v113, v13, v12
    v_mul_f32 v113, v113, v17
    v_exp_f32 v113, v113
    v_mul_f32 v17, v17, v25
    buffer_load_dwordx4 v[168:171], v7, s[8:11], s79 offen offset:2048 sc1
    v_fma_f32 v112, v112, v14, v14
    v_rcp_f32 v112, v112
    v_mul_f32 v114, v18, v18
    v_fma_f32 v114, v114, v13, v12
    v_mul_f32 v114, v114, v18
    v_exp_f32 v114, v114
    v_mul_f32 v18, v18, v26
    v_fma_f32 v113, v113, v14, v14
    v_rcp_f32 v113, v113
    v_mul_f32 v115, v19, v19
    buffer_load_dwordx4 v[172:175], v10, s[8:11], s79 offen offset:2048 sc1
    v_mul_f32 v16, v16, v112
    v_fma_f32 v115, v115, v13, v12
    v_mul_f32 v115, v115, v19
    v_exp_f32 v115, v115
    v_mul_f32 v19, v19, v27
    v_fma_f32 v114, v114, v14, v14
    v_rcp_f32 v114, v114
    v_mul_f32 v116, v20, v20
    v_mul_f32 v17, v17, v113
    v_cvt_pk_bf16_f32 v120, v16, v17
    v_fma_f32 v116, v116, v13, v12
L_pad44288:
    s_cbranch_execz L_ret_p3s0
    v_mul_f32 v116, v116, v20
    v_exp_f32 v116, v116
    v_mul_f32 v20, v20, v28
    v_fma_f32 v115, v115, v14, v14
    v_rcp_f32 v115, v115
    buffer_load_dwordx4 v[176:179], v1, s[8:11], s78 offen offset:2048 sc1
    v_mul_f32 v117, v21, v21
    v_mul_f32 v18, v18, v114
    v_fma_f32 v117, v117, v13, v12
    v_mul_f32 v117, v117, v21
    v_exp_f32 v117, v117
    v_mul_f32 v21, v21, v29
    v_fma_f32 v116, v116, v14, v14
    v_rcp_f32 v116, v116
    v_mul_f32 v118, v22, v22
    v_mul_f32 v19, v19, v115
    v_cvt_pk_bf16_f32 v121, v18, v19
    buffer_load_dwordx4 v[180:183], v15, s[8:11], s78 offen offset:2048 sc1
    v_fma_f32 v118, v118, v13, v12
    v_mul_f32 v118, v118, v22
    v_exp_f32 v118, v118
    v_mul_f32 v22, v22, v30
    v_fma_f32 v117, v117, v14, v14
    v_rcp_f32 v117, v117
    v_mul_f32 v119, v23, v23
    v_mul_f32 v20, v20, v116
    v_fma_f32 v119, v119, v13, v12
    v_mul_f32 v119, v119, v23
    buffer_load_dwordx4 v[184:187], v7, s[8:11], s78 offen offset:2048 sc1
    v_exp_f32 v119, v119
    v_mul_f32 v23, v23, v31
    v_fma_f32 v118, v118, v14, v14
    v_rcp_f32 v118, v118
    v_mul_f32 v21, v21, v117
    v_cvt_pk_bf16_f32 v122, v20, v21
    v_fma_f32 v119, v119, v14, v14
    v_rcp_f32 v119, v119
    v_mul_f32 v22, v22, v118
    v_mul_f32 v23, v23, v119
    v_cvt_pk_bf16_f32 v123, v22, v23
    buffer_store_dwordx4 v[120:123], v1, s[8:11], s33 offen offset:2048 sc1
    v_mfma_f32_32x32x16_bf16 v[80:95], a[164:167], a[224:227], 0
    buffer_load_dwordx4 v[188:191], v10, s[8:11], s78 offen offset:2048 sc1
    s_xor_b32 s37, s3, 1
    s_mul_i32 s37, s37, 12288
    s_add_u32 s37, s37, 65536
    v_mfma_f32_32x32x16_bf16 v[64:79], a[160:163], a[224:227], 0
    v_add_u32 v114, s37, v1
    s_xor_b32 s37, s3, 2
    s_mul_i32 s37, s37, 12288
    v_mfma_f32_32x32x16_bf16 v[80:95], a[172:175], a[228:231], v[80:95]
    s_add_u32 s37, s37, 69632
    v_add_u32 v8, s37, v1
    s_xor_b32 s37, s3, 3
    v_mfma_f32_32x32x16_bf16 v[64:79], a[168:171], a[228:231], v[64:79]
    s_add_u32 s56, s36, 0x2352000
    s_load_dword s94, s[4:5], s56 glc
    s_mul_i32 s37, s37, 12288
    s_add_u32 s37, s37, 73728
    v_add_u32 v9, s37, v1
    v_mfma_f32_32x32x16_bf16 v[80:95], a[180:183], a[232:235], v[80:95]
    s_mul_i32 s37, s3, 12288
    s_add_u32 s37, s37, 65536
    v_add_u32 v115, s37, v1
    v_mfma_f32_32x32x16_bf16 v[64:79], a[176:179], a[232:235], v[64:79]
    buffer_load_dwordx4 v[96:99], v6, s[8:11], s85 offen sc1
    buffer_load_dwordx4 v[100:103], v6, s[8:11], s85 offen offset:512 sc1
    v_mfma_f32_32x32x16_bf16 v[80:95], a[188:191], a[236:239], v[80:95]
    v_mfma_f32_32x32x16_bf16 v[64:79], a[184:187], a[236:239], v[64:79]
    s_add_u32 s38, s35, 0x2362000
    v_mov_b32 v3, 1
    s_waitcnt vmcnt(9)
    s_mov_b64 exec, 1
    buffer_atomic_add v3, off, s[8:11], s38 sc1
    s_mov_b64 exec, -1
    v_mfma_f32_32x32x16_bf16 v[80:95], a[196:199], a[240:243], v[80:95]
    v_mfma_f32_32x32x16_bf16 v[64:79], a[192:195], a[240:243], v[64:79]
    v_mfma_f32_32x32x16_bf16 v[80:95], a[204:207], a[244:247], v[80:95]
    v_mfma_f32_32x32x16_bf16 v[64:79], a[200:203], a[244:247], v[64:79]
    v_mfma_f32_32x32x16_bf16 v[80:95], a[212:215], a[248:251], v[80:95]
    v_mfma_f32_32x32x16_bf16 v[64:79], a[208:211], a[248:251], v[64:79]
    v_mfma_f32_32x32x16_bf16 v[80:95], a[220:223], a[252:255], v[80:95]
    v_mfma_f32_32x32x16_bf16 v[64:79], a[216:219], a[252:255], v[64:79]
    v_mfma_f32_32x32x16_bf16 v[48:63], a[164:167], v[128:131], 0
    v_mfma_f32_32x32x16_bf16 v[32:47], a[160:163], v[128:131], 0
    v_mfma_f32_32x32x16_bf16 v[48:63], a[172:175], v[132:135], v[48:63]
    v_mfma_f32_32x32x16_bf16 v[32:47], a[168:171], v[132:135], v[32:47]
    s_add_u32 s56, s36, 0x2352000
    s_waitcnt lgkmcnt(0)
    s_mov_b32 s57, 100000
    s_cmp_eq_u32 s94, 8
    s_cbranch_scc1 L_pc_ok79
L_pc79:
    s_load_dword s94, s[4:5], s56 glc
    s_sub_u32 s57, s57, 1
    s_cbranch_scc1 L_pc_ok79
    s_waitcnt lgkmcnt(0)
    s_cmp_lg_u32 s94, 8
    s_cbranch_scc1 L_pc79
L_pc_ok79:
    buffer_load_dwordx4 v[128:131], v1, s[8:11], s79 offen offset:3072 sc1
    v_mfma_f32_32x32x16_bf16 v[48:63], a[180:183], v[136:139], v[48:63]
    s_add_u32 s38, s35, 0x236a000
    v_mov_b32 v3, 1
    s_waitcnt vmcnt(5)
    s_mov_b64 exec, 1
    buffer_atomic_add v3, off, s[8:11], s38 sc1
    s_mov_b64 exec, -1
    v_mfma_f32_32x32x16_bf16 v[32:47], a[176:179], v[136:139], v[32:47]
    buffer_load_dwordx4 v[132:135], v15, s[8:11], s79 offen offset:3072 sc1
    v_mfma_f32_32x32x16_bf16 v[48:63], a[188:191], v[140:143], v[48:63]
    s_add_u32 s56, s36, 0x235a000
    s_load_dword s95, s[4:5], s56 glc
    v_mfma_f32_32x32x16_bf16 v[32:47], a[184:187], v[140:143], v[32:47]
    v_mfma_f32_32x32x16_bf16 v[48:63], a[196:199], v[144:147], v[48:63]
    buffer_load_dwordx4 v[136:139], v7, s[8:11], s79 offen offset:3072 sc1
    v_mfma_f32_32x32x16_bf16 v[32:47], a[192:195], v[144:147], v[32:47]
    v_mfma_f32_32x32x16_bf16 v[48:63], a[204:207], v[148:151], v[48:63]
    buffer_load_dwordx4 v[140:143], v10, s[8:11], s79 offen offset:3072 sc1
    v_mfma_f32_32x32x16_bf16 v[32:47], a[200:203], v[148:151], v[32:47]
    v_mfma_f32_32x32x16_bf16 v[48:63], a[212:215], v[152:155], v[48:63]
    v_mfma_f32_32x32x16_bf16 v[32:47], a[208:211], v[152:155], v[32:47]
    buffer_load_dwordx4 v[144:147], v1, s[8:11], s78 offen offset:3072 sc1
    v_mfma_f32_32x32x16_bf16 v[48:63], a[220:223], v[156:159], v[48:63]
    v_mfma_f32_32x32x16_bf16 v[32:47], a[216:219], v[156:159], v[32:47]
    buffer_load_dwordx4 v[148:151], v15, s[8:11], s78 offen offset:3072 sc1
    v_mfma_f32_32x32x16_bf16 v[80:95], a[4:7], v[160:163], v[80:95]
    v_mfma_f32_32x32x16_bf16 v[64:79], a[0:3], v[160:163], v[64:79]
    buffer_load_dwordx4 v[152:155], v7, s[8:11], s78 offen offset:3072 sc1
    v_mfma_f32_32x32x16_bf16 v[80:95], a[12:15], v[164:167], v[80:95]
    v_mfma_f32_32x32x16_bf16 v[64:79], a[8:11], v[164:167], v[64:79]
    v_mfma_f32_32x32x16_bf16 v[80:95], a[20:23], v[168:171], v[80:95]
    buffer_load_dwordx4 v[156:159], v10, s[8:11], s78 offen offset:3072 sc1
    v_mfma_f32_32x32x16_bf16 v[64:79], a[16:19], v[168:171], v[64:79]
    v_mfma_f32_32x32x16_bf16 v[80:95], a[28:31], v[172:175], v[80:95]
    s_add_u32 s56, s36, 0x235a000
    s_waitcnt lgkmcnt(0)
    s_mov_b32 s57, 100000
    s_cmp_eq_u32 s95, 8
    s_cbranch_scc1 L_pc_ok80
L_pc80:
    s_load_dword s95, s[4:5], s56 glc
    s_sub_u32 s57, s57, 1
    s_cbranch_scc1 L_pc_ok80
    s_waitcnt lgkmcnt(0)
    s_cmp_lg_u32 s95, 8
    s_cbranch_scc1 L_pc80
L_pc_ok80:
    buffer_load_dwordx4 v[160:163], v1, s[8:11], s81 offen offset:0 sc1
    v_mfma_f32_32x32x16_bf16 v[64:79], a[24:27], v[172:175], v[64:79]
    v_mfma_f32_32x32x16_bf16 v[48:63], a[4:7], v[176:179], v[48:63]
    v_mfma_f32_32x32x16_bf16 v[32:47], a[0:3], v[176:179], v[32:47]
    buffer_load_dwordx4 v[164:167], v15, s[8:11], s81 offen offset:0 sc1
    s_add_u32 s56, s36, 0x2362000
    s_load_dword s96, s[4:5], s56 glc
    v_mfma_f32_32x32x16_bf16 v[48:63], a[12:15], v[180:183], v[48:63]
    v_mfma_f32_32x32x16_bf16 v[32:47], a[8:11], v[180:183], v[32:47]
    buffer_load_dwordx4 v[168:171], v7, s[8:11], s81 offen offset:0 sc1
    v_mfma_f32_32x32x16_bf16 v[48:63], a[20:23], v[184:187], v[48:63]
    v_mfma_f32_32x32x16_bf16 v[32:47], a[16:19], v[184:187], v[32:47]
    buffer_load_dwordx4 v[172:175], v10, s[8:11], s81 offen offset:0 sc1
    s_waitcnt vmcnt(16)
    v_mfma_f32_32x32x16_bf16 v[48:63], a[28:31], v[188:191], v[48:63]
    v_mfma_f32_32x32x16_bf16 v[32:47], a[24:27], v[188:191], v[32:47]
    s_waitcnt vmcnt(12)
    v_mfma_f32_32x32x16_bf16 v[80:95], a[36:39], v[128:131], v[80:95]
    buffer_load_dwordx4 v[176:179], v1, s[8:11], s80 offen offset:0 sc1
    v_mfma_f32_32x32x16_bf16 v[64:79], a[32:35], v[128:131], v[64:79]
    s_waitcnt vmcnt(11)
    v_mfma_f32_32x32x16_bf16 v[80:95], a[44:47], v[132:135], v[80:95]
    buffer_load_dwordx4 v[180:183], v15, s[8:11], s80 offen offset:0 sc1
    v_mfma_f32_32x32x16_bf16 v[64:79], a[40:43], v[132:135], v[64:79]
    s_waitcnt vmcnt(11)
    v_mfma_f32_32x32x16_bf16 v[80:95], a[52:55], v[136:139], v[80:95]
    v_mfma_f32_32x32x16_bf16 v[64:79], a[48:51], v[136:139], v[64:79]
    buffer_load_dwordx4 v[184:187], v7, s[8:11], s80 offen offset:0 sc1
    s_waitcnt vmcnt(11)
    v_mfma_f32_32x32x16_bf16 v[80:95], a[60:63], v[140:143], v[80:95]
    v_mfma_f32_32x32x16_bf16 v[64:79], a[56:59], v[140:143], v[64:79]
    buffer_load_dwordx4 v[188:191], v10, s[8:11], s80 offen offset:0 sc1
    s_waitcnt vmcnt(11)
    v_mfma_f32_32x32x16_bf16 v[48:63], a[36:39], v[144:147], v[48:63]
    v_mfma_f32_32x32x16_bf16 v[32:47], a[32:35], v[144:147], v[32:47]
    s_add_u32 s56, s36, 0x2362000
    s_waitcnt lgkmcnt(0)
    s_mov_b32 s57, 100000
    s_cmp_eq_u32 s96, 8
    s_cbranch_scc1 L_pc_ok81
L_pc81:
    s_load_dword s96, s[4:5], s56 glc
    s_sub_u32 s57, s57, 1
    s_cbranch_scc1 L_pc_ok81
    s_waitcnt lgkmcnt(0)
    s_cmp_lg_u32 s96, 8
    s_cbranch_scc1 L_pc81
L_pc_ok81:
    buffer_load_dwordx4 v[128:131], v1, s[8:11], s81 offen offset:1024 sc1
    s_waitcnt vmcnt(11)
    v_mfma_f32_32x32x16_bf16 v[48:63], a[44:47], v[148:151], v[48:63]
    v_mfma_f32_32x32x16_bf16 v[32:47], a[40:43], v[148:151], v[32:47]
    s_waitcnt vmcnt(10)
    v_mfma_f32_32x32x16_bf16 v[48:63], a[52:55], v[152:155], v[48:63]
    buffer_load_dwordx4 v[132:135], v15, s[8:11], s81 offen offset:1024 sc1
    v_mfma_f32_32x32x16_bf16 v[32:47], a[48:51], v[152:155], v[32:47]
    s_add_u32 s56, s36, 0x236a000
    s_load_dword s97, s[4:5], s56 glc
    s_waitcnt vmcnt(10)
    v_mfma_f32_32x32x16_bf16 v[48:63], a[60:63], v[156:159], v[48:63]
    buffer_load_dwordx4 v[136:139], v7, s[8:11], s81 offen offset:1024 sc1
    v_max_u32 v112, v96, v100
    v_cmp_eq_u32 vcc, -1, v112
    v_mfma_f32_32x32x16_bf16 v[32:47], a[56:59], v[156:159], v[32:47]
    s_cbranch_vccnz L_fix83
L_back83:
    s_waitcnt vmcnt(10)
    v_mfma_f32_32x32x16_bf16 v[80:95], a[68:71], v[160:163], v[80:95]
    v_lshlrev_b32 v112, 16, v96
    s_nop 7
    v_add_f32 v32, v32, v112
    v_and_b32 v112, 0xffff0000, v96
    v_add_f32 v33, v33, v112
    v_mfma_f32_32x32x16_bf16 v[64:79], a[64:67], v[160:163], v[64:79]
    buffer_load_dwordx4 v[140:143], v10, s[8:11], s81 offen offset:1024 sc1
    v_lshlrev_b32 v113, 16, v97
    v_add_f32 v34, v34, v113
    v_and_b32 v113, 0xffff0000, v97
    v_add_f32 v35, v35, v113
    v_lshlrev_b32 v112, 16, v98
    s_waitcnt vmcnt(10)
    v_mfma_f32_32x32x16_bf16 v[80:95], a[76:79], v[164:167], v[80:95]
    v_add_f32 v36, v36, v112
    v_and_b32 v112, 0xffff0000, v98
    v_add_f32 v37, v37, v112
    v_lshlrev_b32 v113, 16, v99
    v_mfma_f32_32x32x16_bf16 v[64:79], a[72:75], v[164:167], v[64:79]
    buffer_load_dwordx4 v[144:147], v1, s[8:11], s80 offen offset:1024 sc1
    v_add_f32 v38, v38, v113
    v_and_b32 v113, 0xffff0000, v99
    v_add_f32 v39, v39, v113
    v_lshlrev_b32 v112, 16, v100
    v_add_f32 v40, v40, v112
    s_waitcnt vmcnt(10)
    v_mfma_f32_32x32x16_bf16 v[80:95], a[84:87], v[168:171], v[80:95]
    v_and_b32 v112, 0xffff0000, v100
    v_add_f32 v41, v41, v112
    v_lshlrev_b32 v113, 16, v101
    v_add_f32 v42, v42, v113
    v_mfma_f32_32x32x16_bf16 v[64:79], a[80:83], v[168:171], v[64:79]
    buffer_load_dwordx4 v[148:151], v15, s[8:11], s80 offen offset:1024 sc1
    v_and_b32 v113, 0xffff0000, v101
    v_add_f32 v43, v43, v113
    v_lshlrev_b32 v112, 16, v102
    v_add_f32 v44, v44, v112
    v_and_b32 v112, 0xffff0000, v102
    s_waitcnt vmcnt(10)
    v_mfma_f32_32x32x16_bf16 v[80:95], a[92:95], v[172:175], v[80:95]
    v_add_f32 v45, v45, v112
    v_lshlrev_b32 v113, 16, v103
    v_add_f32 v46, v46, v113
    v_and_b32 v113, 0xffff0000, v103
    v_add_f32 v47, v47, v113
    v_mfma_f32_32x32x16_bf16 v[64:79], a[88:91], v[172:175], v[64:79]
    s_waitcnt vmcnt(9)
    v_mfma_f32_32x32x16_bf16 v[48:63], a[68:71], v[176:179], v[48:63]
    buffer_load_dwordx4 v[152:155], v7, s[8:11], s80 offen offset:1024 sc1
    v_mfma_f32_32x32x16_bf16 v[32:47], a[64:67], v[176:179], v[32:47]
    s_waitcnt vmcnt(9)
    v_mfma_f32_32x32x16_bf16 v[48:63], a[76:79], v[180:183], v[48:63]
    buffer_load_dwordx4 v[156:159], v10, s[8:11], s80 offen offset:1024 sc1
    v_mfma_f32_32x32x16_bf16 v[32:47], a[72:75], v[180:183], v[32:47]
    s_waitcnt vmcnt(9)
    v_mfma_f32_32x32x16_bf16 v[48:63], a[84:87], v[184:187], v[48:63]
    v_mfma_f32_32x32x16_bf16 v[32:47], a[80:83], v[184:187], v[32:47]
    s_add_u32 s56, s36, 0x236a000
    s_waitcnt lgkmcnt(0)
    s_mov_b32 s57, 100000
    s_cmp_eq_u32 s97, 8
    s_cbranch_scc1 L_pc_ok82
L_pc82:
    s_load_dword s97, s[4:5], s56 glc
    s_sub_u32 s57, s57, 1
    s_cbranch_scc1 L_pc_ok82
    s_waitcnt lgkmcnt(0)
    s_cmp_lg_u32 s97, 8
    s_cbranch_scc1 L_pc82
L_pc_ok82:
    buffer_load_dwordx4 v[160:163], v1, s[8:11], s81 offen offset:2048 sc1
    s_waitcnt vmcnt(9)
    v_mfma_f32_32x32x16_bf16 v[48:63], a[92:95], v[188:191], v[48:63]
    v_mfma_f32_32x32x16_bf16 v[32:47], a[88:91], v[188:191], v[32:47]
    buffer_load_dwordx4 v[164:167], v15, s[8:11], s81 offen offset:2048 sc1
    s_waitcnt vmcnt(9)
    v_mfma_f32_32x32x16_bf16 v[80:95], a[100:103], v[128:131], v[80:95]
    v_mfma_f32_32x32x16_bf16 v[64:79], a[96:99], v[128:131], v[64:79]
    buffer_load_dwordx4 v[168:171], v7, s[8:11], s81 offen offset:2048 sc1
    s_waitcnt vmcnt(9)
    v_mfma_f32_32x32x16_bf16 v[80:95], a[108:111], v[132:135], v[80:95]
    v_mfma_f32_32x32x16_bf16 v[64:79], a[104:107], v[132:135], v[64:79]
    s_waitcnt vmcnt(8)
    v_mfma_f32_32x32x16_bf16 v[80:95], a[116:119], v[136:139], v[80:95]
    buffer_load_dwordx4 v[172:175], v10, s[8:11], s81 offen offset:2048 sc1
    v_mfma_f32_32x32x16_bf16 v[64:79], a[112:115], v[136:139], v[64:79]
    s_waitcnt vmcnt(8)
    v_mfma_f32_32x32x16_bf16 v[80:95], a[124:127], v[140:143], v[80:95]
    buffer_load_dwordx4 v[176:179], v1, s[8:11], s80 offen offset:2048 sc1
    v_mfma_f32_32x32x16_bf16 v[64:79], a[120:123], v[140:143], v[64:79]
    s_waitcnt vmcnt(8)
    v_mfma_f32_32x32x16_bf16 v[48:63], a[100:103], v[144:147], v[48:63]
    v_mfma_f32_32x32x16_bf16 v[32:47], a[96:99], v[144:147], v[32:47]
    buffer_load_dwordx4 v[180:183], v15, s[8:11], s80 offen offset:2048 sc1
    s_waitcnt vmcnt(8)
    v_mfma_f32_32x32x16_bf16 v[48:63], a[108:111], v[148:151], v[48:63]
    v_mfma_f32_32x32x16_bf16 v[32:47], a[104:107], v[148:151], v[32:47]
    buffer_load_dwordx4 v[184:187], v7, s[8:11], s80 offen offset:2048 sc1
    s_waitcnt vmcnt(8)
    v_mfma_f32_32x32x16_bf16 v[48:63], a[116:119], v[152:155], v[48:63]
    v_mfma_f32_32x32x16_bf16 v[32:47], a[112:115], v[152:155], v[32:47]
    buffer_load_dwordx4 v[188:191], v10, s[8:11], s80 offen offset:2048 sc1
    s_waitcnt vmcnt(8)
    v_mfma_f32_32x32x16_bf16 v[48:63], a[124:127], v[156:159], v[48:63]
    v_mfma_f32_32x32x16_bf16 v[32:47], a[120:123], v[156:159], v[32:47]
    s_waitcnt vmcnt(7)
    v_mfma_f32_32x32x16_bf16 v[80:95], a[132:135], v[160:163], v[80:95]
    v_mfma_f32_32x32x16_bf16 v[64:79], a[128:131], v[160:163], v[64:79]
    s_waitcnt vmcnt(6)
    v_mfma_f32_32x32x16_bf16 v[80:95], a[140:143], v[164:167], v[80:95]
    v_mfma_f32_32x32x16_bf16 v[64:79], a[136:139], v[164:167], v[64:79]
    s_waitcnt vmcnt(5)
    v_mfma_f32_32x32x16_bf16 v[80:95], a[148:151], v[168:171], v[80:95]
    v_mfma_f32_32x32x16_bf16 v[64:79], a[144:147], v[168:171], v[64:79]
    s_waitcnt vmcnt(4)
    v_mfma_f32_32x32x16_bf16 v[80:95], a[156:159], v[172:175], v[80:95]
    v_mfma_f32_32x32x16_bf16 v[64:79], a[152:155], v[172:175], v[64:79]
    s_waitcnt vmcnt(3)
    v_mfma_f32_32x32x16_bf16 v[48:63], a[132:135], v[176:179], v[48:63]
    s_nop 8
    ds_write_b128 v9, v[80:83] offset:0
    s_waitcnt vmcnt(2)
    v_mfma_f32_32x32x16_bf16 v[48:63], a[140:143], v[180:183], v[48:63]
    ds_write_b128 v9, v[84:87] offset:1024
    s_waitcnt vmcnt(1)
    v_mfma_f32_32x32x16_bf16 v[48:63], a[148:151], v[184:187], v[48:63]
    ds_write_b128 v9, v[88:91] offset:2048
    s_waitcnt vmcnt(0)
    v_mfma_f32_32x32x16_bf16 v[48:63], a[156:159], v[188:191], v[48:63]
    ds_write_b128 v9, v[92:95] offset:3072
    v_mfma_f32_32x32x16_bf16 v[32:47], a[128:131], v[176:179], v[32:47]
    ds_write_b128 v8, v[64:67] offset:0
    v_mfma_f32_32x32x16_bf16 v[32:47], a[136:139], v[180:183], v[32:47]
    ds_write_b128 v8, v[68:71] offset:1024
    v_mfma_f32_32x32x16_bf16 v[32:47], a[144:147], v[184:187], v[32:47]
    ds_write_b128 v8, v[72:75] offset:2048
    v_mfma_f32_32x32x16_bf16 v[32:47], a[152:155], v[188:191], v[32:47]
    ds_write_b128 v8, v[76:79] offset:3072
    s_nop 2
    ds_write_b128 v114, v[48:51] offset:0
    ds_write_b128 v114, v[52:55] offset:1024
    ds_write_b128 v114, v[56:59] offset:2048
    ds_write_b128 v114, v[60:63] offset:3072
    s_waitcnt lgkmcnt(0)
    s_barrier
    ds_read_b128 v[128:131], v115 offset:0
    ds_read_b128 v[132:135], v115 offset:1024
    ds_read_b128 v[136:139], v115 offset:2048
    ds_read_b128 v[140:143], v115 offset:3072
    ds_read_b128 v[144:147], v115 offset:4096
    ds_read_b128 v[148:151], v115 offset:5120
    ds_read_b128 v[152:155], v115 offset:6144
    ds_read_b128 v[156:159], v115 offset:7168
    ds_read_b128 v[160:163], v115 offset:8192
    ds_read_b128 v[164:167], v115 offset:9216
    ds_read_b128 v[168:171], v115 offset:10240
    ds_read_b128 v[172:175], v115 offset:11264
    s_waitcnt lgkmcnt(11)
    v_pk_add_f32 v[32:33], v[32:33], v[128:129]
    v_pk_add_f32 v[34:35], v[34:35], v[130:131]
    s_waitcnt lgkmcnt(10)
    v_pk_add_f32 v[36:37], v[36:37], v[132:133]
    v_pk_add_f32 v[38:39], v[38:39], v[134:135]
    s_waitcnt lgkmcnt(9)
    v_pk_add_f32 v[40:41], v[40:41], v[136:137]
    v_pk_add_f32 v[42:43], v[42:43], v[138:139]
    s_waitcnt lgkmcnt(8)
    v_pk_add_f32 v[44:45], v[44:45], v[140:141]
    v_pk_add_f32 v[46:47], v[46:47], v[142:143]
    s_waitcnt lgkmcnt(7)
    v_pk_add_f32 v[32:33], v[32:33], v[144:145]
    v_pk_add_f32 v[34:35], v[34:35], v[146:147]
    s_waitcnt lgkmcnt(6)
    v_pk_add_f32 v[36:37], v[36:37], v[148:149]
    v_pk_add_f32 v[38:39], v[38:39], v[150:151]
    s_waitcnt lgkmcnt(5)
    v_pk_add_f32 v[40:41], v[40:41], v[152:153]
    v_pk_add_f32 v[42:43], v[42:43], v[154:155]
    s_waitcnt lgkmcnt(4)
    v_pk_add_f32 v[44:45], v[44:45], v[156:157]
    v_pk_add_f32 v[46:47], v[46:47], v[158:159]
    s_waitcnt lgkmcnt(3)
    v_pk_add_f32 v[32:33], v[32:33], v[160:161]
    v_pk_add_f32 v[34:35], v[34:35], v[162:163]
    s_waitcnt lgkmcnt(2)
    v_pk_add_f32 v[36:37], v[36:37], v[164:165]
    v_pk_add_f32 v[38:39], v[38:39], v[166:167]
    s_waitcnt lgkmcnt(1)
    v_pk_add_f32 v[40:41], v[40:41], v[168:169]
    v_pk_add_f32 v[42:43], v[42:43], v[170:171]
    s_waitcnt lgkmcnt(0)
    v_pk_add_f32 v[44:45], v[44:45], v[172:173]
    v_pk_add_f32 v[46:47], v[46:47], v[174:175]
    v_cvt_pk_bf16_f32 v104, v32, v33
    v_cvt_pk_bf16_f32 v105, v34, v35
    v_cvt_pk_bf16_f32 v106, v36, v37
    v_cvt_pk_bf16_f32 v107, v38, v39
    v_cvt_pk_bf16_f32 v108, v40, v41
    v_cvt_pk_bf16_f32 v109, v42, v43
    v_cvt_pk_bf16_f32 v110, v44, v45
    v_cvt_pk_bf16_f32 v111, v46, v47
    v_lshlrev_b32 v7, 4, v5
    v_lshl_add_u32 v7, v4, 10, v7
    s_lshl_b32 s32, s82, 15
    s_lshl_b32 s33, s83, 6
    s_add_u32 s32, s32, s33
    v_permlane32_swap_b32 v104, v108
    v_permlane32_swap_b32 v105, v109
    v_permlane32_swap_b32 v106, v110
    v_permlane32_swap_b32 v107, v111
    buffer_store_dwordx4 v[104:107], v7, s[12:15], s32 offen
    buffer_store_dwordx4 v[108:111], v7, s[12:15], s32 offen offset:32
L_pad48384:
    s_cbranch_execz L_ret_p3s0
L_end_interleave_layers__sliding_local_dilated__glu_gated_geglu__prompt_kernel:
    s_endpgm
L_fix25:
    s_mov_b32 s57, 4096
L_fixl25:
    s_add_u32 s56, s67, 0
    buffer_load_dwordx4 v[28:31], v7, s[8:11], s56 offen offset:0 sc1
    s_waitcnt vmcnt(0)
    v_cmp_eq_u32 vcc, -1, v28
    s_sub_u32 s57, s57, 1
    s_cbranch_scc1 L_back25
    s_cbranch_vccnz L_fixl25
    s_branch L_back25
L_fix26:
    s_mov_b32 s57, 4096
L_fixl26:
    s_add_u32 s56, s67, 0
    buffer_load_dwordx4 v[32:35], v7, s[8:11], s56 offen offset:2048 sc1
    s_waitcnt vmcnt(0)
    v_cmp_eq_u32 vcc, -1, v32
    s_sub_u32 s57, s57, 1
    s_cbranch_scc1 L_back26
    s_cbranch_vccnz L_fixl26
    s_branch L_back26
L_fix27:
    s_mov_b32 s57, 4096
L_fixl27:
    s_add_u32 s56, s67, 4096
    buffer_load_dwordx4 v[36:39], v7, s[8:11], s56 offen offset:0 sc1
    s_waitcnt vmcnt(0)
    v_cmp_eq_u32 vcc, -1, v36
    s_sub_u32 s57, s57, 1
    s_cbranch_scc1 L_back27
    s_cbranch_vccnz L_fixl27
    s_branch L_back27
L_fix28:
    s_mov_b32 s57, 4096
L_fixl28:
    s_add_u32 s56, s67, 4096
    buffer_load_dwordx4 v[40:43], v7, s[8:11], s56 offen offset:2048 sc1
    s_waitcnt vmcnt(0)
    v_cmp_eq_u32 vcc, -1, v40
    s_sub_u32 s57, s57, 1
    s_cbranch_scc1 L_back28
    s_cbranch_vccnz L_fixl28
    s_branch L_back28
L_fix29:
    s_mov_b32 s57, 4096
L_fixl29:
    s_add_u32 s56, s67, 8192
    buffer_load_dwordx4 v[44:47], v7, s[8:11], s56 offen offset:0 sc1
    s_waitcnt vmcnt(0)
    v_cmp_eq_u32 vcc, -1, v44
    s_sub_u32 s57, s57, 1
    s_cbranch_scc1 L_back29
    s_cbranch_vccnz L_fixl29
    s_branch L_back29
L_fix30:
    s_mov_b32 s57, 4096
L_fixl30:
    s_add_u32 s56, s67, 8192
    buffer_load_dwordx4 v[48:51], v7, s[8:11], s56 offen offset:2048 sc1
    s_waitcnt vmcnt(0)
    v_cmp_eq_u32 vcc, -1, v48
    s_sub_u32 s57, s57, 1
    s_cbranch_scc1 L_back30
    s_cbranch_vccnz L_fixl30
    s_branch L_back30
L_fix31:
    s_mov_b32 s57, 4096
L_fixl31:
    s_add_u32 s56, s67, 12288
    buffer_load_dwordx4 v[52:55], v7, s[8:11], s56 offen offset:0 sc1
    s_waitcnt vmcnt(0)
    v_cmp_eq_u32 vcc, -1, v52
    s_sub_u32 s57, s57, 1
    s_cbranch_scc1 L_back31
    s_cbranch_vccnz L_fixl31
    s_branch L_back31
L_fix32:
    s_mov_b32 s57, 4096
L_fixl32:
    s_add_u32 s56, s67, 12288
    buffer_load_dwordx4 v[56:59], v7, s[8:11], s56 offen offset:2048 sc1
    s_waitcnt vmcnt(0)
    v_cmp_eq_u32 vcc, -1, v56
    s_sub_u32 s57, s57, 1
    s_cbranch_scc1 L_back32
    s_cbranch_vccnz L_fixl32
    s_branch L_back32
L_fix33:
    s_mov_b32 s57, 4096
L_fixl33:
    s_add_u32 s56, s67, 16384
    buffer_load_dwordx4 v[60:63], v7, s[8:11], s56 offen offset:0 sc1
    s_waitcnt vmcnt(0)
    v_cmp_eq_u32 vcc, -1, v60
    s_sub_u32 s57, s57, 1
    s_cbranch_scc1 L_back33
    s_cbranch_vccnz L_fixl33
    s_branch L_back33
L_fix34:
    s_mov_b32 s57, 4096
L_fixl34:
    s_add_u32 s56, s67, 16384
    buffer_load_dwordx4 v[64:67], v7, s[8:11], s56 offen offset:2048 sc1
    s_waitcnt vmcnt(0)
    v_cmp_eq_u32 vcc, -1, v64
    s_sub_u32 s57, s57, 1
    s_cbranch_scc1 L_back34
    s_cbranch_vccnz L_fixl34
    s_branch L_back34
L_fix35:
    s_mov_b32 s57, 4096
L_fixl35:
    s_add_u32 s56, s67, 20480
    buffer_load_dwordx4 v[68:71], v7, s[8:11], s56 offen offset:0 sc1
    s_waitcnt vmcnt(0)
    v_cmp_eq_u32 vcc, -1, v68
    s_sub_u32 s57, s57, 1
    s_cbranch_scc1 L_back35
    s_cbranch_vccnz L_fixl35
    s_branch L_back35
L_fix36:
    s_mov_b32 s57, 4096
L_fixl36:
    s_add_u32 s56, s67, 20480
    buffer_load_dwordx4 v[72:75], v7, s[8:11], s56 offen offset:2048 sc1
    s_waitcnt vmcnt(0)
    v_cmp_eq_u32 vcc, -1, v72
    s_sub_u32 s57, s57, 1
    s_cbranch_scc1 L_back36
    s_cbranch_vccnz L_fixl36
    s_branch L_back36
L_fix37:
    s_mov_b32 s57, 4096
L_fixl37:
    s_add_u32 s56, s67, 24576
    buffer_load_dwordx4 v[76:79], v7, s[8:11], s56 offen offset:0 sc1
    s_waitcnt vmcnt(0)
    v_cmp_eq_u32 vcc, -1, v76
    s_sub_u32 s57, s57, 1
    s_cbranch_scc1 L_back37
    s_cbranch_vccnz L_fixl37
    s_branch L_back37
L_fix38:
    s_mov_b32 s57, 4096
L_fixl38:
    s_add_u32 s56, s67, 24576
    buffer_load_dwordx4 v[80:83], v7, s[8:11], s56 offen offset:2048 sc1
    s_waitcnt vmcnt(0)
    v_cmp_eq_u32 vcc, -1, v80
    s_sub_u32 s57, s57, 1
    s_cbranch_scc1 L_back38
    s_cbranch_vccnz L_fixl38
    s_branch L_back38
L_fix39:
    s_mov_b32 s57, 4096
L_fixl39:
    s_add_u32 s56, s67, 28672
    buffer_load_dwordx4 v[84:87], v7, s[8:11], s56 offen offset:0 sc1
    s_waitcnt vmcnt(0)
    v_cmp_eq_u32 vcc, -1, v84
    s_sub_u32 s57, s57, 1
    s_cbranch_scc1 L_back39
    s_cbranch_vccnz L_fixl39
    s_branch L_back39
L_fix40:
    s_mov_b32 s57, 4096
L_fixl40:
    s_add_u32 s56, s67, 28672
    buffer_load_dwordx4 v[88:91], v7, s[8:11], s56 offen offset:2048 sc1
    s_waitcnt vmcnt(0)
    v_cmp_eq_u32 vcc, -1, v88
    s_sub_u32 s57, s57, 1
    s_cbranch_scc1 L_back40
    s_cbranch_vccnz L_fixl40
    s_branch L_back40
L_fix44:
    s_mov_b32 s57, 4096
L_fixl44:
    s_add_u32 s56, s67, 0
    buffer_load_dwordx4 v[128:131], v1, s[8:11], s56 offen offset:0 sc1
    s_waitcnt vmcnt(0)
    v_cmp_eq_u32 vcc, -1, v128
    s_sub_u32 s57, s57, 1
    s_cbranch_scc1 L_back44
    s_cbranch_vccnz L_fixl44
    s_branch L_back44
L_fix45:
    s_mov_b32 s57, 4096
L_fixl45:
    s_add_u32 s56, s67, 0
    buffer_load_dwordx4 v[132:135], v1, s[8:11], s56 offen offset:1024 sc1
    s_waitcnt vmcnt(0)
    v_cmp_eq_u32 vcc, -1, v132
    s_sub_u32 s57, s57, 1
    s_cbranch_scc1 L_back45
    s_cbranch_vccnz L_fixl45
    s_branch L_back45
L_fix46:
    s_mov_b32 s57, 4096
L_fixl46:
    s_add_u32 s56, s67, 0
    buffer_load_dwordx4 v[136:139], v1, s[8:11], s56 offen offset:2048 sc1
    s_waitcnt vmcnt(0)
    v_cmp_eq_u32 vcc, -1, v136
    s_sub_u32 s57, s57, 1
    s_cbranch_scc1 L_back46
    s_cbranch_vccnz L_fixl46
    s_branch L_back46
L_fix47:
    s_mov_b32 s57, 4096
L_fixl47:
    s_add_u32 s56, s67, 0
    buffer_load_dwordx4 v[140:143], v1, s[8:11], s56 offen offset:3072 sc1
    s_waitcnt vmcnt(0)
    v_cmp_eq_u32 vcc, -1, v140
    s_sub_u32 s57, s57, 1
    s_cbranch_scc1 L_back47
    s_cbranch_vccnz L_fixl47
    s_branch L_back47
L_fix48:
    s_mov_b32 s57, 4096
L_fixl48:
    s_add_u32 s56, s67, 4096
    buffer_load_dwordx4 v[144:147], v1, s[8:11], s56 offen offset:0 sc1
    s_waitcnt vmcnt(0)
    v_cmp_eq_u32 vcc, -1, v144
    s_sub_u32 s57, s57, 1
    s_cbranch_scc1 L_back48
    s_cbranch_vccnz L_fixl48
    s_branch L_back48
L_fix49:
    s_mov_b32 s57, 4096
L_fixl49:
    s_add_u32 s56, s67, 4096
    buffer_load_dwordx4 v[148:151], v1, s[8:11], s56 offen offset:1024 sc1
    s_waitcnt vmcnt(0)
    v_cmp_eq_u32 vcc, -1, v148
    s_sub_u32 s57, s57, 1
    s_cbranch_scc1 L_back49
    s_cbranch_vccnz L_fixl49
    s_branch L_back49
L_fix50:
    s_mov_b32 s57, 4096
L_fixl50:
    s_add_u32 s56, s67, 4096
    buffer_load_dwordx4 v[152:155], v1, s[8:11], s56 offen offset:2048 sc1
    s_waitcnt vmcnt(0)
    v_cmp_eq_u32 vcc, -1, v152
    s_sub_u32 s57, s57, 1
    s_cbranch_scc1 L_back50
    s_cbranch_vccnz L_fixl50
    s_branch L_back50
L_fix51:
    s_mov_b32 s57, 4096
L_fixl51:
    s_add_u32 s56, s67, 4096
    buffer_load_dwordx4 v[156:159], v1, s[8:11], s56 offen offset:3072 sc1
    s_waitcnt vmcnt(0)
    v_cmp_eq_u32 vcc, -1, v156
    s_sub_u32 s57, s57, 1
    s_cbranch_scc1 L_back51
    s_cbranch_vccnz L_fixl51
    s_branch L_back51
L_fix52:
    s_mov_b32 s57, 4096
L_fixl52:
    s_add_u32 s56, s67, 8192
    buffer_load_dwordx4 v[160:163], v1, s[8:11], s56 offen offset:0 sc1
    s_waitcnt vmcnt(0)
    v_cmp_eq_u32 vcc, -1, v160
    s_sub_u32 s57, s57, 1
    s_cbranch_scc1 L_back52
    s_cbranch_vccnz L_fixl52
    s_branch L_back52
L_fix53:
    s_mov_b32 s57, 4096
L_fixl53:
    s_add_u32 s56, s67, 8192
    buffer_load_dwordx4 v[164:167], v1, s[8:11], s56 offen offset:1024 sc1
    s_waitcnt vmcnt(0)
    v_cmp_eq_u32 vcc, -1, v164
    s_sub_u32 s57, s57, 1
    s_cbranch_scc1 L_back53
    s_cbranch_vccnz L_fixl53
    s_branch L_back53
L_fix54:
    s_mov_b32 s57, 4096
L_fixl54:
    s_add_u32 s56, s67, 8192
    buffer_load_dwordx4 v[168:171], v1, s[8:11], s56 offen offset:2048 sc1
    s_waitcnt vmcnt(0)
    v_cmp_eq_u32 vcc, -1, v168
    s_sub_u32 s57, s57, 1
    s_cbranch_scc1 L_back54
    s_cbranch_vccnz L_fixl54
    s_branch L_back54
L_fix55:
    s_mov_b32 s57, 4096
L_fixl55:
    s_add_u32 s56, s67, 8192
    buffer_load_dwordx4 v[172:175], v1, s[8:11], s56 offen offset:3072 sc1
    s_waitcnt vmcnt(0)
    v_cmp_eq_u32 vcc, -1, v172
    s_sub_u32 s57, s57, 1
    s_cbranch_scc1 L_back55
    s_cbranch_vccnz L_fixl55
    s_branch L_back55
L_fix56:
    s_mov_b32 s57, 4096
L_fixl56:
    s_add_u32 s56, s67, 12288
    buffer_load_dwordx4 v[176:179], v1, s[8:11], s56 offen offset:0 sc1
    s_waitcnt vmcnt(0)
    v_cmp_eq_u32 vcc, -1, v176
    s_sub_u32 s57, s57, 1
    s_cbranch_scc1 L_back56
    s_cbranch_vccnz L_fixl56
    s_branch L_back56
L_fix57:
    s_mov_b32 s57, 4096
L_fixl57:
    s_add_u32 s56, s67, 12288
    buffer_load_dwordx4 v[180:183], v1, s[8:11], s56 offen offset:1024 sc1
    s_waitcnt vmcnt(0)
    v_cmp_eq_u32 vcc, -1, v180
    s_sub_u32 s57, s57, 1
    s_cbranch_scc1 L_back57
    s_cbranch_vccnz L_fixl57
    s_branch L_back57
L_fix58:
    s_mov_b32 s57, 4096
L_fixl58:
    s_add_u32 s56, s67, 12288
    buffer_load_dwordx4 v[184:187], v1, s[8:11], s56 offen offset:2048 sc1
    s_waitcnt vmcnt(0)
    v_cmp_eq_u32 vcc, -1, v184
    s_sub_u32 s57, s57, 1
    s_cbranch_scc1 L_back58
    s_cbranch_vccnz L_fixl58
    s_branch L_back58
L_fix59:
    s_mov_b32 s57, 4096
L_fixl59:
    s_add_u32 s56, s67, 12288
    buffer_load_dwordx4 v[188:191], v1, s[8:11], s56 offen offset:3072 sc1
    s_waitcnt vmcnt(0)
    v_cmp_eq_u32 vcc, -1, v188
    s_sub_u32 s57, s57, 1
    s_cbranch_scc1 L_back59
    s_cbranch_vccnz L_fixl59
    s_branch L_back59
L_fix60:
    s_mov_b32 s57, 4096
L_fixl60:
    s_add_u32 s56, s67, 16384
    buffer_load_dwordx4 v[192:195], v1, s[8:11], s56 offen offset:0 sc1
    s_waitcnt vmcnt(0)
    v_cmp_eq_u32 vcc, -1, v192
    s_sub_u32 s57, s57, 1
    s_cbranch_scc1 L_back60
    s_cbranch_vccnz L_fixl60
    s_branch L_back60
L_fix61:
    s_mov_b32 s57, 4096
L_fixl61:
    s_add_u32 s56, s67, 16384
    buffer_load_dwordx4 v[196:199], v1, s[8:11], s56 offen offset:1024 sc1
    s_waitcnt vmcnt(0)
    v_cmp_eq_u32 vcc, -1, v196
    s_sub_u32 s57, s57, 1
    s_cbranch_scc1 L_back61
    s_cbranch_vccnz L_fixl61
    s_branch L_back61
L_fix62:
    s_mov_b32 s57, 4096
L_fixl62:
    s_add_u32 s56, s67, 16384
    buffer_load_dwordx4 v[200:203], v1, s[8:11], s56 offen offset:2048 sc1
    s_waitcnt vmcnt(0)
    v_cmp_eq_u32 vcc, -1, v200
    s_sub_u32 s57, s57, 1
    s_cbranch_scc1 L_back62
    s_cbranch_vccnz L_fixl62
    s_branch L_back62
L_fix63:
    s_mov_b32 s57, 4096
L_fixl63:
    s_add_u32 s56, s67, 16384
    buffer_load_dwordx4 v[204:207], v1, s[8:11], s56 offen offset:3072 sc1
    s_waitcnt vmcnt(0)
    v_cmp_eq_u32 vcc, -1, v204
    s_sub_u32 s57, s57, 1
    s_cbranch_scc1 L_back63
    s_cbranch_vccnz L_fixl63
    s_branch L_back63
L_fix64:
    s_mov_b32 s57, 4096
L_fixl64:
    s_add_u32 s56, s67, 20480
    buffer_load_dwordx4 v[208:211], v1, s[8:11], s56 offen offset:0 sc1
    s_waitcnt vmcnt(0)
    v_cmp_eq_u32 vcc, -1, v208
    s_sub_u32 s57, s57, 1
    s_cbranch_scc1 L_back64
    s_cbranch_vccnz L_fixl64
    s_branch L_back64
L_fix65:
    s_mov_b32 s57, 4096
L_fixl65:
    s_add_u32 s56, s67, 20480
    buffer_load_dwordx4 v[212:215], v1, s[8:11], s56 offen offset:1024 sc1
    s_waitcnt vmcnt(0)
    v_cmp_eq_u32 vcc, -1, v212
    s_sub_u32 s57, s57, 1
    s_cbranch_scc1 L_back65
    s_cbranch_vccnz L_fixl65
    s_branch L_back65
L_fix66:
    s_mov_b32 s57, 4096
L_fixl66:
    s_add_u32 s56, s67, 20480
    buffer_load_dwordx4 v[216:219], v1, s[8:11], s56 offen offset:2048 sc1
    s_waitcnt vmcnt(0)
    v_cmp_eq_u32 vcc, -1, v216
    s_sub_u32 s57, s57, 1
    s_cbranch_scc1 L_back66
    s_cbranch_vccnz L_fixl66
    s_branch L_back66
L_fix67:
    s_mov_b32 s57, 4096
L_fixl67:
    s_add_u32 s56, s67, 20480
    buffer_load_dwordx4 v[220:223], v1, s[8:11], s56 offen offset:3072 sc1
    s_waitcnt vmcnt(0)
    v_cmp_eq_u32 vcc, -1, v220
    s_sub_u32 s57, s57, 1
    s_cbranch_scc1 L_back67
    s_cbranch_vccnz L_fixl67
    s_branch L_back67
L_fix68:
    s_mov_b32 s57, 4096
L_fixl68:
    s_add_u32 s56, s67, 24576
    buffer_load_dwordx4 v[224:227], v1, s[8:11], s56 offen offset:0 sc1
    s_waitcnt vmcnt(0)
    v_cmp_eq_u32 vcc, -1, v224
    s_sub_u32 s57, s57, 1
    s_cbranch_scc1 L_back68
    s_cbranch_vccnz L_fixl68
    s_branch L_back68
L_fix69:
    s_mov_b32 s57, 4096
L_fixl69:
    s_add_u32 s56, s67, 24576
    buffer_load_dwordx4 v[228:231], v1, s[8:11], s56 offen offset:1024 sc1
    s_waitcnt vmcnt(0)
    v_cmp_eq_u32 vcc, -1, v228
    s_sub_u32 s57, s57, 1
    s_cbranch_scc1 L_back69
    s_cbranch_vccnz L_fixl69
    s_branch L_back69
L_fix70:
    s_mov_b32 s57, 4096
L_fixl70:
    s_add_u32 s56, s67, 24576
    buffer_load_dwordx4 v[232:235], v1, s[8:11], s56 offen offset:2048 sc1
    s_waitcnt vmcnt(0)
    v_cmp_eq_u32 vcc, -1, v232
    s_sub_u32 s57, s57, 1
    s_cbranch_scc1 L_back70
    s_cbranch_vccnz L_fixl70
    s_branch L_back70
L_fix71:
    s_mov_b32 s57, 4096
L_fixl71:
    s_add_u32 s56, s67, 24576
    buffer_load_dwordx4 v[236:239], v1, s[8:11], s56 offen offset:3072 sc1
    s_waitcnt vmcnt(0)
    v_cmp_eq_u32 vcc, -1, v236
    s_sub_u32 s57, s57, 1
    s_cbranch_scc1 L_back71
    s_cbranch_vccnz L_fixl71
    s_branch L_back71
L_fix72:
    s_mov_b32 s57, 4096
L_fixl72:
    s_add_u32 s56, s67, 28672
    buffer_load_dwordx4 v[240:243], v1, s[8:11], s56 offen offset:0 sc1
    s_waitcnt vmcnt(0)
    v_cmp_eq_u32 vcc, -1, v240
    s_sub_u32 s57, s57, 1
    s_cbranch_scc1 L_back72
    s_cbranch_vccnz L_fixl72
    s_branch L_back72
L_fix73:
    s_mov_b32 s57, 4096
L_fixl73:
    s_add_u32 s56, s67, 28672
    buffer_load_dwordx4 v[244:247], v1, s[8:11], s56 offen offset:1024 sc1
    s_waitcnt vmcnt(0)
    v_cmp_eq_u32 vcc, -1, v244
    s_sub_u32 s57, s57, 1
    s_cbranch_scc1 L_back73
    s_cbranch_vccnz L_fixl73
    s_branch L_back73
L_fix74:
    s_mov_b32 s57, 4096
L_fixl74:
    s_add_u32 s56, s67, 28672
    buffer_load_dwordx4 v[248:251], v1, s[8:11], s56 offen offset:2048 sc1
    s_waitcnt vmcnt(0)
    v_cmp_eq_u32 vcc, -1, v248
    s_sub_u32 s57, s57, 1
    s_cbranch_scc1 L_back74
    s_cbranch_vccnz L_fixl74
    s_branch L_back74
L_fix75:
    s_mov_b32 s57, 4096
L_fixl75:
    s_add_u32 s56, s67, 28672
    buffer_load_dwordx4 v[252:255], v1, s[8:11], s56 offen offset:3072 sc1
    s_waitcnt vmcnt(0)
    v_cmp_eq_u32 vcc, -1, v252
    s_sub_u32 s57, s57, 1
    s_cbranch_scc1 L_back75
    s_cbranch_vccnz L_fixl75
    s_branch L_back75
L_fix76:
    s_mov_b32 s57, 4096
L_fixl76:
    buffer_load_dwordx2 v[112:113], v6, s[8:11], s32 offen offset:0 sc1
    buffer_load_dwordx2 v[114:115], v6, s[8:11], s32 offen offset:128 sc1
    buffer_load_dwordx2 v[116:117], v6, s[8:11], s32 offen offset:256 sc1
    buffer_load_dwordx2 v[118:119], v6, s[8:11], s32 offen offset:384 sc1
    s_waitcnt vmcnt(0)
    v_max_u32 v11, v112, v113
    v_max3_u32 v11, v11, v114, v115
    v_max3_u32 v11, v11, v116, v117
    v_max3_u32 v11, v11, v118, v119
    v_cmp_eq_u32 s[6:7], -1, v11
    s_sub_u32 s57, s57, 1
    s_cbranch_scc1 L_back76
    s_cmp_lg_u64 s[6:7], 0
    s_cbranch_scc1 L_fixl76
    s_branch L_back76
L_fix83:
    s_mov_b32 s57, 4096
L_fixl83:
    buffer_load_dwordx4 v[96:99], v6, s[8:11], s85 offen sc1
    buffer_load_dwordx4 v[100:103], v6, s[8:11], s85 offen offset:512 sc1
    s_waitcnt vmcnt(0)
    v_max_u32 v112, v96, v100
    v_cmp_eq_u32 vcc, -1, v112
    s_sub_u32 s57, s57, 1
    s_cbranch_scc1 L_back83
    s_cbranch_vccnz L_fixl83
    s_branch L_back83

.section .rodata,"a"
.p2align 6
.amdhsa_kernel interleave_layers__sliding_local_dilated__glu_gated_geglu__prompt_kernel
  .amdhsa_next_free_vgpr 512
  .amdhsa_next_free_sgpr 102
  .amdhsa_accum_offset 256
  .amdhsa_group_segment_fixed_size 0
  .amdhsa_kernarg_size 80
  .amdhsa_user_sgpr_count 2
  .amdhsa_user_sgpr_kernarg_segment_ptr 1
  .amdhsa_system_sgpr_workgroup_id_x 1
  .amdhsa_float_denorm_mode_32 3
.end_amdhsa_kernel
```
